```python
import torch

def _softmax(x, axis=-1):
    return torch.softmax(x, dim=axis)

def _gelu(x):
    return torch.nn.functional.gelu(x, approximate='tanh')

def _silu(x):
    return torch.nn.functional.silu(x)

def _sigmoid(x):
    return torch.sigmoid(x)

def _layernorm(x, axis=-1, eps=1e-05):
    m = x.mean(dim=axis, keepdim=True)
    v = x.var(dim=axis, keepdim=True, unbiased=False)
    return (x - m) / torch.sqrt(v + eps)

def _scatter_add(tgt, idx, src, axis=0):
    return tgt.clone().index_add_(axis, idx, src)

def _segment_sum(src, seg, n):
    out = torch.zeros((n,) + src.shape[1:], dtype=src.dtype)
    return out.index_add_(0, seg, src)

def _pad(x, pw):
    flat = tuple((v for pair in reversed(pw) for v in pair))
    return torch.nn.functional.pad(x, flat)
kernel_name = 'adaLN_cond__grouped_kv_mqa__dense_activation_silu__prompt'

def setup_inputs():

    _w = lambda a: (lambda t: t.to(torch.bfloat16) if t.is_floating_point() else t)(torch.as_tensor(a))

    def _A_setup():
        B, S, D, H = (1, 2048, 1024, 32)
        Dh = D // H
        return {'x': _w((lambda *s: torch.randn(*s, dtype=torch.bfloat16) * 0.05)(B, S, D)), 'wq': _w((lambda *s: torch.randn(*s, dtype=torch.bfloat16) * 0.05)(D, H * Dh)), 'wk': _w((lambda *s: torch.randn(*s, dtype=torch.bfloat16) * 0.05)(D, Dh)), 'wv': _w((lambda *s: torch.randn(*s, dtype=torch.bfloat16) * 0.05)(D, Dh)), 'wo': _w((lambda *s: torch.randn(*s, dtype=torch.bfloat16) * 0.05)(H * Dh, D))}
    _A_in = _A_setup()

    def _B_setup():
        B, S, D, F = (1, 2048, 1024, 3584)
        return {'x': _w((lambda *s: torch.randn(*s, dtype=torch.bfloat16) * 0.05)(B, S, D)), 'w1': _w((lambda *s: torch.randn(*s, dtype=torch.bfloat16) * 3.2)(D, F) * D ** (-0.5)), 'w2': _w((lambda *s: torch.randn(*s, dtype=torch.bfloat16) * 0.8)(F, D) * F ** (-0.5))}
    _B_in = _B_setup()
    return {'A_x': _A_in['x'], 'A_wq': _A_in['wq'], 'A_wk': _A_in['wk'], 'A_wv': _A_in['wv'], 'A_wo': _A_in['wo'], 'B_x': _B_in['x'], 'B_w1': _B_in['w1'], 'B_w2': _B_in['w2'], 'c': _w((lambda *s: torch.randn(*s, dtype=torch.bfloat16) * 0.1)(1, 1024) * 8.0), 'w_mod': _w((lambda *s: torch.randn(*s, dtype=torch.bfloat16) * 0.1)(1024, 6 * 1024) * 1024 ** (-0.5) * 8.0)}

def reference(A_x, A_wq, A_wk, A_wv, A_wo, B_x, B_w1, B_w2, c, w_mod):

    def _A_ref(x, wq, wk, wv, wo):
        B, S, D = x.shape
        H = 32
        Dh = D // H
        q = (lambda x, *d: x.permute(*d))((x @ wq).reshape(B, S, H, Dh), 0, 2, 1, 3)
        k = x @ wk
        v = x @ wv
        scores = torch.einsum('bhqd,bkd->bhqk', q, k) * Dh ** (-0.5)
        p = _softmax(scores, axis=-1)
        o = torch.einsum('bhqk,bkd->bhqd', p, v)
        return (lambda x, *d: x.permute(*d))(o, 0, 2, 1, 3).reshape(B, S, H * Dh) @ wo

    def _B_ref(x, w1, w2):
        h = torch.einsum('bsd,df->bsf', x, w1)
        h = _silu(h)
        out = torch.einsum('bsf,fd->bsd', h, w2)
        return out
    x = A_x
    mod = (_silu(c) @ w_mod).reshape(c.shape[0], 6, 1, -1)
    sa, ca, ga, sb, cb, gb = (mod[:, 0].clone(), mod[:, 1].clone(), mod[:, 2].clone(), mod[:, 3].clone(), mod[:, 4].clone(), mod[:, 5].clone())
    h = _layernorm(x, axis=-1) * (1 + ca) + sa
    x = x + ga * _A_ref(h, A_wq, A_wk, A_wv, A_wo)
    h = _layernorm(x, axis=-1) * (1 + cb) + sb
    x = x + gb * _B_ref(h, B_w1, B_w2)
    return x
```

```asm
; @launch kernel=adaLN_cond__grouped_kv_mqa__dense_activation_silu__prompt_kernel grid=(256,1,1) block=(512,1,1) lds=163840
.amdgcn_target "amdgcn-amd-amdhsa--gfx950"
.text
.globl adaLN_cond__grouped_kv_mqa__dense_activation_silu__prompt_kernel
.p2align 8
.type adaLN_cond__grouped_kv_mqa__dense_activation_silu__prompt_kernel,@function
adaLN_cond__grouped_kv_mqa__dense_activation_silu__prompt_kernel:
  s_cmp_ge_u32 s2, 256
  s_cbranch_scc1 L_f_exit
  v_lshrrev_b32 v1, 6, v0
  v_and_b32 v2, 63, v0
  v_readfirstlane_b32 s42, v1
  s_load_dwordx2 s[10:11], s[0:1], 96
  s_load_dwordx2 s[56:57], s[0:1], 88
  s_cmp_ge_u32 s2, 128
  s_cbranch_scc1 L_f_ln
  s_load_dwordx2 s[4:5], s[0:1], 64
  s_load_dwordx2 s[6:7], s[0:1], 72
  s_load_dwordx2 s[8:9], s[0:1], 8
  s_load_dwordx2 s[36:37], s[0:1], 32
  s_and_b32 s28, s2, 31
  s_lshr_b32 s29, s2, 5
  v_lshlrev_b32 v3, 4, v2
  v_lshrrev_b32 v4, 3, v2
  v_and_b32 v5, 7, v2
  v_mul_u32_u24 v6, 49152, v4
  v_lshl_add_u32 v6, v5, 4, v6
  s_lshl_b32 s30, s29, 3
  s_add_u32 s30, s30, s42
  s_mul_i32 s31, s30, 64
  s_mul_i32 s30, s30, 393216
  s_lshl_b32 s21, s28, 7
  s_add_u32 s30, s30, s21
  v_lshlrev_b32 v7, 2, v2
  s_waitcnt lgkmcnt(0)
  s_mov_b32 s12, s4
  s_and_b32 s13, s5, 0xffff
  s_mov_b32 s14, 2048
  s_mov_b32 s15, 0x20000
  s_mov_b32 s16, s6
  s_and_b32 s17, s7, 0xffff
  s_mov_b32 s18, 12582912
  s_mov_b32 s19, 0x20000
  s_add_u32 s24, s10, 65536
  s_addc_u32 s25, s11, 0
  s_and_b32 s25, s25, 0xffff
  s_mov_b32 s26, 98304
  s_mov_b32 s27, 0x20000
  buffer_load_dword v8, v7, s[12:15], s31 offen
  s_add_u32 s22, s30, 0
  buffer_load_dwordx4 v[32:35], v6, s[16:19], s22 offen
  s_add_u32 s22, s30, 12288
  buffer_load_dwordx4 v[36:39], v6, s[16:19], s22 offen
  s_add_u32 s22, s30, 24576
  buffer_load_dwordx4 v[40:43], v6, s[16:19], s22 offen
  s_add_u32 s22, s30, 36864
  buffer_load_dwordx4 v[44:47], v6, s[16:19], s22 offen
  v_lshrrev_b32 v64, 3, v2
  s_mov_b32 s47, 2048
  v_mul_lo_u32 v64, v64, s47
  v_and_b32 v66, 7, v2
  v_lshl_add_u32 v64, v66, 4, v64
  v_bfe_u32 v65, v2, 2, 2
  v_bfe_u32 v66, v2, 4, 1
  v_lshl_add_u32 v65, v66, 3, v65
  v_lshrrev_b32 v66, 5, v2
  v_lshl_add_u32 v65, v66, 4, v65
  v_lshlrev_b32 v65, 7, v65
  v_and_b32 v66, 3, v2
  v_lshl_add_u32 v65, v66, 3, v65
  v_bfe_u32 v66, v2, 4, 1
  v_lshlrev_b32 v66, 9, v66
  v_sub_u32 v66, v65, v66
  s_cmp_lt_u32 s42, 4
  s_cselect_b64 vcc, -1, 0
  s_cselect_b32 s32, s8, s36
  s_cselect_b32 s33, s9, s37
  s_and_b32 s33, s33, 0xffff
  s_mov_b32 s34, 0x200000
  s_mov_b32 s35, 0x20000
  v_cndmask_b32 v65, v66, v65, vcc
  s_lshl_b32 s45, s2, 2
  s_and_b32 s46, s42, 3
  s_add_u32 s45, s45, s46
  s_lshl_b32 s46, s42, 12
  v_add_u32 v65, s46, v65
  s_and_b32 s47, s45, 31
  s_lshl_b32 s47, s47, 16
  s_lshr_b32 s48, s45, 5
  s_lshl_b32 s48, s48, 7
  s_add_u32 s47, s47, s48
  s_waitcnt vmcnt(4)
  v_and_b32 v9, 0xffff0000, v8
  v_lshlrev_b32 v8, 16, v8
  v_mul_f32 v10, 0xbfb8aa3b, v8
  v_mul_f32 v11, 0xbfb8aa3b, v9
  v_exp_f32 v10, v10
  v_exp_f32 v11, v11
  s_lshl_b32 s22, s42, 9
  v_add_f32 v10, 1.0, v10
  v_add_f32 v11, 1.0, v11
  v_rcp_f32 v10, v10
  v_rcp_f32 v11, v11
  s_add_u32 s22, s22, 32768
  v_mul_f32 v8, v8, v10
  v_mul_f32 v9, v9, v11
  s_add_u32 s12, s10, 196608
  s_addc_u32 s13, s11, 0
  s_and_b32 s13, s13, 0xffff
  s_mov_b32 s14, 2048
  s_mov_b32 s15, 0x20000
  v_cvt_pk_bf16_f32 v10, v8, v9
  s_cmp_eq_u32 s28, 0
  s_cselect_b32 s14, 2048, 0
  v_mov_b32 v11, 0x80000000
  v_cmp_gt_u32 vcc, 16, v2
  v_lshlrev_b32 v8, 16, v10
  v_and_b32 v9, 0xffff0000, v10
  v_cndmask_b32 v11, v11, v7, vcc
  buffer_store_dword v10, v11, s[12:15], s31 offen sc0 sc1
  v_lshl_add_u32 v10, v2, 3, s22
  ds_write_b64 v10, v[8:9]
  v_lshl_add_u32 v10, v4, 4, s22
  s_waitcnt lgkmcnt(0)
  ds_read_b128 v[12:15], v10 offset:0
  s_waitcnt lgkmcnt(0)
  s_waitcnt vmcnt(4)
  v_lshlrev_b32 v28, 16, v32
  v_and_b32 v29, 0xffff0000, v32
  v_mul_f32 v20, v28, v12
  v_mul_f32 v21, v29, v12
  v_lshlrev_b32 v30, 16, v33
  v_and_b32 v31, 0xffff0000, v33
  v_mul_f32 v22, v30, v12
  v_mul_f32 v23, v31, v12
  v_lshlrev_b32 v28, 16, v34
  v_and_b32 v29, 0xffff0000, v34
  v_mul_f32 v24, v28, v12
  v_mul_f32 v25, v29, v12
  v_lshlrev_b32 v30, 16, v35
  v_and_b32 v31, 0xffff0000, v35
  v_mul_f32 v26, v30, v12
  v_mul_f32 v27, v31, v12
  s_waitcnt vmcnt(3)
  v_lshlrev_b32 v28, 16, v36
  v_and_b32 v29, 0xffff0000, v36
  v_fmac_f32 v20, v28, v13
  v_fmac_f32 v21, v29, v13
  v_lshlrev_b32 v30, 16, v37
  v_and_b32 v31, 0xffff0000, v37
  v_fmac_f32 v22, v30, v13
  v_fmac_f32 v23, v31, v13
  v_lshlrev_b32 v28, 16, v38
  v_and_b32 v29, 0xffff0000, v38
  v_fmac_f32 v24, v28, v13
  v_fmac_f32 v25, v29, v13
  v_lshlrev_b32 v30, 16, v39
  v_and_b32 v31, 0xffff0000, v39
  v_fmac_f32 v26, v30, v13
  v_fmac_f32 v27, v31, v13
  s_waitcnt vmcnt(2)
  v_lshlrev_b32 v28, 16, v40
  v_and_b32 v29, 0xffff0000, v40
  v_fmac_f32 v20, v28, v14
  v_fmac_f32 v21, v29, v14
  v_lshlrev_b32 v30, 16, v41
  v_and_b32 v31, 0xffff0000, v41
  v_fmac_f32 v22, v30, v14
  v_fmac_f32 v23, v31, v14
  v_lshlrev_b32 v28, 16, v42
  v_and_b32 v29, 0xffff0000, v42
  v_fmac_f32 v24, v28, v14
  v_fmac_f32 v25, v29, v14
  v_lshlrev_b32 v30, 16, v43
  v_and_b32 v31, 0xffff0000, v43
  v_fmac_f32 v26, v30, v14
  v_fmac_f32 v27, v31, v14
  s_waitcnt vmcnt(1)
  v_lshlrev_b32 v28, 16, v44
  v_and_b32 v29, 0xffff0000, v44
  v_fmac_f32 v20, v28, v15
  v_fmac_f32 v21, v29, v15
  v_lshlrev_b32 v30, 16, v45
  v_and_b32 v31, 0xffff0000, v45
  v_fmac_f32 v22, v30, v15
  v_fmac_f32 v23, v31, v15
  v_lshlrev_b32 v28, 16, v46
  v_and_b32 v29, 0xffff0000, v46
  v_fmac_f32 v24, v28, v15
  v_fmac_f32 v25, v29, v15
  v_lshlrev_b32 v30, 16, v47
  v_and_b32 v31, 0xffff0000, v47
  v_fmac_f32 v26, v30, v15
  v_fmac_f32 v27, v31, v15
  s_nop 1
  v_permlane32_swap_b32 v20, v24
  v_permlane32_swap_b32 v21, v25
  v_permlane32_swap_b32 v22, v26
  v_permlane32_swap_b32 v23, v27
  v_add_f32 v20, v20, v24
  v_add_f32 v21, v21, v25
  v_add_f32 v22, v22, v26
  v_add_f32 v23, v23, v27
  s_nop 1
  v_permlane16_swap_b32 v20, v22
  v_permlane16_swap_b32 v21, v23
  v_add_f32 v20, v20, v22
  v_add_f32 v21, v21, v23
  s_nop 1
  v_add_f32_dpp v20, v20, v20 row_ror:8 row_mask:0xf bank_mask:0xf
  v_add_f32_dpp v21, v21, v21 row_ror:8 row_mask:0xf bank_mask:0xf
  v_lshrrev_b32 v10, 4, v2
  v_lshlrev_b32 v10, 3, v10
  v_lshl_add_u32 v10, v5, 5, v10
  s_lshl_b32 s22, s42, 8
  s_add_u32 s22, s22, 36864
  v_add_u32 v10, s22, v10
  ds_write_b64 v10, v[20:21]
  s_cmp_lg_u32 s42, 0
  s_cbranch_scc1 L_f1_nowait
  s_mov_b32 s12, s56
  s_and_b32 s13, s57, 0xffff
  s_mov_b32 s14, 256
  s_mov_b32 s15, 0x20000
  v_and_b32 v28, 7, v2
  v_lshlrev_b32 v28, 2, v28
  s_mov_b32 s51, 4194304
L_f_wig:
  buffer_load_dword v29, v28, s[12:15], 0 offen sc1
  s_waitcnt vmcnt(0)
  v_cmp_eq_u32 vcc, 0, v29
  s_sub_u32 s51, s51, 1
  s_cbranch_scc1 L_f_wdg
  s_cmp_lg_u64 vcc, 0
  s_cbranch_scc1 L_f_wig
L_f_wdg:
L_f1_nowait:
  s_waitcnt lgkmcnt(0)
  s_barrier
  s_cmp_lg_u32 s42, 0
  s_cbranch_scc1 L_f1_gdone
  v_add_u32 v10, 36864, v7
  ds_read_b32 v12, v10 offset:0
  ds_read_b32 v13, v10 offset:256
  ds_read_b32 v14, v10 offset:512
  ds_read_b32 v15, v10 offset:768
  ds_read_b32 v16, v10 offset:1024
  ds_read_b32 v17, v10 offset:1280
  ds_read_b32 v18, v10 offset:1536
  ds_read_b32 v19, v10 offset:1792
  s_mul_i32 s21, s29, 24576
  s_lshl_b32 s22, s28, 8
  s_add_u32 s21, s21, s22
  s_waitcnt lgkmcnt(0)
  v_add_f32 v12, v12, v13
  v_add_f32 v12, v12, v14
  v_add_f32 v12, v12, v15
  v_add_f32 v12, v12, v16
  v_add_f32 v12, v12, v17
  v_add_f32 v12, v12, v18
  v_add_f32 v12, v12, v19
  v_min_u32 v12, -2, v12
  buffer_store_dword v12, v7, s[24:27], s21 offen sc0 sc1
L_f1_gdone:
  s_barrier
  s_add_u32 m0, s46, 0
  s_add_u32 s48, s47, 0
  buffer_load_dwordx4 v64, s[32:35], s48 offen lds
  s_add_u32 m0, s46, 1024
  s_add_u32 s48, s47, 16384
  buffer_load_dwordx4 v64, s[32:35], s48 offen lds
  s_add_u32 m0, s46, 2048
  s_add_u32 s48, s47, 32768
  buffer_load_dwordx4 v64, s[32:35], s48 offen lds
  s_add_u32 m0, s46, 3072
  s_add_u32 s48, s47, 49152
  buffer_load_dwordx4 v64, s[32:35], s48 offen lds
  s_add_u32 s16, s10, 33554432
  s_addc_u32 s17, s11, 0
  s_and_b32 s17, s17, 0xffff
  s_mov_b32 s18, 4194304
  s_mov_b32 s19, 0x20000
  s_cmp_lg_u32 s42, 7
  s_cbranch_scc1 L_f_nopull
  s_getpc_b64 s[68:69]
L_adaLN_cond__grouped_kv_mqa__dense_activation_silu__prompt_kernel_pc_1:
  s_add_u32 s68, s68, L_f_end-L_adaLN_cond__grouped_kv_mqa__dense_activation_silu__prompt_kernel_pc_1
  s_addc_u32 s69, s69, 0
  v_lshlrev_b32 v70, 7, v2
  v_min_u32 v71, L_code_end-L_f_end-4, v70
  global_load_dword v72, v71, s[68:69]
  v_add_u32 v70, 8192, v70
  v_min_u32 v71, L_code_end-L_f_end-4, v70
  global_load_dword v72, v71, s[68:69]
  v_add_u32 v70, 8192, v70
  v_min_u32 v71, L_code_end-L_f_end-4, v70
  global_load_dword v72, v71, s[68:69]
  v_add_u32 v70, 8192, v70
  v_min_u32 v71, L_code_end-L_f_end-4, v70
  global_load_dword v72, v71, s[68:69]
L_f_nopull:
  s_lshl_b32 s47, s45, 12
  s_cmp_lt_u32 s42, 4
  s_waitcnt vmcnt(0)
  s_cbranch_scc0 L_f_pko
  ds_read_b64_tr_b16 v[32:33], v65 offset:0
  ds_read_b64_tr_b16 v[34:35], v65 offset:512
  ds_read_b64_tr_b16 v[36:37], v65 offset:32
  ds_read_b64_tr_b16 v[38:39], v65 offset:544
  ds_read_b64_tr_b16 v[40:41], v65 offset:64
  ds_read_b64_tr_b16 v[42:43], v65 offset:576
  ds_read_b64_tr_b16 v[44:45], v65 offset:96
  ds_read_b64_tr_b16 v[46:47], v65 offset:608
  s_branch L_f_pkst
L_f_pko:
  s_add_u32 s47, s47, 2097152
  ds_read_b64_tr_b16 v[32:33], v65 offset:0
  ds_read_b64_tr_b16 v[34:35], v65 offset:1024
  ds_read_b64_tr_b16 v[36:37], v65 offset:32
  ds_read_b64_tr_b16 v[38:39], v65 offset:1056
  ds_read_b64_tr_b16 v[40:41], v65 offset:64
  ds_read_b64_tr_b16 v[42:43], v65 offset:1088
  ds_read_b64_tr_b16 v[44:45], v65 offset:96
  ds_read_b64_tr_b16 v[46:47], v65 offset:1120
L_f_pkst:
  s_add_u32 s20, s10, 6029312
  s_addc_u32 s21, s11, 0
  s_and_b32 s21, s21, 0xffff
  s_mov_b32 s22, 131072
  s_mov_b32 s23, 0x20000
  s_lshl_b32 s48, s2, 10
  s_lshl_b32 s49, s42, 7
  s_add_u32 s48, s48, s49
  v_and_b32 v4, 31, v2
  v_lshlrev_b32 v4, 2, v4
  v_mov_b32 v5, 0
  buffer_store_dword v5, v4, s[20:23], s48 offen sc0 sc1
  s_waitcnt lgkmcnt(0)
  buffer_store_dwordx4 v[32:35], v3, s[16:19], s47 offen offset:0 sc0 sc1
  buffer_store_dwordx4 v[36:39], v3, s[16:19], s47 offen offset:1024 sc0 sc1
  buffer_store_dwordx4 v[40:43], v3, s[16:19], s47 offen offset:2048 sc0 sc1
  buffer_store_dwordx4 v[44:47], v3, s[16:19], s47 offen offset:3072 sc0 sc1
  s_branch L_f_end
L_f_ln:
  s_load_dwordx2 s[4:5], s[0:1], 0
  s_load_dwordx2 s[6:7], s[0:1], 16
  s_load_dwordx2 s[8:9], s[0:1], 24
  s_and_b32 s40, s2, 7
  s_lshl_b32 s40, s40, 4
  s_sub_u32 s3, s2, 128
  s_lshr_b32 s3, s3, 3
  s_add_u32 s40, s40, s3
  v_and_b32 v3, 15, v2
  v_lshrrev_b32 v4, 4, v2
  v_lshlrev_b32 v5, 11, v3
  v_lshl_add_u32 v5, v4, 4, v5
  s_lshl_b32 s43, s40, 15
  s_lshl_b32 s44, s42, 8
  s_add_u32 s43, s43, s44
  v_lshrrev_b32 v7, 2, v2
  v_and_b32 v136, 3, v2
  v_lshrrev_b32 v137, 5, v2
  v_lshlrev_b32 v137, 1, v137
  v_xor_b32 v136, v136, v137
  v_lshlrev_b32 v7, 6, v7
  v_lshl_add_u32 v7, v136, 4, v7
  s_lshl_b32 s46, s42, 13
  s_lshl_b32 s47, s42, 14
  s_add_u32 s48, s46, 4096
  s_waitcnt lgkmcnt(0)
  s_mov_b32 s12, s4
  s_and_b32 s13, s5, 0xffff
  s_mov_b32 s14, 4194304
  s_mov_b32 s15, 0x20000
  s_mov_b32 s16, s6
  s_and_b32 s17, s7, 0xffff
  s_mov_b32 s18, 65536
  s_mov_b32 s19, 0x20000
  s_mov_b32 s20, s8
  s_and_b32 s21, s9, 0xffff
  s_mov_b32 s22, 65536
  s_mov_b32 s23, 0x20000
  s_add_u32 s24, s10, 65536
  s_addc_u32 s25, s11, 0
  s_and_b32 s25, s25, 0xffff
  s_mov_b32 s26, 98304
  s_mov_b32 s27, 0x20000
  s_mov_b32 s36, s56
  s_and_b32 s37, s57, 0xffff
  s_mov_b32 s38, 256
  s_mov_b32 s39, 0x20000
  v_lshlrev_b32 v6, 4, v0
  s_cmp_ge_u32 s2, 136
  s_cbranch_scc1 L_f_noinit
  s_cmp_eq_u32 s42, 0
  s_cbranch_scc1 L_f_init
  s_barrier
  s_branch L_f_noinit
L_f_init:
  s_and_b32 s55, s2, 7
  s_lshl_b32 s45, s55, 10
  v_mov_b32 v24, -1
  v_mov_b32 v25, -1
  v_mov_b32 v26, -1
  v_mov_b32 v27, -1
  buffer_store_dwordx4 v[24:27], v6, s[24:27], s45 offen sc0 sc1
  s_add_u32 s45, s45, 24576
  buffer_store_dwordx4 v[24:27], v6, s[24:27], s45 offen sc0 sc1
  s_add_u32 s45, s45, 24576
  buffer_store_dwordx4 v[24:27], v6, s[24:27], s45 offen sc0 sc1
  s_add_u32 s45, s45, 24576
  buffer_store_dwordx4 v[24:27], v6, s[24:27], s45 offen sc0 sc1
  s_add_u32 s45, s45, 24576
  s_add_u32 s28, s10, 5505024
  s_addc_u32 s29, s11, 0
  s_and_b32 s29, s29, 0xffff
  s_mov_b32 s30, 16384
  s_mov_b32 s31, 0x20000
  v_mov_b32 v32, 0
  v_mov_b32 v33, 0
  v_mov_b32 v34, 0
  v_mov_b32 v35, 0
  s_lshl_b32 s45, s55, 11
  buffer_store_dwordx4 v[32:35], v6, s[28:31], s45 offen sc0 sc1
  buffer_store_dwordx4 v[32:35], v6, s[28:31], s45 offen offset:1024 sc0 sc1
  s_lshl_b32 s55, s55, 2
  v_mov_b32 v28, s55
  s_waitcnt vmcnt(0)
  buffer_store_dword v24, v28, s[36:39], 0 offen sc0 sc1
  s_barrier
L_f_noinit:
  s_and_b32 s45, s40, 15
  s_lshl_b32 s45, s45, 12
  s_cmp_lt_u32 s42, 2
  s_cselect_b32 s45, s45, 0x40000000
  v_lshlrev_b32 v141, 6, v2
  s_cmp_eq_u32 s42, 0
  s_cbranch_scc1 L_f_pk
  buffer_load_dword v142, v141, s[20:23], s45 offen
  s_branch L_f_pd
L_f_pk:
  buffer_load_dword v142, v141, s[16:19], s45 offen
L_f_pd:
  buffer_load_dwordx4 v[8:11], v5, s[12:15], s43 offen offset:0
  buffer_load_dwordx4 v[12:15], v5, s[12:15], s43 offen offset:64
  buffer_load_dwordx4 v[16:19], v5, s[12:15], s43 offen offset:128
  buffer_load_dwordx4 v[20:23], v5, s[12:15], s43 offen offset:192
  s_add_u32 s28, s10, 1048576
  s_addc_u32 s29, s11, 0
  s_and_b32 s29, s29, 0xffff
  s_mov_b32 s30, 4194304
  s_mov_b32 s31, 0x20000
  s_add_u32 s32, s10, 5242880
  s_addc_u32 s33, s11, 0
  s_and_b32 s33, s33, 0xffff
  s_mov_b32 s34, 262144
  s_mov_b32 s35, 0x20000
  s_barrier
  s_add_u32 m0, s47, 0
  s_nop 0
  buffer_load_dwordx4 v7, s[16:19], s46 offen offset:0 lds
  buffer_load_dwordx4 v7, s[16:19], s46 offen offset:1024 lds
  buffer_load_dwordx4 v7, s[16:19], s46 offen offset:2048 lds
  buffer_load_dwordx4 v7, s[16:19], s46 offen offset:3072 lds
  s_add_u32 m0, s47, 8192
  s_nop 0
  buffer_load_dwordx4 v7, s[20:23], s46 offen offset:0 lds
  buffer_load_dwordx4 v7, s[20:23], s46 offen offset:1024 lds
  buffer_load_dwordx4 v7, s[20:23], s46 offen offset:2048 lds
  buffer_load_dwordx4 v7, s[20:23], s46 offen offset:3072 lds
  s_waitcnt vmcnt(8)
  v_lshlrev_b32 v24, 16, v8
  v_and_b32 v25, 0xffff0000, v8
  v_lshlrev_b32 v26, 16, v9
  v_and_b32 v27, 0xffff0000, v9
  v_lshlrev_b32 v28, 16, v10
  v_and_b32 v29, 0xffff0000, v10
  v_lshlrev_b32 v30, 16, v11
  v_and_b32 v31, 0xffff0000, v11
  v_lshlrev_b32 v32, 16, v12
  v_and_b32 v33, 0xffff0000, v12
  v_lshlrev_b32 v34, 16, v13
  v_and_b32 v35, 0xffff0000, v13
  v_lshlrev_b32 v36, 16, v14
  v_and_b32 v37, 0xffff0000, v14
  v_lshlrev_b32 v38, 16, v15
  v_and_b32 v39, 0xffff0000, v15
  v_lshlrev_b32 v40, 16, v16
  v_and_b32 v41, 0xffff0000, v16
  v_lshlrev_b32 v42, 16, v17
  v_and_b32 v43, 0xffff0000, v17
  v_lshlrev_b32 v44, 16, v18
  v_and_b32 v45, 0xffff0000, v18
  v_lshlrev_b32 v46, 16, v19
  v_and_b32 v47, 0xffff0000, v19
  v_lshlrev_b32 v48, 16, v20
  v_and_b32 v49, 0xffff0000, v20
  v_lshlrev_b32 v50, 16, v21
  v_and_b32 v51, 0xffff0000, v21
  v_lshlrev_b32 v52, 16, v22
  v_and_b32 v53, 0xffff0000, v22
  v_lshlrev_b32 v54, 16, v23
  v_and_b32 v55, 0xffff0000, v23
  v_pk_add_f32 v[120:121], v[24:25], v[26:27]
  v_pk_add_f32 v[120:121], v[120:121], v[28:29]
  v_pk_add_f32 v[120:121], v[120:121], v[30:31]
  v_pk_add_f32 v[120:121], v[120:121], v[32:33]
  v_pk_add_f32 v[120:121], v[120:121], v[34:35]
  v_pk_add_f32 v[120:121], v[120:121], v[36:37]
  v_pk_add_f32 v[120:121], v[120:121], v[38:39]
  v_pk_add_f32 v[120:121], v[120:121], v[40:41]
  v_pk_add_f32 v[120:121], v[120:121], v[42:43]
  v_pk_add_f32 v[120:121], v[120:121], v[44:45]
  v_pk_add_f32 v[120:121], v[120:121], v[46:47]
  v_pk_add_f32 v[120:121], v[120:121], v[48:49]
  v_pk_add_f32 v[120:121], v[120:121], v[50:51]
  v_pk_add_f32 v[120:121], v[120:121], v[52:53]
  v_pk_add_f32 v[120:121], v[120:121], v[54:55]
  v_add_f32 v120, v120, v121
  v_mov_b32 v121, v120
  s_nop 1
  v_permlane16_swap_b32 v120, v121
  v_add_f32 v120, v120, v121
  v_mov_b32 v121, v120
  s_nop 1
  v_permlane32_swap_b32 v120, v121
  v_add_f32 v120, v120, v121
  v_mul_f32 v132, 0xbc000000, v120
  s_add_u32 m0, s47, 4096
  s_nop 0
  buffer_load_dwordx4 v7, s[16:19], s48 offen offset:0 lds
  buffer_load_dwordx4 v7, s[16:19], s48 offen offset:1024 lds
  buffer_load_dwordx4 v7, s[16:19], s48 offen offset:2048 lds
  buffer_load_dwordx4 v7, s[16:19], s48 offen offset:3072 lds
  v_pk_add_f32 v[56:57], v[24:25], v[132:133] op_sel_hi:[1,0]
  v_pk_add_f32 v[58:59], v[26:27], v[132:133] op_sel_hi:[1,0]
  v_pk_add_f32 v[60:61], v[28:29], v[132:133] op_sel_hi:[1,0]
  v_pk_add_f32 v[62:63], v[30:31], v[132:133] op_sel_hi:[1,0]
  v_pk_add_f32 v[64:65], v[32:33], v[132:133] op_sel_hi:[1,0]
  v_pk_add_f32 v[66:67], v[34:35], v[132:133] op_sel_hi:[1,0]
  v_pk_add_f32 v[68:69], v[36:37], v[132:133] op_sel_hi:[1,0]
  v_pk_add_f32 v[70:71], v[38:39], v[132:133] op_sel_hi:[1,0]
  v_pk_add_f32 v[72:73], v[40:41], v[132:133] op_sel_hi:[1,0]
  v_pk_add_f32 v[74:75], v[42:43], v[132:133] op_sel_hi:[1,0]
  v_pk_add_f32 v[76:77], v[44:45], v[132:133] op_sel_hi:[1,0]
  v_pk_add_f32 v[78:79], v[46:47], v[132:133] op_sel_hi:[1,0]
  v_pk_add_f32 v[80:81], v[48:49], v[132:133] op_sel_hi:[1,0]
  v_pk_add_f32 v[82:83], v[50:51], v[132:133] op_sel_hi:[1,0]
  v_pk_add_f32 v[84:85], v[52:53], v[132:133] op_sel_hi:[1,0]
  v_pk_add_f32 v[86:87], v[54:55], v[132:133] op_sel_hi:[1,0]
  v_pk_mul_f32 v[120:121], v[56:57], v[56:57]
  v_pk_fma_f32 v[120:121], v[58:59], v[58:59], v[120:121]
  v_pk_fma_f32 v[120:121], v[60:61], v[60:61], v[120:121]
  v_pk_fma_f32 v[120:121], v[62:63], v[62:63], v[120:121]
  v_pk_fma_f32 v[120:121], v[64:65], v[64:65], v[120:121]
  v_pk_fma_f32 v[120:121], v[66:67], v[66:67], v[120:121]
  v_pk_fma_f32 v[120:121], v[68:69], v[68:69], v[120:121]
  v_pk_fma_f32 v[120:121], v[70:71], v[70:71], v[120:121]
  v_pk_fma_f32 v[120:121], v[72:73], v[72:73], v[120:121]
  v_pk_fma_f32 v[120:121], v[74:75], v[74:75], v[120:121]
  v_pk_fma_f32 v[120:121], v[76:77], v[76:77], v[120:121]
  v_pk_fma_f32 v[120:121], v[78:79], v[78:79], v[120:121]
  v_pk_fma_f32 v[120:121], v[80:81], v[80:81], v[120:121]
  v_pk_fma_f32 v[120:121], v[82:83], v[82:83], v[120:121]
  v_pk_fma_f32 v[120:121], v[84:85], v[84:85], v[120:121]
  v_pk_fma_f32 v[120:121], v[86:87], v[86:87], v[120:121]
  v_add_f32 v120, v120, v121
  v_mov_b32 v121, v120
  s_nop 1
  v_permlane16_swap_b32 v120, v121
  v_add_f32 v120, v120, v121
  v_mov_b32 v121, v120
  s_nop 1
  v_permlane32_swap_b32 v120, v121
  v_add_f32 v120, v120, v121
  v_lshlrev_b32 v122, 5, v3
  v_add_u32 v122, 139264, v122
  v_lshl_add_u32 v123, v1, 2, v122
  ds_write_b32 v123, v132
  ds_write_b32 v123, v120 offset:512
  s_add_u32 m0, s47, 12288
  s_nop 0
  buffer_load_dwordx4 v7, s[20:23], s48 offen offset:0 lds
  buffer_load_dwordx4 v7, s[20:23], s48 offen offset:1024 lds
  buffer_load_dwordx4 v7, s[20:23], s48 offen offset:2048 lds
  buffer_load_dwordx4 v7, s[20:23], s48 offen offset:3072 lds
  s_cmp_lg_u32 s42, 0
  s_cbranch_scc1 L_f_wdl
  s_mov_b32 s36, s56
  s_and_b32 s37, s57, 0xffff
  s_mov_b32 s38, 256
  s_mov_b32 s39, 0x20000
  v_and_b32 v141, 7, v2
  v_lshlrev_b32 v141, 2, v141
  s_mov_b32 s51, 4194304
L_f_wil:
  buffer_load_dword v142, v141, s[36:39], 0 offen sc1
  s_waitcnt vmcnt(0)
  v_cmp_eq_u32 vcc, 0, v142
  s_sub_u32 s51, s51, 1
  s_cbranch_scc1 L_f_wdl
  s_cmp_lg_u64 vcc, 0
  s_cbranch_scc1 L_f_wil
L_f_wdl:
  s_waitcnt lgkmcnt(0)
  s_barrier
  ds_read_b128 v[56:59], v122
  ds_read_b128 v[60:63], v122 offset:16
  ds_read_b128 v[124:127], v122 offset:512
  ds_read_b128 v[128:131], v122 offset:528
  s_lshr_b32 s49, s40, 3
  s_lshl_b32 s49, s49, 18
  s_and_b32 s50, s40, 7
  s_lshl_b32 s50, s50, 10
  s_add_u32 s49, s49, s50
  s_lshl_b32 s50, s42, 15
  s_add_u32 s49, s49, s50
  v_lshlrev_b32 v136, 4, v2
  v_lshrrev_b32 v137, 2, v3
  v_lshl_add_u32 v137, v4, 3, v137
  v_lshlrev_b32 v137, 6, v137
  v_and_b32 v138, 3, v2
  v_lshl_add_u32 v137, v138, 3, v137
  v_and_b32 v138, 1, v4
  v_lshlrev_b32 v138, 5, v138
  v_add_u32 v137, s47, v137
  v_add_u32 v139, v137, v138
  v_xor_b32 v138, 32, v138
  v_add_u32 v140, v137, v138
  s_waitcnt lgkmcnt(0)
  v_pk_add_f32 v[132:133], v[56:57], v[58:59]
  v_pk_add_f32 v[132:133], v[132:133], v[60:61]
  v_pk_add_f32 v[132:133], v[132:133], v[62:63]
  v_pk_add_f32 v[124:125], v[124:125], v[126:127]
  v_pk_add_f32 v[124:125], v[124:125], v[128:129]
  v_pk_add_f32 v[124:125], v[124:125], v[130:131]
  v_add_f32 v132, v132, v133
  v_add_f32 v124, v124, v125
  v_mul_f32 v132, 0x3e000000, v132
  v_pk_add_f32 v[56:57], v[56:57], v[132:133] op_sel_hi:[1,0] neg_lo:[0,1] neg_hi:[0,1]
  v_pk_add_f32 v[58:59], v[58:59], v[132:133] op_sel_hi:[1,0] neg_lo:[0,1] neg_hi:[0,1]
  v_pk_add_f32 v[60:61], v[60:61], v[132:133] op_sel_hi:[1,0] neg_lo:[0,1] neg_hi:[0,1]
  v_pk_add_f32 v[62:63], v[62:63], v[132:133] op_sel_hi:[1,0] neg_lo:[0,1] neg_hi:[0,1]
  v_pk_mul_f32 v[126:127], v[56:57], v[56:57]
  v_pk_fma_f32 v[126:127], v[58:59], v[58:59], v[126:127]
  v_pk_fma_f32 v[126:127], v[60:61], v[60:61], v[126:127]
  v_pk_fma_f32 v[126:127], v[62:63], v[62:63], v[126:127]
  v_add_f32 v126, v126, v127
  v_mul_f32 v125, 0x3a800000, v124
  v_fmac_f32 v125, 0x3e000000, v126
  v_cvt_pk_bf16_f32 v125, v125, v125
  v_and_b32 v125, 0xffff0000, v125
  v_add_f32 v125, 0x3727c5ac, v125
  v_cvt_pk_bf16_f32 v125, v125, v125
  v_and_b32 v125, 0xffff0000, v125
  v_sqrt_f32 v125, v125
  s_nop 0
  v_cvt_pk_bf16_f32 v125, v125, v125
  v_and_b32 v125, 0xffff0000, v125
  v_rcp_f32 v125, v125
  v_cvt_pk_bf16_f32 v132, v132, v132
  v_and_b32 v132, 0xffff0000, v132
  v_mul_f32 v124, v132, v125
  v_pk_fma_f32 v[24:25], v[24:25], v[124:125], v[124:125] op_sel:[0,1,0] op_sel_hi:[1,1,0]
  v_pk_fma_f32 v[26:27], v[26:27], v[124:125], v[124:125] op_sel:[0,1,0] op_sel_hi:[1,1,0]
  v_pk_fma_f32 v[28:29], v[28:29], v[124:125], v[124:125] op_sel:[0,1,0] op_sel_hi:[1,1,0]
  v_pk_fma_f32 v[30:31], v[30:31], v[124:125], v[124:125] op_sel:[0,1,0] op_sel_hi:[1,1,0]
  v_pk_fma_f32 v[32:33], v[32:33], v[124:125], v[124:125] op_sel:[0,1,0] op_sel_hi:[1,1,0]
  v_pk_fma_f32 v[34:35], v[34:35], v[124:125], v[124:125] op_sel:[0,1,0] op_sel_hi:[1,1,0]
  v_pk_fma_f32 v[36:37], v[36:37], v[124:125], v[124:125] op_sel:[0,1,0] op_sel_hi:[1,1,0]
  v_pk_fma_f32 v[38:39], v[38:39], v[124:125], v[124:125] op_sel:[0,1,0] op_sel_hi:[1,1,0]
  v_pk_fma_f32 v[40:41], v[40:41], v[124:125], v[124:125] op_sel:[0,1,0] op_sel_hi:[1,1,0]
  v_pk_fma_f32 v[42:43], v[42:43], v[124:125], v[124:125] op_sel:[0,1,0] op_sel_hi:[1,1,0]
  v_pk_fma_f32 v[44:45], v[44:45], v[124:125], v[124:125] op_sel:[0,1,0] op_sel_hi:[1,1,0]
  v_pk_fma_f32 v[46:47], v[46:47], v[124:125], v[124:125] op_sel:[0,1,0] op_sel_hi:[1,1,0]
  v_pk_fma_f32 v[48:49], v[48:49], v[124:125], v[124:125] op_sel:[0,1,0] op_sel_hi:[1,1,0]
  v_pk_fma_f32 v[50:51], v[50:51], v[124:125], v[124:125] op_sel:[0,1,0] op_sel_hi:[1,1,0]
  v_pk_fma_f32 v[52:53], v[52:53], v[124:125], v[124:125] op_sel:[0,1,0] op_sel_hi:[1,1,0]
  v_pk_fma_f32 v[54:55], v[54:55], v[124:125], v[124:125] op_sel:[0,1,0] op_sel_hi:[1,1,0]
  s_waitcnt vmcnt(0)
  ds_read_b64_tr_b16 v[144:145], v139 offset:0
  ds_read_b64_tr_b16 v[146:147], v139 offset:256
  ds_read_b64_tr_b16 v[148:149], v140 offset:0
  ds_read_b64_tr_b16 v[150:151], v140 offset:256
  ds_read_b64_tr_b16 v[152:153], v139 offset:8192
  ds_read_b64_tr_b16 v[154:155], v139 offset:8448
  ds_read_b64_tr_b16 v[156:157], v140 offset:8192
  ds_read_b64_tr_b16 v[158:159], v140 offset:8448
  ds_read_b64_tr_b16 v[160:161], v139 offset:2048
  ds_read_b64_tr_b16 v[162:163], v139 offset:2304
  ds_read_b64_tr_b16 v[164:165], v140 offset:2048
  ds_read_b64_tr_b16 v[166:167], v140 offset:2304
  ds_read_b64_tr_b16 v[168:169], v139 offset:10240
  ds_read_b64_tr_b16 v[170:171], v139 offset:10496
  ds_read_b64_tr_b16 v[172:173], v140 offset:10240
  ds_read_b64_tr_b16 v[174:175], v140 offset:10496
  ds_read_b64_tr_b16 v[176:177], v139 offset:4096
  ds_read_b64_tr_b16 v[178:179], v139 offset:4352
  ds_read_b64_tr_b16 v[180:181], v140 offset:4096
  ds_read_b64_tr_b16 v[182:183], v140 offset:4352
  ds_read_b64_tr_b16 v[184:185], v139 offset:12288
  ds_read_b64_tr_b16 v[186:187], v139 offset:12544
  ds_read_b64_tr_b16 v[188:189], v140 offset:12288
  ds_read_b64_tr_b16 v[190:191], v140 offset:12544
  ds_read_b64_tr_b16 v[192:193], v139 offset:6144
  ds_read_b64_tr_b16 v[194:195], v139 offset:6400
  ds_read_b64_tr_b16 v[196:197], v140 offset:6144
  ds_read_b64_tr_b16 v[198:199], v140 offset:6400
  ds_read_b64_tr_b16 v[200:201], v139 offset:14336
  ds_read_b64_tr_b16 v[202:203], v139 offset:14592
  ds_read_b64_tr_b16 v[204:205], v140 offset:14336
  ds_read_b64_tr_b16 v[206:207], v140 offset:14592
  s_mov_b32 s51, 4194304
L_f_poll:
  s_mov_b32 s45, 0
  buffer_load_dwordx4 v[56:59], v6, s[24:27], s45 offen sc1
  s_mov_b32 s45, 24576
  buffer_load_dwordx4 v[60:63], v6, s[24:27], s45 offen sc1
  s_mov_b32 s45, 49152
  buffer_load_dwordx4 v[64:67], v6, s[24:27], s45 offen sc1
  s_mov_b32 s45, 73728
  buffer_load_dwordx4 v[68:71], v6, s[24:27], s45 offen sc1
  s_waitcnt vmcnt(0)
  v_max3_u32 v141, v56, v57, v58
  v_max3_u32 v141, v141, v59, v60
  v_max3_u32 v141, v141, v61, v62
  v_max3_u32 v141, v141, v63, v64
  v_max3_u32 v141, v141, v65, v66
  v_max3_u32 v141, v141, v67, v68
  v_max3_u32 v141, v141, v69, v70
  v_max_u32 v141, v141, v71
  v_cmp_eq_u32 vcc, -1, v141
  s_sub_u32 s51, s51, 1
  s_cbranch_scc1 L_f_ready
  s_cmp_lg_u64 vcc, 0
  s_cbranch_scc1 L_f_poll
L_f_ready:
  s_cmp_ge_u32 s42, 4
  s_cselect_b32 s45, 1.0, 0
  v_add_u32 v6, 131072, v6
  v_pk_add_f32 v[56:57], v[56:57], v[60:61]
  v_pk_add_f32 v[64:65], v[64:65], v[68:69]
  v_pk_add_f32 v[58:59], v[58:59], v[62:63]
  v_pk_add_f32 v[66:67], v[66:67], v[70:71]
  v_pk_add_f32 v[56:57], v[56:57], v[64:65]
  v_pk_add_f32 v[58:59], v[58:59], v[66:67]
  v_cvt_pk_bf16_f32 v56, v56, v56
  v_and_b32 v56, 0xffff0000, v56
  v_cvt_pk_bf16_f32 v57, v57, v57
  v_and_b32 v57, 0xffff0000, v57
  v_cvt_pk_bf16_f32 v58, v58, v58
  v_and_b32 v58, 0xffff0000, v58
  v_cvt_pk_bf16_f32 v59, v59, v59
  v_and_b32 v59, 0xffff0000, v59
  v_add_f32 v56, s45, v56
  v_add_f32 v57, s45, v57
  v_add_f32 v58, s45, v58
  v_add_f32 v59, s45, v59
  v_cvt_pk_bf16_f32 v56, v56, v56
  v_and_b32 v56, 0xffff0000, v56
  v_cvt_pk_bf16_f32 v57, v57, v57
  v_and_b32 v57, 0xffff0000, v57
  v_cvt_pk_bf16_f32 v58, v58, v58
  v_and_b32 v58, 0xffff0000, v58
  v_cvt_pk_bf16_f32 v59, v59, v59
  v_and_b32 v59, 0xffff0000, v59
  ds_write_b128 v6, v[56:59]
  s_lshl_b32 s45, s42, 9
  s_add_u32 s45, s45, 131072
  v_lshl_add_u32 v6, v4, 5, s45
  s_waitcnt lgkmcnt(0)
  s_barrier
  ds_read_b128 v[88:91], v6 offset:0
  ds_read_b128 v[56:59], v6 offset:4096
  ds_read_b128 v[92:95], v6 offset:16
  ds_read_b128 v[60:63], v6 offset:4112
  ds_read_b128 v[96:99], v6 offset:128
  ds_read_b128 v[64:67], v6 offset:4224
  ds_read_b128 v[100:103], v6 offset:144
  ds_read_b128 v[68:71], v6 offset:4240
  ds_read_b128 v[104:107], v6 offset:256
  ds_read_b128 v[72:75], v6 offset:4352
  ds_read_b128 v[108:111], v6 offset:272
  ds_read_b128 v[76:79], v6 offset:4368
  ds_read_b128 v[112:115], v6 offset:384
  ds_read_b128 v[80:83], v6 offset:4480
  ds_read_b128 v[116:119], v6 offset:400
  ds_read_b128 v[84:87], v6 offset:4496
  s_waitcnt lgkmcnt(12)
  v_pk_fma_f32 v[24:25], v[24:25], v[56:57], v[88:89]
  v_pk_fma_f32 v[26:27], v[26:27], v[58:59], v[90:91]
  v_pk_fma_f32 v[28:29], v[28:29], v[60:61], v[92:93]
  v_pk_fma_f32 v[30:31], v[30:31], v[62:63], v[94:95]
  v_cvt_pk_bf16_f32 v8, v24, v25
  v_cvt_pk_bf16_f32 v9, v26, v27
  v_cvt_pk_bf16_f32 v10, v28, v29
  v_cvt_pk_bf16_f32 v11, v30, v31
  s_nop 1
  v_mfma_f32_16x16x32_bf16 v[120:123], v[144:147], v[8:11], 0
  v_mfma_f32_16x16x32_bf16 v[124:127], v[148:151], v[8:11], 0
  v_mfma_f32_16x16x32_bf16 v[128:131], v[8:11], v[152:155], 0
  v_mfma_f32_16x16x32_bf16 v[132:135], v[8:11], v[156:159], 0
  s_waitcnt lgkmcnt(8)
  v_pk_fma_f32 v[32:33], v[32:33], v[64:65], v[96:97]
  v_pk_fma_f32 v[34:35], v[34:35], v[66:67], v[98:99]
  v_pk_fma_f32 v[36:37], v[36:37], v[68:69], v[100:101]
  v_pk_fma_f32 v[38:39], v[38:39], v[70:71], v[102:103]
  v_cvt_pk_bf16_f32 v12, v32, v33
  v_cvt_pk_bf16_f32 v13, v34, v35
  v_cvt_pk_bf16_f32 v14, v36, v37
  v_cvt_pk_bf16_f32 v15, v38, v39
  s_nop 1
  v_mfma_f32_16x16x32_bf16 v[120:123], v[160:163], v[12:15], v[120:123]
  v_mfma_f32_16x16x32_bf16 v[124:127], v[164:167], v[12:15], v[124:127]
  v_mfma_f32_16x16x32_bf16 v[128:131], v[12:15], v[168:171], v[128:131]
  v_mfma_f32_16x16x32_bf16 v[132:135], v[12:15], v[172:175], v[132:135]
  s_waitcnt lgkmcnt(4)
  v_pk_fma_f32 v[40:41], v[40:41], v[72:73], v[104:105]
  v_pk_fma_f32 v[42:43], v[42:43], v[74:75], v[106:107]
  v_pk_fma_f32 v[44:45], v[44:45], v[76:77], v[108:109]
  v_pk_fma_f32 v[46:47], v[46:47], v[78:79], v[110:111]
  v_cvt_pk_bf16_f32 v16, v40, v41
  v_cvt_pk_bf16_f32 v17, v42, v43
  v_cvt_pk_bf16_f32 v18, v44, v45
  v_cvt_pk_bf16_f32 v19, v46, v47
  s_nop 1
  v_mfma_f32_16x16x32_bf16 v[120:123], v[176:179], v[16:19], v[120:123]
  v_mfma_f32_16x16x32_bf16 v[124:127], v[180:183], v[16:19], v[124:127]
  v_mfma_f32_16x16x32_bf16 v[128:131], v[16:19], v[184:187], v[128:131]
  v_mfma_f32_16x16x32_bf16 v[132:135], v[16:19], v[188:191], v[132:135]
  s_waitcnt lgkmcnt(0)
  v_pk_fma_f32 v[48:49], v[48:49], v[80:81], v[112:113]
  v_pk_fma_f32 v[50:51], v[50:51], v[82:83], v[114:115]
  v_pk_fma_f32 v[52:53], v[52:53], v[84:85], v[116:117]
  v_pk_fma_f32 v[54:55], v[54:55], v[86:87], v[118:119]
  v_cvt_pk_bf16_f32 v20, v48, v49
  v_cvt_pk_bf16_f32 v21, v50, v51
  v_cvt_pk_bf16_f32 v22, v52, v53
  v_cvt_pk_bf16_f32 v23, v54, v55
  s_nop 1
  v_mfma_f32_16x16x32_bf16 v[120:123], v[192:195], v[20:23], v[120:123]
  v_mfma_f32_16x16x32_bf16 v[124:127], v[196:199], v[20:23], v[124:127]
  v_mfma_f32_16x16x32_bf16 v[128:131], v[20:23], v[200:203], v[128:131]
  v_mfma_f32_16x16x32_bf16 v[132:135], v[20:23], v[204:207], v[132:135]
  v_add_u32 v137, s47, v136
  s_add_u32 s50, s49, 0
  buffer_store_dwordx4 v[8:11], v136, s[28:31], s50 offen sc0 sc1
  s_add_u32 s50, s49, 8192
  buffer_store_dwordx4 v[12:15], v136, s[28:31], s50 offen sc0 sc1
  s_add_u32 s50, s49, 16384
  buffer_store_dwordx4 v[16:19], v136, s[28:31], s50 offen sc0 sc1
  s_add_u32 s50, s49, 24576
  buffer_store_dwordx4 v[20:23], v136, s[28:31], s50 offen sc0 sc1
  ds_write_b128 v137, v[120:123] offset:0
  ds_write_b128 v137, v[124:127] offset:1024
  ds_write_b128 v137, v[128:131] offset:2048
  ds_write_b128 v137, v[132:135] offset:3072
  s_waitcnt lgkmcnt(0)
  s_barrier
  s_cmp_ge_u32 s42, 2
  s_cbranch_scc1 L_f_end
  s_lshl_b32 s51, s42, 11
  v_add_u32 v137, s51, v136
  v_add_u32 v138, 0x10000, v137
  ds_read_b128 v[24:27], v137 offset:0
  ds_read_b128 v[28:31], v137 offset:1024
  ds_read_b128 v[32:35], v137 offset:16384
  ds_read_b128 v[36:39], v137 offset:17408
  ds_read_b128 v[40:43], v137 offset:32768
  ds_read_b128 v[44:47], v137 offset:33792
  ds_read_b128 v[48:51], v137 offset:49152
  ds_read_b128 v[52:55], v137 offset:50176
  ds_read_b128 v[56:59], v138 offset:0
  ds_read_b128 v[60:63], v138 offset:1024
  ds_read_b128 v[64:67], v138 offset:16384
  ds_read_b128 v[68:71], v138 offset:17408
  ds_read_b128 v[72:75], v138 offset:32768
  ds_read_b128 v[76:79], v138 offset:33792
  ds_read_b128 v[80:83], v138 offset:49152
  ds_read_b128 v[84:87], v138 offset:50176
  s_lshr_b32 s52, s40, 1
  s_lshl_b32 s52, s52, 12
  s_and_b32 s53, s40, 1
  v_and_b32 v137, 1, v4
  v_lshrrev_b32 v138, 1, v4
  v_lshlrev_b32 v138, 9, v138
  v_lshl_add_u32 v138, v3, 4, v138
  s_waitcnt lgkmcnt(12)
  v_pk_add_f32 v[24:25], v[24:25], v[32:33]
  v_pk_add_f32 v[26:27], v[26:27], v[34:35]
  v_pk_add_f32 v[28:29], v[28:29], v[36:37]
  v_pk_add_f32 v[30:31], v[30:31], v[38:39]
  s_waitcnt lgkmcnt(10)
  v_pk_add_f32 v[24:25], v[24:25], v[40:41]
  v_pk_add_f32 v[26:27], v[26:27], v[42:43]
  v_pk_add_f32 v[28:29], v[28:29], v[44:45]
  v_pk_add_f32 v[30:31], v[30:31], v[46:47]
  s_waitcnt lgkmcnt(8)
  v_pk_add_f32 v[24:25], v[24:25], v[48:49]
  v_pk_add_f32 v[26:27], v[26:27], v[50:51]
  v_pk_add_f32 v[28:29], v[28:29], v[52:53]
  v_pk_add_f32 v[30:31], v[30:31], v[54:55]
  s_waitcnt lgkmcnt(6)
  v_pk_add_f32 v[24:25], v[24:25], v[56:57]
  v_pk_add_f32 v[26:27], v[26:27], v[58:59]
  v_pk_add_f32 v[28:29], v[28:29], v[60:61]
  v_pk_add_f32 v[30:31], v[30:31], v[62:63]
  s_waitcnt lgkmcnt(4)
  v_pk_add_f32 v[24:25], v[24:25], v[64:65]
  v_pk_add_f32 v[26:27], v[26:27], v[66:67]
  v_pk_add_f32 v[28:29], v[28:29], v[68:69]
  v_pk_add_f32 v[30:31], v[30:31], v[70:71]
  s_waitcnt lgkmcnt(2)
  v_pk_add_f32 v[24:25], v[24:25], v[72:73]
  v_pk_add_f32 v[26:27], v[26:27], v[74:75]
  v_pk_add_f32 v[28:29], v[28:29], v[76:77]
  v_pk_add_f32 v[30:31], v[30:31], v[78:79]
  s_waitcnt lgkmcnt(0)
  v_pk_add_f32 v[24:25], v[24:25], v[80:81]
  v_pk_add_f32 v[26:27], v[26:27], v[82:83]
  v_pk_add_f32 v[28:29], v[28:29], v[84:85]
  v_pk_add_f32 v[30:31], v[30:31], v[86:87]
  v_cvt_pk_bf16_f32 v120, v24, v25
  v_cvt_pk_bf16_f32 v121, v26, v27
  v_cvt_pk_bf16_f32 v122, v28, v29
  v_cvt_pk_bf16_f32 v123, v30, v31
  s_cmp_eq_u32 s42, 1
  s_cbranch_scc1 L_f_v
  s_lshl_b32 s53, s53, 8
  s_add_u32 s52, s52, s53
  v_lshl_add_u32 v137, v137, 10, v138
  buffer_store_dwordx4 v[120:123], v137, s[32:35], s52 offen sc0 sc1
  s_branch L_f_end
L_f_v:
  s_lshl_b32 s53, s53, 10
  s_add_u32 s52, s52, s53
  v_lshl_add_u32 v137, v137, 3, v138
  buffer_store_dwordx2 v[120:121], v137, s[32:35], s52 offen offset:2048 sc0 sc1
  buffer_store_dwordx2 v[122:123], v137, s[32:35], s52 offen offset:2304 sc0 sc1
L_f_end:
  s_add_u32 s24, s10, 5505024
  s_addc_u32 s25, s11, 0
  s_and_b32 s25, s25, 0xffff
  s_mov_b32 s26, 16384
  s_mov_b32 s27, 0x20000
  v_lshlrev_b32 v3, 4, v2
  v_lshlrev_b32 v5, 5, v2
  v_mov_b32 v6, 0
  v_mov_b32 v7, 1
  s_lshl_b32 s58, s2, 5
  s_waitcnt vmcnt(0) lgkmcnt(0)
  s_barrier
  s_cmp_lg_u32 s42, 4
  s_cbranch_scc1 L_f_nopub
  buffer_store_dword v7, v6, s[24:27], s58 offen sc0 sc1
L_f_nopub:
  s_and_b32 s40, s2, 7
  s_lshr_b32 s3, s2, 3
  s_and_b32 s41, s40, 0
  s_lshl_b32 s41, s41, 4
  s_lshr_b32 s40, s40, 0
  s_lshl_b32 s40, s40, 1
  s_and_b32 s39, s3, 1
  s_or_b32 s40, s40, s39
  s_lshr_b32 s39, s3, 1
  s_or_b32 s41, s41, s39
  s_add_u32 s12, s10, 1048576
  s_addc_u32 s13, s11, 0
  s_and_b32 s13, s13, 0xffff
  s_mov_b32 s14, 4194304
  s_mov_b32 s15, 0x20000
  s_add_u32 s16, s10, 33554432
  s_addc_u32 s17, s11, 0
  s_and_b32 s17, s17, 0xffff
  s_mov_b32 s18, 2097152
  s_mov_b32 s19, 0x20000
  s_add_u32 s20, s10, 5242880
  s_addc_u32 s21, s11, 0
  s_and_b32 s21, s21, 0xffff
  s_mov_b32 s22, 262144
  s_mov_b32 s23, 0x20000
  s_cmp_lt_u32 s42, 4
  s_cbranch_scc1 L_attn_qcomp
  s_load_dwordx2 s[8:9], s[0:1], 48
  s_load_dwordx2 s[6:7], s[0:1], 56
  s_load_dwordx2 s[4:5], s[0:1], 72
  s_load_dwordx2 s[64:65], s[0:1], 0
  s_and_b32 s57, s42, 3
  s_lshl_b32 s57, s57, 14
  s_sub_u32 s43, s42, 4
  s_mul_i32 s45, s40, 262144
  s_mul_i32 s46, s43, 4096
  s_add_u32 s45, s45, s46
  s_mul_i32 s47, s41, 131072
  s_mul_i32 s49, s43, 2048
  s_add_u32 s47, s47, s49
  s_add_u32 s49, s49, 16384
  s_mov_b32 s53, 65536
  s_mov_b32 s62, s45
  s_lshl_b32 s50, s40, 3
  s_add_u32 s50, s50, s41
  s_and_b32 s50, s50, 15
  s_mov_b32 s60, s47
  s_add_u32 s51, s45, 262144
  s_add_u32 s52, s47, 131072
  s_mul_i32 s48, s50, 16384
  s_add_u32 s45, s45, s48
  s_mul_i32 s48, s50, 8192
  s_add_u32 s47, s47, s48
  v_and_b32 v8, 7, v2
  s_lshl_b32 s58, s41, 3
  v_add_u32 v9, s58, v8
  s_and_b32 s58, s40, 1
  s_lshl_b32 s58, s58, 6
  s_lshr_b32 s59, s40, 1
  s_add_u32 s58, s58, s59
  s_add_u32 s58, s58, 128
  v_lshl_add_u32 v8, v8, 3, s58
  v_cmp_gt_u32 vcc, 32, v2
  s_nop 1
  v_cndmask_b32 v8, v8, v9, vcc
  v_lshlrev_b32 v8, 5, v8
  s_mov_b32 s66, 4194304
  s_branch L_pfff
L_pff:
  s_sleep 4
L_pfff:
  buffer_load_dword v28, v8, s[24:27], 0 offen sc1
  s_waitcnt vmcnt(0)
  v_cmp_eq_u32 vcc, 0, v28
  s_sub_u32 s66, s66, 1
  s_cbranch_scc1 L_pffd
  s_cmp_lg_u64 vcc, 0
  s_cbranch_scc1 L_pff
L_pffd:
  s_add_u32 m0, s53, s46
  s_add_u32 s54, s53, s49
  buffer_load_dwordx4 v3, s[12:15], s45 offen offset:0 sc1 lds
  buffer_load_dwordx4 v3, s[12:15], s45 offen offset:1024 sc1 lds
  buffer_load_dwordx4 v3, s[12:15], s45 offen offset:2048 sc1 lds
  buffer_load_dwordx4 v3, s[12:15], s45 offen offset:3072 sc1 lds
  s_mov_b32 m0, s54
  s_add_u32 s45, s45, 16384
  buffer_load_dwordx4 v3, s[16:19], s47 offen offset:0 sc1 lds
  buffer_load_dwordx4 v3, s[16:19], s47 offen offset:1024 sc1 lds
  s_add_u32 s47, s47, 8192
  s_cmp_eq_u32 s45, s51
  s_cselect_b32 s45, s62, s45
  s_cmp_eq_u32 s47, s52
  s_cselect_b32 s47, s60, s47
  s_add_u32 s53, s53, 24576
  s_cmp_eq_u32 s53, 163840
  s_cselect_b32 s53, 65536, s53
  s_add_u32 m0, s53, s46
  s_add_u32 s54, s53, s49
  buffer_load_dwordx4 v3, s[12:15], s45 offen offset:0 sc1 lds
  buffer_load_dwordx4 v3, s[12:15], s45 offen offset:1024 sc1 lds
  buffer_load_dwordx4 v3, s[12:15], s45 offen offset:2048 sc1 lds
  buffer_load_dwordx4 v3, s[12:15], s45 offen offset:3072 sc1 lds
  s_mov_b32 m0, s54
  s_add_u32 s45, s45, 16384
  buffer_load_dwordx4 v3, s[16:19], s47 offen offset:0 sc1 lds
  buffer_load_dwordx4 v3, s[16:19], s47 offen offset:1024 sc1 lds
  s_add_u32 s47, s47, 8192
  s_cmp_eq_u32 s45, s51
  s_cselect_b32 s45, s62, s45
  s_cmp_eq_u32 s47, s52
  s_cselect_b32 s47, s60, s47
  s_add_u32 s53, s53, 24576
  s_cmp_eq_u32 s53, 163840
  s_cselect_b32 s53, 65536, s53
  s_waitcnt vmcnt(6)
  s_barrier
  s_add_u32 m0, s53, s46
  s_add_u32 s54, s53, s49
  buffer_load_dwordx4 v3, s[12:15], s45 offen offset:0 sc1 lds
  buffer_load_dwordx4 v3, s[12:15], s45 offen offset:1024 sc1 lds
  buffer_load_dwordx4 v3, s[12:15], s45 offen offset:2048 sc1 lds
  buffer_load_dwordx4 v3, s[12:15], s45 offen offset:3072 sc1 lds
  s_mov_b32 m0, s54
  s_add_u32 s45, s45, 16384
  buffer_load_dwordx4 v3, s[16:19], s47 offen offset:0 sc1 lds
  buffer_load_dwordx4 v3, s[16:19], s47 offen offset:1024 sc1 lds
  s_add_u32 s47, s47, 8192
  s_cmp_eq_u32 s45, s51
  s_cselect_b32 s45, s62, s45
  s_cmp_eq_u32 s47, s52
  s_cselect_b32 s47, s60, s47
  s_add_u32 s53, s53, 24576
  s_cmp_eq_u32 s53, 163840
  s_cselect_b32 s53, 65536, s53
  s_add_u32 m0, s53, s46
  s_add_u32 s54, s53, s49
  buffer_load_dwordx4 v3, s[12:15], s45 offen offset:0 sc1 lds
  buffer_load_dwordx4 v3, s[12:15], s45 offen offset:1024 sc1 lds
  buffer_load_dwordx4 v3, s[12:15], s45 offen offset:2048 sc1 lds
  buffer_load_dwordx4 v3, s[12:15], s45 offen offset:3072 sc1 lds
  s_mov_b32 m0, s54
  s_add_u32 s45, s45, 16384
  buffer_load_dwordx4 v3, s[16:19], s47 offen offset:0 sc1 lds
  buffer_load_dwordx4 v3, s[16:19], s47 offen offset:1024 sc1 lds
  s_add_u32 s47, s47, 8192
  s_cmp_eq_u32 s45, s51
  s_cselect_b32 s45, s62, s45
  s_cmp_eq_u32 s47, s52
  s_cselect_b32 s47, s60, s47
  s_add_u32 s53, s53, 24576
  s_cmp_eq_u32 s53, 163840
  s_cselect_b32 s53, 65536, s53
  s_mov_b32 s56, 12
L_attnq_lloop:
  s_waitcnt vmcnt(12)
  s_barrier
  s_add_u32 m0, s53, s46
  s_add_u32 s54, s53, s49
  buffer_load_dwordx4 v3, s[12:15], s45 offen offset:0 sc1 lds
  buffer_load_dwordx4 v3, s[12:15], s45 offen offset:1024 sc1 lds
  buffer_load_dwordx4 v3, s[12:15], s45 offen offset:2048 sc1 lds
  buffer_load_dwordx4 v3, s[12:15], s45 offen offset:3072 sc1 lds
  s_mov_b32 m0, s54
  s_add_u32 s45, s45, 16384
  buffer_load_dwordx4 v3, s[16:19], s47 offen offset:0 sc1 lds
  buffer_load_dwordx4 v3, s[16:19], s47 offen offset:1024 sc1 lds
  s_add_u32 s47, s47, 8192
  s_cmp_eq_u32 s45, s51
  s_cselect_b32 s45, s62, s45
  s_cmp_eq_u32 s47, s52
  s_cselect_b32 s47, s60, s47
  s_add_u32 s53, s53, 24576
  s_cmp_eq_u32 s53, 163840
  s_cselect_b32 s53, 65536, s53
  s_sub_u32 s56, s56, 1
  s_cmp_lg_u32 s56, 0
  s_cbranch_scc1 L_attnq_lloop
  s_waitcnt vmcnt(12)
  s_barrier
  s_mov_b32 s58, 0
  buffer_load_dword v28, v5, s[24:27], s58 offen sc1
  s_mov_b32 s58, 2048
  buffer_load_dword v29, v5, s[24:27], s58 offen sc1
  s_mov_b32 s58, 4096
  buffer_load_dword v30, v5, s[24:27], s58 offen sc1
  s_mov_b32 s58, 6144
  buffer_load_dword v31, v5, s[24:27], s58 offen sc1
  s_waitcnt vmcnt(10)
  s_barrier
  s_waitcnt vmcnt(4)
  s_barrier
  s_waitcnt vmcnt(0)
  v_min3_u32 v28, v28, v29, v30
  v_min_u32 v28, v28, v31
  v_cmp_eq_u32 vcc, 0, v28
  s_nop 0
  s_cmp_eq_u64 vcc, 0
  s_cbranch_scc1 L_pkvd
  s_mov_b32 s66, 4194304
L_pkv:
  s_mov_b32 s58, 0
  buffer_load_dword v28, v5, s[24:27], s58 offen sc1
  s_mov_b32 s58, 2048
  buffer_load_dword v29, v5, s[24:27], s58 offen sc1
  s_mov_b32 s58, 4096
  buffer_load_dword v30, v5, s[24:27], s58 offen sc1
  s_mov_b32 s58, 6144
  buffer_load_dword v31, v5, s[24:27], s58 offen sc1
  s_waitcnt vmcnt(0)
  v_min3_u32 v28, v28, v29, v30
  v_min_u32 v28, v28, v31
  v_cmp_eq_u32 vcc, 0, v28
  s_sub_u32 s66, s66, 1
  s_cbranch_scc1 L_pkvd
  s_cmp_lg_u64 vcc, 0
  s_cbranch_scc1 L_pkv
L_pkvd:
  s_add_u32 m0, s57, 0
  s_add_u32 s59, s57, 0
  buffer_load_dwordx4 v3, s[20:23], s59 offen offset:0 sc1 lds
  buffer_load_dwordx4 v3, s[20:23], s59 offen offset:1024 sc1 lds
  buffer_load_dwordx4 v3, s[20:23], s59 offen offset:2048 sc1 lds
  buffer_load_dwordx4 v3, s[20:23], s59 offen offset:3072 sc1 lds
  s_waitcnt vmcnt(8)
  s_barrier
  s_add_u32 m0, s57, 4096
  s_add_u32 s59, s57, 4096
  buffer_load_dwordx4 v3, s[20:23], s59 offen offset:0 sc1 lds
  buffer_load_dwordx4 v3, s[20:23], s59 offen offset:1024 sc1 lds
  buffer_load_dwordx4 v3, s[20:23], s59 offen offset:2048 sc1 lds
  buffer_load_dwordx4 v3, s[20:23], s59 offen offset:3072 sc1 lds
  s_add_u32 m0, s57, 8192
  s_add_u32 s59, s57, 8192
  buffer_load_dwordx4 v3, s[20:23], s59 offen offset:0 sc1 lds
  buffer_load_dwordx4 v3, s[20:23], s59 offen offset:1024 sc1 lds
  buffer_load_dwordx4 v3, s[20:23], s59 offen offset:2048 sc1 lds
  buffer_load_dwordx4 v3, s[20:23], s59 offen offset:3072 sc1 lds
  s_add_u32 m0, s57, 12288
  s_add_u32 s59, s57, 12288
  buffer_load_dwordx4 v3, s[20:23], s59 offen offset:0 sc1 lds
  buffer_load_dwordx4 v3, s[20:23], s59 offen offset:1024 sc1 lds
  buffer_load_dwordx4 v3, s[20:23], s59 offen offset:2048 sc1 lds
  buffer_load_dwordx4 v3, s[20:23], s59 offen offset:3072 sc1 lds
  s_setprio 3
  s_waitcnt vmcnt(0) lgkmcnt(0)
  s_barrier
  s_mov_b32 s32, s8
  s_and_b32 s33, s9, 0xffff
  s_mov_b32 s34, 7340032
  s_mov_b32 s35, 0x20000
  s_mov_b32 s36, s6
  s_and_b32 s37, s7, 0xffff
  s_mov_b32 s38, 7340032
  s_mov_b32 s39, 0x20000
  s_mov_b32 s4, s4
  s_and_b32 s5, s5, 0xffff
  s_mov_b32 s6, 12582912
  s_mov_b32 s7, 0x20000
  s_mov_b32 s64, s64
  s_and_b32 s65, s65, 0xffff
  s_mov_b32 s66, 4194304
  s_mov_b32 s67, 0x20000
  s_add_u32 s12, s10, 37748736
  s_addc_u32 s13, s11, 0
  s_and_b32 s13, s13, 0xffff
  s_mov_b32 s14, 7340032
  s_mov_b32 s15, 0x20000
  s_add_u32 s16, s10, 45088768
  s_addc_u32 s17, s11, 0
  s_and_b32 s17, s17, 0xffff
  s_mov_b32 s18, 7340032
  s_mov_b32 s19, 0x20000
  s_add_u32 s28, s10, 0
  s_addc_u32 s29, s11, 0
  s_and_b32 s29, s29, 0xffff
  s_mov_b32 s30, 57540608
  s_mov_b32 s31, 0x20000
  v_lshrrev_b32 v4, 3, v2
  s_mov_b32 s47, 2048
  v_mul_lo_u32 v4, v4, s47
  v_and_b32 v6, 7, v2
  v_lshl_add_u32 v4, v6, 4, v4
  v_bfe_u32 v5, v2, 2, 2
  v_bfe_u32 v6, v2, 4, 1
  v_lshl_add_u32 v5, v6, 2, v5
  v_lshrrev_b32 v6, 5, v2
  v_lshl_add_u32 v5, v6, 3, v5
  v_lshlrev_b32 v5, 7, v5
  v_and_b32 v6, 3, v2
  v_lshl_add_u32 v5, v6, 3, v5
  v_add_u32 v5, 131072, v5
  v_lshrrev_b32 v7, 3, v2
  v_mul_u32_u24 v11, 12288, v7
  v_mul_u32_u24 v7, 7168, v7
  v_and_b32 v6, 7, v2
  v_lshl_add_u32 v7, v6, 4, v7
  v_lshl_add_u32 v11, v6, 4, v11
  v_lshlrev_b32 v8, 7, v2
  v_lshrrev_b32 v13, 4, v2
  v_lshl_add_u32 v12, v13, 9, v5
  v_lshlrev_b32 v15, 3, v13
  s_mul_i32 s45, s2, 7
  s_and_b32 s54, s2, 15
  s_lshl_b32 s54, s54, 2
  s_add_u32 s54, s54, s43
  s_lshr_b32 s55, s2, 4
  s_add_u32 m0, s57, 65536
  s_add_u32 s59, s57, 65536
  buffer_load_dwordx4 v3, s[20:23], s59 offen offset:0 sc1 lds
  buffer_load_dwordx4 v3, s[20:23], s59 offen offset:1024 sc1 lds
  buffer_load_dwordx4 v3, s[20:23], s59 offen offset:2048 sc1 lds
  buffer_load_dwordx4 v3, s[20:23], s59 offen offset:3072 sc1 lds
  s_add_u32 m0, s57, 69632
  s_add_u32 s59, s57, 69632
  buffer_load_dwordx4 v3, s[20:23], s59 offen offset:0 sc1 lds
  buffer_load_dwordx4 v3, s[20:23], s59 offen offset:1024 sc1 lds
  buffer_load_dwordx4 v3, s[20:23], s59 offen offset:2048 sc1 lds
  buffer_load_dwordx4 v3, s[20:23], s59 offen offset:3072 sc1 lds
  s_add_u32 m0, s57, 73728
  s_add_u32 s59, s57, 73728
  buffer_load_dwordx4 v3, s[20:23], s59 offen offset:0 sc1 lds
  buffer_load_dwordx4 v3, s[20:23], s59 offen offset:1024 sc1 lds
  buffer_load_dwordx4 v3, s[20:23], s59 offen offset:2048 sc1 lds
  buffer_load_dwordx4 v3, s[20:23], s59 offen offset:3072 sc1 lds
  s_add_u32 m0, s57, 77824
  s_add_u32 s59, s57, 77824
  buffer_load_dwordx4 v3, s[20:23], s59 offen offset:0 sc1 lds
  buffer_load_dwordx4 v3, s[20:23], s59 offen offset:1024 sc1 lds
  buffer_load_dwordx4 v3, s[20:23], s59 offen offset:2048 sc1 lds
  buffer_load_dwordx4 v3, s[20:23], s59 offen offset:3072 sc1 lds
  s_mul_i32 s46, s41, 131072
  s_mul_i32 s48, s43, 2048
  s_add_u32 s46, s46, s48
  s_add_u32 s46, s46, 35651584
  s_mov_b32 s50, 0
  s_add_u32 s47, s50, 0
  s_and_b32 s47, s47, 15
  s_mul_i32 s47, s47, 8192
  s_add_u32 s47, s47, s46
  buffer_load_dwordx4 v[100:103], v3, s[28:31], s47 offen offset:0 sc1
  buffer_load_dwordx4 v[104:107], v3, s[28:31], s47 offen offset:1024 sc1
  s_add_u32 s47, s50, 1
  s_and_b32 s47, s47, 15
  s_mul_i32 s47, s47, 8192
  s_add_u32 s47, s47, s46
  buffer_load_dwordx4 v[108:111], v3, s[28:31], s47 offen offset:0 sc1
  buffer_load_dwordx4 v[112:115], v3, s[28:31], s47 offen offset:1024 sc1
  s_add_u32 s47, s50, 2
  s_and_b32 s47, s47, 15
  s_mul_i32 s47, s47, 8192
  s_add_u32 s47, s47, s46
  buffer_load_dwordx4 v[116:119], v3, s[28:31], s47 offen offset:0 sc1
  buffer_load_dwordx4 v[120:123], v3, s[28:31], s47 offen offset:1024 sc1
  s_add_u32 s47, s50, 3
  s_and_b32 s47, s47, 15
  s_mul_i32 s47, s47, 8192
  s_add_u32 s47, s47, s46
  buffer_load_dwordx4 v[124:127], v3, s[28:31], s47 offen offset:0 sc1
  buffer_load_dwordx4 v[128:131], v3, s[28:31], s47 offen offset:1024 sc1
  s_add_u32 s47, s50, 4
  s_and_b32 s47, s47, 15
  s_mul_i32 s47, s47, 8192
  s_add_u32 s47, s47, s46
  buffer_load_dwordx4 v[132:135], v3, s[28:31], s47 offen offset:0 sc1
  buffer_load_dwordx4 v[136:139], v3, s[28:31], s47 offen offset:1024 sc1
  s_add_u32 s47, s50, 5
  s_and_b32 s47, s47, 15
  s_mul_i32 s47, s47, 8192
  s_add_u32 s47, s47, s46
  buffer_load_dwordx4 v[140:143], v3, s[28:31], s47 offen offset:0 sc1
  buffer_load_dwordx4 v[144:147], v3, s[28:31], s47 offen offset:1024 sc1
  s_add_u32 s47, s50, 6
  s_and_b32 s47, s47, 15
  s_mul_i32 s47, s47, 8192
  s_add_u32 s47, s47, s46
  buffer_load_dwordx4 v[148:151], v3, s[28:31], s47 offen offset:0 sc1
  buffer_load_dwordx4 v[152:155], v3, s[28:31], s47 offen offset:1024 sc1
  s_add_u32 s47, s50, 7
  s_and_b32 s47, s47, 15
  s_mul_i32 s47, s47, 8192
  s_add_u32 s47, s47, s46
  buffer_load_dwordx4 v[156:159], v3, s[28:31], s47 offen offset:0 sc1
  buffer_load_dwordx4 v[160:163], v3, s[28:31], s47 offen offset:1024 sc1
  s_lshl_b32 s47, s54, 7
  s_add_u32 s47, s47, 4096
  s_lshl_b32 s48, s55, 1
  s_lshl_b32 s49, s48, 6
  s_add_u32 s49, s49, 196608
  s_mul_i32 s48, s48, 393216
  s_add_u32 s47, s47, s48
  s_lshl_b32 s46, s43, 12
  v_add_u32 v10, s46, v5
  s_add_u32 s46, s46, 131072
  s_add_u32 m0, s46, 0
  s_add_u32 s48, s47, 0
  buffer_load_dwordx4 v11, s[4:7], s48 offen lds
  s_add_u32 m0, s46, 1024
  s_add_u32 s48, s47, 98304
  buffer_load_dwordx4 v11, s[4:7], s48 offen lds
  s_add_u32 m0, s46, 2048
  s_add_u32 s48, s47, 196608
  buffer_load_dwordx4 v11, s[4:7], s48 offen lds
  s_add_u32 m0, s46, 3072
  s_add_u32 s48, s47, 294912
  buffer_load_dwordx4 v11, s[4:7], s48 offen lds
  s_add_u32 s47, s47, 393216
  s_add_u32 s46, s46, 16384
  s_add_u32 m0, s46, 0
  s_add_u32 s48, s47, 0
  buffer_load_dwordx4 v11, s[4:7], s48 offen lds
  s_add_u32 m0, s46, 1024
  s_add_u32 s48, s47, 98304
  buffer_load_dwordx4 v11, s[4:7], s48 offen lds
  s_add_u32 m0, s46, 2048
  s_add_u32 s48, s47, 196608
  buffer_load_dwordx4 v11, s[4:7], s48 offen lds
  s_add_u32 m0, s46, 3072
  s_add_u32 s48, s47, 294912
  buffer_load_dwordx4 v11, s[4:7], s48 offen lds
  buffer_load_dwordx2 v[48:49], v15, s[28:31], s49 offen offset:0 sc1
  buffer_load_dwordx2 v[50:51], v15, s[28:31], s49 offen offset:32 sc1
  buffer_load_dwordx2 v[52:53], v15, s[28:31], s49 offen offset:64 sc1
  buffer_load_dwordx2 v[54:55], v15, s[28:31], s49 offen offset:96 sc1
  v_mov_b32 v84, -1
  v_mov_b32 v85, -1
  v_mov_b32 v86, -1
  v_mov_b32 v87, -1
  s_lshl_b32 s47, s2, 11
  s_lshl_b32 s48, s43, 9
  s_add_u32 s47, s47, s48
  s_lshr_b32 s48, s47, 1
  s_add_u32 s48, s48, 5767168
  v_lshlrev_b32 v9, 2, v2
  v_mov_b32 v88, 0
  buffer_store_dword v88, v9, s[28:31], s48 offen sc0 sc1
  s_waitcnt vmcnt(13)
  s_barrier
  s_waitcnt vmcnt(0)
  s_add_u32 m0, s57, 0
  s_add_u32 s59, s57, 131072
  buffer_load_dwordx4 v3, s[20:23], s59 offen offset:0 sc1 lds
  buffer_load_dwordx4 v3, s[20:23], s59 offen offset:1024 sc1 lds
  buffer_load_dwordx4 v3, s[20:23], s59 offen offset:2048 sc1 lds
  buffer_load_dwordx4 v3, s[20:23], s59 offen offset:3072 sc1 lds
  s_add_u32 m0, s57, 4096
  s_add_u32 s59, s57, 135168
  buffer_load_dwordx4 v3, s[20:23], s59 offen offset:0 sc1 lds
  buffer_load_dwordx4 v3, s[20:23], s59 offen offset:1024 sc1 lds
  buffer_load_dwordx4 v3, s[20:23], s59 offen offset:2048 sc1 lds
  buffer_load_dwordx4 v3, s[20:23], s59 offen offset:3072 sc1 lds
  s_add_u32 m0, s57, 8192
  s_add_u32 s59, s57, 139264
  buffer_load_dwordx4 v3, s[20:23], s59 offen offset:0 sc1 lds
  buffer_load_dwordx4 v3, s[20:23], s59 offen offset:1024 sc1 lds
  buffer_load_dwordx4 v3, s[20:23], s59 offen offset:2048 sc1 lds
  buffer_load_dwordx4 v3, s[20:23], s59 offen offset:3072 sc1 lds
  s_add_u32 m0, s57, 12288
  s_add_u32 s59, s57, 143360
  buffer_load_dwordx4 v3, s[20:23], s59 offen offset:0 sc1 lds
  buffer_load_dwordx4 v3, s[20:23], s59 offen offset:1024 sc1 lds
  buffer_load_dwordx4 v3, s[20:23], s59 offen offset:2048 sc1 lds
  buffer_load_dwordx4 v3, s[20:23], s59 offen offset:3072 sc1 lds
  s_mul_i32 s46, s41, 131072
  s_mul_i32 s48, s43, 2048
  s_add_u32 s46, s46, s48
  s_add_u32 s46, s46, 35651584
  s_mov_b32 s50, 0
  s_add_u32 s47, s50, 8
  s_and_b32 s47, s47, 15
  s_mul_i32 s47, s47, 8192
  s_add_u32 s47, s47, s46
  buffer_load_dwordx4 v[164:167], v3, s[28:31], s47 offen offset:0 sc1
  buffer_load_dwordx4 v[168:171], v3, s[28:31], s47 offen offset:1024 sc1
  s_add_u32 s47, s50, 9
  s_and_b32 s47, s47, 15
  s_mul_i32 s47, s47, 8192
  s_add_u32 s47, s47, s46
  buffer_load_dwordx4 v[172:175], v3, s[28:31], s47 offen offset:0 sc1
  buffer_load_dwordx4 v[176:179], v3, s[28:31], s47 offen offset:1024 sc1
  s_add_u32 s47, s50, 10
  s_and_b32 s47, s47, 15
  s_mul_i32 s47, s47, 8192
  s_add_u32 s47, s47, s46
  buffer_load_dwordx4 v[180:183], v3, s[28:31], s47 offen offset:0 sc1
  buffer_load_dwordx4 v[184:187], v3, s[28:31], s47 offen offset:1024 sc1
  s_add_u32 s47, s50, 11
  s_and_b32 s47, s47, 15
  s_mul_i32 s47, s47, 8192
  s_add_u32 s47, s47, s46
  buffer_load_dwordx4 v[188:191], v3, s[28:31], s47 offen offset:0 sc1
  buffer_load_dwordx4 v[192:195], v3, s[28:31], s47 offen offset:1024 sc1
  s_add_u32 s47, s50, 12
  s_and_b32 s47, s47, 15
  s_mul_i32 s47, s47, 8192
  s_add_u32 s47, s47, s46
  buffer_load_dwordx4 v[196:199], v3, s[28:31], s47 offen offset:0 sc1
  buffer_load_dwordx4 v[200:203], v3, s[28:31], s47 offen offset:1024 sc1
  s_add_u32 s47, s50, 13
  s_and_b32 s47, s47, 15
  s_mul_i32 s47, s47, 8192
  s_add_u32 s47, s47, s46
  buffer_load_dwordx4 v[204:207], v3, s[28:31], s47 offen offset:0 sc1
  buffer_load_dwordx4 v[208:211], v3, s[28:31], s47 offen offset:1024 sc1
  s_add_u32 s47, s50, 14
  s_and_b32 s47, s47, 15
  s_mul_i32 s47, s47, 8192
  s_add_u32 s47, s47, s46
  buffer_load_dwordx4 v[212:215], v3, s[28:31], s47 offen offset:0 sc1
  buffer_load_dwordx4 v[216:219], v3, s[28:31], s47 offen offset:1024 sc1
  s_add_u32 s47, s50, 15
  s_and_b32 s47, s47, 15
  s_mul_i32 s47, s47, 8192
  s_add_u32 s47, s47, s46
  buffer_load_dwordx4 v[220:223], v3, s[28:31], s47 offen offset:0 sc1
  buffer_load_dwordx4 v[224:227], v3, s[28:31], s47 offen offset:1024 sc1
  ds_read_b64_tr_b16 v[16:17], v10 offset:0
  ds_read_b64_tr_b16 v[18:19], v10 offset:2048
  ds_read_b64_tr_b16 v[20:21], v10 offset:32
  ds_read_b64_tr_b16 v[22:23], v10 offset:2080
  ds_read_b64_tr_b16 v[24:25], v10 offset:64
  ds_read_b64_tr_b16 v[26:27], v10 offset:2112
  ds_read_b64_tr_b16 v[28:29], v10 offset:96
  ds_read_b64_tr_b16 v[30:31], v10 offset:2144
  v_add_u32 v10, 16384, v10
  ds_read_b64_tr_b16 v[32:33], v10 offset:0
  ds_read_b64_tr_b16 v[34:35], v10 offset:2048
  ds_read_b64_tr_b16 v[36:37], v10 offset:32
  ds_read_b64_tr_b16 v[38:39], v10 offset:2080
  ds_read_b64_tr_b16 v[40:41], v10 offset:64
  ds_read_b64_tr_b16 v[42:43], v10 offset:2112
  ds_read_b64_tr_b16 v[44:45], v10 offset:96
  ds_read_b64_tr_b16 v[46:47], v10 offset:2144
  s_lshl_b32 s47, s55, 14
  s_lshl_b32 s48, s54, 8
  s_add_u32 s47, s47, s48
  s_add_u32 s47, s47, 262144
  v_lshlrev_b32 v15, 1, v15
  s_waitcnt lgkmcnt(0)
  v_mfma_f32_16x16x32_bf16 v[64:67], v[16:19], v[48:51], 0
  v_mfma_f32_16x16x32_bf16 v[68:71], v[20:23], v[48:51], 0
  v_mfma_f32_16x16x32_bf16 v[72:75], v[24:27], v[48:51], 0
  v_mfma_f32_16x16x32_bf16 v[76:79], v[28:31], v[48:51], 0
  v_mfma_f32_16x16x32_bf16 v[64:67], v[32:35], v[52:55], v[64:67]
  v_mfma_f32_16x16x32_bf16 v[68:71], v[36:39], v[52:55], v[68:71]
  v_mfma_f32_16x16x32_bf16 v[72:75], v[40:43], v[52:55], v[72:75]
  v_mfma_f32_16x16x32_bf16 v[76:79], v[44:47], v[52:55], v[76:79]
  s_nop 7
  buffer_store_dwordx4 v[64:67], v15, s[28:31], s47 offen offset:0 sc0 sc1
  buffer_store_dwordx4 v[68:71], v15, s[28:31], s47 offen offset:64 sc0 sc1
  buffer_store_dwordx4 v[72:75], v15, s[28:31], s47 offen offset:128 sc0 sc1
  buffer_store_dwordx4 v[76:79], v15, s[28:31], s47 offen offset:192 sc0 sc1
  s_lshl_b32 s47, s40, 18
  s_lshl_b32 s48, s41, 14
  s_add_u32 s47, s47, s48
  s_lshl_b32 s48, s43, 12
  s_add_u32 s47, s47, s48
  s_add_u32 s47, s47, 6291456
  s_cmp_ge_u32 s41, 7
  s_cselect_b32 s47, 0x40000000, s47
  buffer_store_dwordx4 v[84:87], v3, s[28:31], s47 offen offset:0 sc0 sc1
  buffer_store_dwordx4 v[84:87], v3, s[28:31], s47 offen offset:1024 sc0 sc1
  buffer_store_dwordx4 v[84:87], v3, s[28:31], s47 offen offset:2048 sc0 sc1
  buffer_store_dwordx4 v[84:87], v3, s[28:31], s47 offen offset:3072 sc0 sc1
  s_lshr_b32 s47, s2, 4
  s_lshl_b32 s47, s47, 18
  s_and_b32 s48, s2, 15
  s_lshl_b32 s48, s48, 2
  s_add_u32 s48, s48, s43
  s_mul_i32 s48, s48, 2048
  s_add_u32 s47, s47, s48
  s_add_u32 s47, s47, 14680064
  s_lshr_b32 s49, s2, 3
  s_mul_i32 s49, s49, 458752
  s_and_b32 s48, s2, 7
  s_lshl_b32 s48, s48, 2
  s_add_u32 s48, s48, s43
  s_mul_i32 s48, s48, 4096
  s_add_u32 s49, s49, s48
  s_add_u32 s49, s49, 18874368
  buffer_store_dwordx4 v[84:87], v3, s[28:31], s47 offen offset:0 sc0 sc1
  buffer_store_dwordx4 v[84:87], v3, s[28:31], s47 offen offset:1024 sc0 sc1
  s_waitcnt vmcnt(0)
  s_mov_b32 s56, s43
L_attn_sw2i:
  s_add_u32 s52, s45, s56
  s_lshl_b32 s53, s56, 12
  s_lshr_b32 s47, s52, 4
  s_lshl_b32 s47, s47, 16
  s_and_b32 s48, s52, 15
  s_lshl_b32 s48, s48, 7
  s_add_u32 s47, s47, s48
  s_add_u32 s46, s53, 131072
  s_add_u32 m0, s46, 0
  s_add_u32 s48, s47, 0
  buffer_load_dwordx4 v4, s[36:39], s48 offen lds
  s_add_u32 m0, s46, 1024
  s_add_u32 s48, s47, 16384
  buffer_load_dwordx4 v4, s[36:39], s48 offen lds
  s_add_u32 m0, s46, 2048
  s_add_u32 s48, s47, 32768
  buffer_load_dwordx4 v4, s[36:39], s48 offen lds
  s_add_u32 m0, s46, 3072
  s_add_u32 s48, s47, 49152
  buffer_load_dwordx4 v4, s[36:39], s48 offen lds
  s_add_u32 s56, s56, 4
  s_cmp_lt_u32 s56, 7
  s_cbranch_scc1 L_attn_sw2i
  s_lshr_b32 s50, s2, 3
  s_lshl_b32 s50, s50, 2
  s_add_u32 s50, s50, s43
  s_lshl_b32 s51, s50, 14
  s_add_u32 s51, s51, 35651584
  s_lshl_b32 s50, s50, 12
  s_and_b32 s49, s2, 7
  s_lshl_b32 s49, s49, 19
  s_add_u32 s50, s50, s49
  v_lshlrev_b32 v9, 6, v2
  buffer_load_dword v14, v9, s[64:67], s50 offen
  s_barrier
  s_waitcnt vmcnt(0)
  s_cmp_lg_u32 s43, 0
  s_cbranch_scc1 L_attn_nosva
  s_lshl_b32 s58, s2, 5
  s_add_u32 s58, s58, 5513216
  v_mov_b32 v9, 0
  v_mov_b32 v10, 1
  buffer_store_dword v10, v9, s[28:31], s58 offen sc0 sc1
L_attn_nosva:
  s_add_u32 m0, s57, 65536
  s_add_u32 s59, s57, 196608
  buffer_load_dwordx4 v3, s[20:23], s59 offen offset:0 sc1 lds
  buffer_load_dwordx4 v3, s[20:23], s59 offen offset:1024 sc1 lds
  buffer_load_dwordx4 v3, s[20:23], s59 offen offset:2048 sc1 lds
  buffer_load_dwordx4 v3, s[20:23], s59 offen offset:3072 sc1 lds
  s_add_u32 m0, s57, 69632
  s_add_u32 s59, s57, 200704
  buffer_load_dwordx4 v3, s[20:23], s59 offen offset:0 sc1 lds
  buffer_load_dwordx4 v3, s[20:23], s59 offen offset:1024 sc1 lds
  buffer_load_dwordx4 v3, s[20:23], s59 offen offset:2048 sc1 lds
  buffer_load_dwordx4 v3, s[20:23], s59 offen offset:3072 sc1 lds
  s_add_u32 m0, s57, 73728
  s_add_u32 s59, s57, 204800
  buffer_load_dwordx4 v3, s[20:23], s59 offen offset:0 sc1 lds
  buffer_load_dwordx4 v3, s[20:23], s59 offen offset:1024 sc1 lds
  buffer_load_dwordx4 v3, s[20:23], s59 offen offset:2048 sc1 lds
  buffer_load_dwordx4 v3, s[20:23], s59 offen offset:3072 sc1 lds
  s_add_u32 m0, s57, 77824
  s_add_u32 s59, s57, 208896
  buffer_load_dwordx4 v3, s[20:23], s59 offen offset:0 sc1 lds
  buffer_load_dwordx4 v3, s[20:23], s59 offen offset:1024 sc1 lds
  buffer_load_dwordx4 v3, s[20:23], s59 offen offset:2048 sc1 lds
  buffer_load_dwordx4 v3, s[20:23], s59 offen offset:3072 sc1 lds
  s_waitcnt vmcnt(0)
  s_mov_b32 s56, s43
L_attn_sw2o:
  s_add_u32 s52, s45, s56
  s_lshl_b32 s53, s56, 12
  s_lshr_b32 s48, s52, 4
  s_mul_i32 s49, s48, 9363
  s_lshr_b32 s49, s49, 16
  s_mul_i32 s50, s49, 7
  s_sub_u32 s48, s48, s50
  s_cmp_eq_u32 s48, 6
  s_cselect_b64 vcc, -1, 0
  s_cselect_b32 s51, 4, 16
  s_lshl_b32 s51, s51, 7
  v_cndmask_b32 v10, v5, v12, vcc
  v_add_u32 v10, s53, v10
  v_add_u32 v9, s51, v10
  ds_read_b64_tr_b16 v[16:17], v10 offset:0
  ds_read_b64_tr_b16 v[18:19], v9 offset:0
  ds_read_b64_tr_b16 v[20:21], v10 offset:32
  ds_read_b64_tr_b16 v[22:23], v9 offset:32
  ds_read_b64_tr_b16 v[24:25], v10 offset:64
  ds_read_b64_tr_b16 v[26:27], v9 offset:64
  ds_read_b64_tr_b16 v[28:29], v10 offset:96
  ds_read_b64_tr_b16 v[30:31], v9 offset:96
  s_and_b32 s50, s49, 7
  s_lshr_b32 s49, s49, 3
  s_cmp_ge_u32 s48, 3
  s_cselect_b32 s51, -47, 0
  s_lshl_b32 s47, s48, 4
  s_add_u32 s47, s47, s51
  s_cmp_ge_u32 s47, 16
  s_cselect_b32 s51, 8, 0
  s_add_u32 s47, s47, s51
  s_add_u32 s47, s47, s50
  s_cmp_eq_u32 s48, 6
  s_cselect_b32 s47, 16, s47
  s_add_u32 s47, s47, s50
  s_mul_i32 s50, s49, 56
  s_add_u32 s47, s47, s50
  s_bfe_u32 s50, s52, 0x30001
  s_mul_i32 s50, s50, 112
  s_add_u32 s47, s47, s50
  s_lshl_b32 s47, s47, 13
  s_and_b32 s50, s52, 1
  s_lshl_b32 s50, s50, 12
  s_add_u32 s47, s47, s50
  s_lshl_b32 s49, s49, 11
  s_add_u32 s47, s47, s49
  s_xor_b32 s48, s47, 2048
  s_waitcnt lgkmcnt(0)
  buffer_store_dwordx4 v[16:19], v3, s[16:19], s47 offen offset:0 sc0 sc1
  buffer_store_dwordx4 v[20:23], v3, s[16:19], s47 offen offset:1024 sc0 sc1
  buffer_store_dwordx4 v[24:27], v3, s[16:19], s48 offen offset:0 sc0 sc1
  buffer_store_dwordx4 v[28:31], v3, s[16:19], s48 offen offset:1024 sc0 sc1
  s_add_u32 s56, s56, 4
  s_cmp_lt_u32 s56, 7
  s_cbranch_scc1 L_attn_sw2o
  s_mov_b32 s56, s43
L_attn_sw1i:
  s_add_u32 s52, s45, s56
  s_lshl_b32 s53, s56, 12
  s_lshr_b32 s47, s2, 3
  s_mul_i32 s47, s47, 222208
  s_lshl_b32 s48, s52, 7
  s_add_u32 s47, s47, s48
  s_add_u32 s46, s53, 131072
  s_add_u32 m0, s46, 0
  s_add_u32 s48, s47, 0
  buffer_load_dwordx4 v7, s[32:35], s48 offen lds
  s_add_u32 m0, s46, 1024
  s_add_u32 s48, s47, 57344
  buffer_load_dwordx4 v7, s[32:35], s48 offen lds
  s_add_u32 m0, s46, 2048
  s_add_u32 s48, s47, 114688
  buffer_load_dwordx4 v7, s[32:35], s48 offen lds
  s_add_u32 m0, s46, 3072
  s_add_u32 s48, s47, 172032
  buffer_load_dwordx4 v7, s[32:35], s48 offen lds
  s_add_u32 s56, s56, 4
  s_cmp_lt_u32 s56, 7
  s_cbranch_scc1 L_attn_sw1i
  s_add_u32 s24, s10, 5505024
  s_addc_u32 s25, s11, 0
  s_and_b32 s25, s25, 0xffff
  s_mov_b32 s26, 16384
  s_mov_b32 s27, 0x20000
  v_lshlrev_b32 v51, 5, v2
  s_mov_b32 s58, 8192
  buffer_load_dword v28, v51, s[24:27], s58 offen sc1
  s_mov_b32 s58, 10240
  buffer_load_dword v29, v51, s[24:27], s58 offen sc1
  s_mov_b32 s58, 12288
  buffer_load_dword v30, v51, s[24:27], s58 offen sc1
  s_mov_b32 s58, 14336
  buffer_load_dword v31, v51, s[24:27], s58 offen sc1
  s_barrier
  s_waitcnt vmcnt(0)
  v_min3_u32 v28, v28, v29, v30
  v_min_u32 v28, v28, v31
  v_cmp_gt_u32 vcc, 1, v28
  s_nop 0
  s_cmp_eq_u64 vcc, 0
  s_cbranch_scc1 L_psvad
  s_mov_b32 s66, 4194304
  s_branch L_psvaf
L_psva:
  s_sleep 16
L_psvaf:
  s_mov_b32 s58, 8192
  buffer_load_dword v28, v51, s[24:27], s58 offen sc1
  s_mov_b32 s58, 10240
  buffer_load_dword v29, v51, s[24:27], s58 offen sc1
  s_mov_b32 s58, 12288
  buffer_load_dword v30, v51, s[24:27], s58 offen sc1
  s_mov_b32 s58, 14336
  buffer_load_dword v31, v51, s[24:27], s58 offen sc1
  s_waitcnt vmcnt(0)
  v_min3_u32 v28, v28, v29, v30
  v_min_u32 v28, v28, v31
  v_cmp_gt_u32 vcc, 1, v28
  s_sub_u32 s66, s66, 1
  s_cbranch_scc1 L_psvad
  s_cmp_lg_u64 vcc, 0
  s_cbranch_scc1 L_psva
L_psvad:
  s_add_u32 s24, s10, 262144
  s_addc_u32 s25, s11, 0
  s_and_b32 s25, s25, 0xffff
  s_mov_b32 s26, 262144
  s_mov_b32 s27, 0x20000
  s_lshl_b32 s57, s43, 12
  s_lshl_b32 s58, s41, 8
  s_add_u32 s57, s57, s58
  s_and_b32 s59, s43, 1
  s_lshl_b32 s59, s59, 8
  s_lshr_b32 s58, s2, 5
  s_lshl_b32 s58, s58, 9
  s_add_u32 s59, s59, s58
  s_add_u32 s59, s59, 12288
  v_and_b32 v50, 0xf0, v3
  v_lshrrev_b32 v52, 4, v2
  v_lshl_add_u32 v53, v52, 14, v50
  buffer_load_dwordx4 v[16:19], v53, s[24:27], s57 offen sc1
  s_add_u32 s57, s57, 65536
  buffer_load_dwordx4 v[32:35], v53, s[24:27], s59 offen sc1
  s_add_u32 s59, s59, 65536
  buffer_load_dwordx4 v[20:23], v53, s[24:27], s57 offen sc1
  s_add_u32 s57, s57, 65536
  buffer_load_dwordx4 v[36:39], v53, s[24:27], s59 offen sc1
  s_add_u32 s59, s59, 65536
  buffer_load_dwordx4 v[24:27], v53, s[24:27], s57 offen sc1
  s_add_u32 s57, s57, 65536
  buffer_load_dwordx4 v[40:43], v53, s[24:27], s59 offen sc1
  s_add_u32 s59, s59, 65536
  buffer_load_dwordx4 v[28:31], v53, s[24:27], s57 offen sc1
  s_add_u32 s57, s57, 65536
  buffer_load_dwordx4 v[44:47], v53, s[24:27], s59 offen sc1
  s_add_u32 s59, s59, 65536
  v_and_b32 v54, 0x70, v3
  v_lshrrev_b32 v55, 3, v2
  v_lshl_add_u32 v55, v55, 14, v54
  s_lshr_b32 s57, s2, 3
  s_lshl_b32 s57, s57, 7
  s_add_u32 s57, s57, 4096
  s_add_u32 s59, s57, 4096
  buffer_load_dwordx4 v[64:67], v55, s[24:27], s59 offen sc1
  s_add_u32 s59, s57, 135168
  buffer_load_dwordx4 v[68:71], v55, s[24:27], s59 offen sc1
  s_add_u32 s59, s57, 0
  buffer_load_dwordx4 v[72:75], v55, s[24:27], s59 offen sc1
  s_add_u32 s59, s57, 131072
  buffer_load_dwordx4 v[76:79], v55, s[24:27], s59 offen sc1
  s_cmp_eq_u32 s43, 2
  s_cselect_b32 s58, 1.0, 0
  s_lshl_b32 s57, s43, 8
  s_add_u32 s57, s57, 159744
  v_lshl_add_u32 v50, v52, 2, v50
  v_add_u32 v50, s57, v50
  s_waitcnt vmcnt(0)
  v_pk_add_f32 v[16:17], v[16:17], v[20:21]
  v_pk_add_f32 v[18:19], v[18:19], v[22:23]
  v_pk_add_f32 v[16:17], v[16:17], v[24:25]
  v_pk_add_f32 v[18:19], v[18:19], v[26:27]
  v_pk_add_f32 v[16:17], v[16:17], v[28:29]
  v_pk_add_f32 v[18:19], v[18:19], v[30:31]
  v_pk_add_f32 v[32:33], v[32:33], v[36:37]
  v_pk_add_f32 v[34:35], v[34:35], v[38:39]
  v_pk_add_f32 v[32:33], v[32:33], v[40:41]
  v_pk_add_f32 v[34:35], v[34:35], v[42:43]
  v_pk_add_f32 v[32:33], v[32:33], v[44:45]
  v_pk_add_f32 v[34:35], v[34:35], v[46:47]
  s_nop 0
  v_permlane16_swap_b32 v16, v17
  v_permlane16_swap_b32 v18, v19
  v_permlane16_swap_b32 v32, v33
  v_permlane16_swap_b32 v34, v35
  v_add_f32 v16, v16, v17
  v_add_f32 v18, v18, v19
  v_add_f32 v32, v32, v33
  v_add_f32 v34, v34, v35
  s_nop 1
  v_permlane32_swap_b32 v16, v18
  v_permlane32_swap_b32 v32, v34
  v_add_f32 v16, v16, v18
  v_cvt_pk_bf16_f32 v16, v16, v16
  v_and_b32 v16, 0xffff0000, v16
  v_add_f32 v32, v32, v34
  v_cvt_pk_bf16_f32 v32, v32, v32
  v_and_b32 v32, 0xffff0000, v32
  v_add_f32 v16, s58, v16
  v_cvt_pk_bf16_f32 v16, v16, v16
  v_and_b32 v16, 0xffff0000, v16
  ds_write_b32 v50, v16
  ds_write_b32 v50, v32 offset:2048
  v_pk_add_f32 v[64:65], v[64:65], v[68:69]
  v_pk_add_f32 v[66:67], v[66:67], v[70:71]
  v_pk_add_f32 v[72:73], v[72:73], v[76:77]
  v_pk_add_f32 v[74:75], v[74:75], v[78:79]
  v_cmp_gt_u32 vcc, 32, v2
  s_nop 0
  v_permlane32_swap_b32 v64, v72
  v_permlane32_swap_b32 v65, v73
  v_permlane32_swap_b32 v66, v74
  v_permlane32_swap_b32 v67, v75
  v_pk_add_f32 v[64:65], v[64:65], v[72:73]
  v_pk_add_f32 v[66:67], v[66:67], v[74:75]
  v_cndmask_b32 v72, 0, 1.0, vcc
  s_nop 0
  v_permlane16_swap_b32 v64, v66
  v_permlane16_swap_b32 v65, v67
  v_pk_add_f32 v[64:65], v[64:65], v[66:67]
  v_lshrrev_b32 v54, 1, v54
  v_lshl_add_u32 v54, v52, 2, v54
  v_add_f32_dpp v64, v64, v64 row_ror:8 row_mask:0xf bank_mask:0xf
  v_add_f32_dpp v65, v65, v65 row_ror:8 row_mask:0xf bank_mask:0xf
  v_cvt_pk_bf16_f32 v64, v64, v64
  v_and_b32 v64, 0xffff0000, v64
  v_cvt_pk_bf16_f32 v65, v65, v65
  v_and_b32 v65, 0xffff0000, v65
  v_add_f32 v64, v64, v72
  v_add_f32 v65, v65, v72
  v_lshrrev_b32 v55, 5, v2
  v_mul_u32_u24 v55, 56, v55
  v_add_u32 v54, v54, v55
  v_add_u32 v54, 162816, v54
  v_cvt_pk_bf16_f32 v64, v64, v65
  ds_write_b32 v54, v64
  v_and_b32 v54, 1, v2
  v_lshlrev_b32 v55, 6, v54
  v_lshl_add_u32 v55, v52, 3, v55
  v_add_u32 v55, 162816, v55
  s_waitcnt lgkmcnt(0)
  ds_read_b64 v[56:57], v55
  ds_read_b64 v[58:59], v55 offset:32
  v_mul_u32_u24 v55, 14336, v54
  v_lshl_add_u32 v55, v52, 4, v55
  v_and_b32 v54, 14, v2
  v_cmp_eq_u32 vcc, 0, v54
  v_mov_b32 v54, 0x80000000
  s_waitcnt lgkmcnt(0)
  v_cndmask_b32 v55, v54, v55, vcc
  s_mov_b32 s56, s43
L_attn_sw1o:
  s_add_u32 s52, s45, s56
  s_lshl_b32 s53, s56, 12
  v_add_u32 v10, s53, v5
  ds_read_b64_tr_b16 v[16:17], v10 offset:0
  ds_read_b64_tr_b16 v[18:19], v10 offset:2048
  ds_read_b64_tr_b16 v[20:21], v10 offset:32
  ds_read_b64_tr_b16 v[22:23], v10 offset:2080
  ds_read_b64_tr_b16 v[24:25], v10 offset:64
  ds_read_b64_tr_b16 v[26:27], v10 offset:2112
  ds_read_b64_tr_b16 v[28:29], v10 offset:96
  ds_read_b64_tr_b16 v[30:31], v10 offset:2144
  s_lshr_b32 s47, s2, 3
  s_mul_i32 s48, s47, 56
  s_mul_i32 s47, s47, 14336
  s_sub_u32 s48, s52, s48
  s_lshl_b32 s48, s48, 2
  s_waitcnt lgkmcnt(0)
  v_mfma_f32_16x16x32_bf16 v[64:67], v[16:19], v[56:59], 0
  v_mfma_f32_16x16x32_bf16 v[68:71], v[20:23], v[56:59], 0
  v_mfma_f32_16x16x32_bf16 v[72:75], v[24:27], v[56:59], 0
  v_mfma_f32_16x16x32_bf16 v[76:79], v[28:31], v[56:59], 0
  s_add_u32 s49, s48, 0
  s_mul_i32 s50, s49, 4682
  s_lshr_b32 s50, s50, 16
  s_mul_i32 s51, s50, 14
  s_sub_u32 s49, s49, s51
  s_cmp_ge_u32 s49, 6
  s_addc_u32 s51, s49, 0
  s_cmp_eq_u32 s49, 12
  s_cselect_b32 s51, 6, s51
  s_min_u32 s51, s51, 13
  s_mul_i32 s50, s50, 458752
  s_lshl_b32 s51, s51, 10
  s_add_u32 s50, s50, s51
  s_add_u32 s50, s50, s47
  buffer_store_dwordx4 v[16:19], v3, s[12:15], s50 offen sc0 sc1
  s_add_u32 s49, s48, 1
  s_mul_i32 s50, s49, 4682
  s_lshr_b32 s50, s50, 16
  s_mul_i32 s51, s50, 14
  s_sub_u32 s49, s49, s51
  s_cmp_ge_u32 s49, 6
  s_addc_u32 s51, s49, 0
  s_cmp_eq_u32 s49, 12
  s_cselect_b32 s51, 6, s51
  s_min_u32 s51, s51, 13
  s_mul_i32 s50, s50, 458752
  s_lshl_b32 s51, s51, 10
  s_add_u32 s50, s50, s51
  s_add_u32 s50, s50, s47
  buffer_store_dwordx4 v[20:23], v3, s[12:15], s50 offen sc0 sc1
  s_add_u32 s49, s48, 2
  s_mul_i32 s50, s49, 4682
  s_lshr_b32 s50, s50, 16
  s_mul_i32 s51, s50, 14
  s_sub_u32 s49, s49, s51
  s_cmp_ge_u32 s49, 6
  s_addc_u32 s51, s49, 0
  s_cmp_eq_u32 s49, 12
  s_cselect_b32 s51, 6, s51
  s_min_u32 s51, s51, 13
  s_mul_i32 s50, s50, 458752
  s_lshl_b32 s51, s51, 10
  s_add_u32 s50, s50, s51
  s_add_u32 s50, s50, s47
  buffer_store_dwordx4 v[24:27], v3, s[12:15], s50 offen sc0 sc1
  s_add_u32 s49, s48, 3
  s_mul_i32 s50, s49, 4682
  s_lshr_b32 s50, s50, 16
  s_mul_i32 s51, s50, 14
  s_sub_u32 s49, s49, s51
  s_cmp_ge_u32 s49, 6
  s_addc_u32 s51, s49, 0
  s_cmp_eq_u32 s49, 12
  s_cselect_b32 s51, 6, s51
  s_min_u32 s51, s51, 13
  s_mul_i32 s50, s50, 458752
  s_lshl_b32 s51, s51, 10
  s_add_u32 s50, s50, s51
  s_add_u32 s50, s50, s47
  buffer_store_dwordx4 v[28:31], v3, s[12:15], s50 offen sc0 sc1
  s_lshr_b32 s47, s2, 3
  s_mul_i32 s47, s47, 28672
  s_lshl_b32 s48, s48, 6
  s_add_u32 s47, s47, s48
  s_add_u32 s47, s47, 56623104
  buffer_store_dwordx4 v[64:67], v55, s[28:31], s47 offen offset:0 sc0 sc1
  buffer_store_dwordx4 v[68:71], v55, s[28:31], s47 offen offset:64 sc0 sc1
  buffer_store_dwordx4 v[72:75], v55, s[28:31], s47 offen offset:128 sc0 sc1
  buffer_store_dwordx4 v[76:79], v55, s[28:31], s47 offen offset:192 sc0 sc1
  s_add_u32 s56, s56, 4
  s_cmp_lt_u32 s56, 7
  s_cbranch_scc1 L_attn_sw1o
  s_waitcnt vmcnt(0)
  s_setprio 0
  s_add_u32 s12, s10, 6291456
  s_addc_u32 s13, s11, 0
  s_and_b32 s13, s13, 0xffff
  s_mov_b32 s14, 4194304
  s_mov_b32 s15, 0x20000
  s_add_u32 s16, s10, 35651584
  s_addc_u32 s17, s11, 0
  s_and_b32 s17, s17, 0xffff
  s_mov_b32 s18, 2097152
  s_mov_b32 s19, 0x20000
  s_sub_u32 s43, s42, 4
  s_mul_i32 s45, s40, 262144
  s_mul_i32 s46, s43, 4096
  s_add_u32 s45, s45, s46
  s_mul_i32 s47, s41, 131072
  s_mul_i32 s49, s43, 2048
  s_add_u32 s47, s47, s49
  s_add_u32 s49, s49, 16384
  s_mov_b32 s53, 0
  s_mov_b32 s62, s45
  v_add_u32 v59, s49, v3
  v_add_u32 v63, 0, v59
  ds_write_b128 v63, v[100:103] offset:0
  ds_write_b128 v63, v[104:107] offset:1024
  v_add_u32 v63, 24576, v59
  ds_write_b128 v63, v[108:111] offset:0
  ds_write_b128 v63, v[112:115] offset:1024
  s_add_u32 s24, s10, 5767168
  s_addc_u32 s25, s11, 0
  s_and_b32 s25, s25, 0xffff
  s_mov_b32 s26, 524288
  s_mov_b32 s27, 0x20000
  v_lshlrev_b32 v6, 7, v2
  s_lshl_b32 s57, s40, 13
  s_add_u32 s57, s57, 262144
  s_barrier
  s_cmp_lg_u32 s43, 0
  s_cbranch_scc1 L_attn_nosv
  s_lshl_b32 s58, s2, 5
  s_add_u32 s58, s58, 5513216
  v_mov_b32 v9, 0
  v_mov_b32 v10, 2
  buffer_store_dword v10, v9, s[28:31], s58 offen sc0 sc1
L_attn_nosv:
  s_mov_b32 s55, 0
  v_add_u32 v60, s46, v3
  s_add_u32 m0, s53, s46
  s_nop 0
  buffer_load_dwordx4 v3, s[12:15], s45 offen offset:0 sc1 lds
  buffer_load_dwordx4 v3, s[12:15], s45 offen offset:1024 sc1 lds
  buffer_load_dwordx4 v3, s[12:15], s45 offen offset:2048 sc1 lds
  buffer_load_dwordx4 v3, s[12:15], s45 offen offset:3072 sc1 lds
  s_add_u32 s45, s45, 16384
  s_add_u32 s53, s53, 24576
  s_cmp_eq_u32 s53, 147456
  s_cselect_b32 s53, 0, s53
  s_add_u32 m0, s53, s46
  s_nop 0
  buffer_load_dwordx4 v3, s[12:15], s45 offen offset:0 sc1 lds
  buffer_load_dwordx4 v3, s[12:15], s45 offen offset:1024 sc1 lds
  buffer_load_dwordx4 v3, s[12:15], s45 offen offset:2048 sc1 lds
  buffer_load_dwordx4 v3, s[12:15], s45 offen offset:3072 sc1 lds
  s_add_u32 s45, s45, 16384
  s_add_u32 s53, s53, 24576
  s_cmp_eq_u32 s53, 147456
  s_cselect_b32 s53, 0, s53
  s_waitcnt vmcnt(4)
  s_mov_b32 s66, 4194304
L_bo_val0:
  v_add_u32 v61, 0, v60
  ds_read_b128 v[64:67], v61 offset:0
  ds_read_b128 v[68:71], v61 offset:1024
  ds_read_b128 v[72:75], v61 offset:2048
  ds_read_b128 v[76:79], v61 offset:3072
  s_waitcnt lgkmcnt(0)
  v_max3_u32 v62, v64, v65, v66
  v_max3_u32 v62, v62, v67, v68
  v_max3_u32 v62, v62, v69, v70
  v_max3_u32 v62, v62, v71, v72
  v_max3_u32 v62, v62, v73, v74
  v_max3_u32 v62, v62, v75, v76
  v_max3_u32 v62, v62, v77, v78
  v_max_u32 v62, v62, v79
  v_cmp_eq_u32 vcc, -1, v62
  s_sub_u32 s66, s66, 1
  s_cbranch_scc1 L_bo_ok0
  s_cmp_eq_u64 vcc, 0
  s_cbranch_scc1 L_bo_ok0
  s_add_u32 m0, s46, 0
  s_add_u32 s63, s62, 0
  buffer_load_dwordx4 v3, s[12:15], s63 offen offset:0 sc1 lds
  buffer_load_dwordx4 v3, s[12:15], s63 offen offset:1024 sc1 lds
  buffer_load_dwordx4 v3, s[12:15], s63 offen offset:2048 sc1 lds
  buffer_load_dwordx4 v3, s[12:15], s63 offen offset:3072 sc1 lds
  s_add_u32 m0, s46, 24576
  s_add_u32 s63, s62, 16384
  buffer_load_dwordx4 v3, s[12:15], s63 offen offset:0 sc1 lds
  buffer_load_dwordx4 v3, s[12:15], s63 offen offset:1024 sc1 lds
  buffer_load_dwordx4 v3, s[12:15], s63 offen offset:2048 sc1 lds
  buffer_load_dwordx4 v3, s[12:15], s63 offen offset:3072 sc1 lds
  s_waitcnt vmcnt(4)
  s_mov_b32 s55, 1
  s_branch L_bo_val0
L_bo_ok0:
  s_waitcnt lgkmcnt(0)
  s_barrier
  s_add_u32 m0, s53, s46
  s_nop 0
  buffer_load_dwordx4 v3, s[12:15], s45 offen offset:0 sc1 lds
  buffer_load_dwordx4 v3, s[12:15], s45 offen offset:1024 sc1 lds
  buffer_load_dwordx4 v3, s[12:15], s45 offen offset:2048 sc1 lds
  buffer_load_dwordx4 v3, s[12:15], s45 offen offset:3072 sc1 lds
  s_add_u32 s45, s45, 16384
  s_add_u32 s53, s53, 24576
  s_cmp_eq_u32 s53, 147456
  s_cselect_b32 s53, 0, s53
  v_add_u32 v63, 49152, v59
  ds_write_b128 v63, v[116:119] offset:0
  ds_write_b128 v63, v[120:123] offset:1024
  s_add_u32 m0, s53, s46
  s_nop 0
  buffer_load_dwordx4 v3, s[12:15], s45 offen offset:0 sc1 lds
  buffer_load_dwordx4 v3, s[12:15], s45 offen offset:1024 sc1 lds
  buffer_load_dwordx4 v3, s[12:15], s45 offen offset:2048 sc1 lds
  buffer_load_dwordx4 v3, s[12:15], s45 offen offset:3072 sc1 lds
  s_add_u32 s45, s45, 16384
  s_add_u32 s53, s53, 24576
  s_cmp_eq_u32 s53, 147456
  s_cselect_b32 s53, 0, s53
  v_add_u32 v63, 73728, v59
  ds_write_b128 v63, v[124:127] offset:0
  ds_write_b128 v63, v[128:131] offset:1024
  s_waitcnt vmcnt(8)
  s_cmp_eq_u32 s55, 0
  s_cbranch_scc1 L_bo_nr1
  s_waitcnt vmcnt(0)
  s_mov_b32 s55, 0
L_bo_nr1:
  s_mov_b32 s66, 4194304
L_bo_val1:
  v_add_u32 v61, 24576, v60
  ds_read_b128 v[64:67], v61 offset:0
  ds_read_b128 v[68:71], v61 offset:1024
  ds_read_b128 v[72:75], v61 offset:2048
  ds_read_b128 v[76:79], v61 offset:3072
  s_waitcnt lgkmcnt(0)
  v_max3_u32 v62, v64, v65, v66
  v_max3_u32 v62, v62, v67, v68
  v_max3_u32 v62, v62, v69, v70
  v_max3_u32 v62, v62, v71, v72
  v_max3_u32 v62, v62, v73, v74
  v_max3_u32 v62, v62, v75, v76
  v_max3_u32 v62, v62, v77, v78
  v_max_u32 v62, v62, v79
  v_cmp_eq_u32 vcc, -1, v62
  s_sub_u32 s66, s66, 1
  s_cbranch_scc1 L_bo_ok1
  s_cmp_eq_u64 vcc, 0
  s_cbranch_scc1 L_bo_ok1
  s_add_u32 m0, s46, 24576
  s_add_u32 s63, s62, 16384
  buffer_load_dwordx4 v3, s[12:15], s63 offen offset:0 sc1 lds
  buffer_load_dwordx4 v3, s[12:15], s63 offen offset:1024 sc1 lds
  buffer_load_dwordx4 v3, s[12:15], s63 offen offset:2048 sc1 lds
  buffer_load_dwordx4 v3, s[12:15], s63 offen offset:3072 sc1 lds
  s_add_u32 m0, s46, 49152
  s_add_u32 s63, s62, 32768
  buffer_load_dwordx4 v3, s[12:15], s63 offen offset:0 sc1 lds
  buffer_load_dwordx4 v3, s[12:15], s63 offen offset:1024 sc1 lds
  buffer_load_dwordx4 v3, s[12:15], s63 offen offset:2048 sc1 lds
  buffer_load_dwordx4 v3, s[12:15], s63 offen offset:3072 sc1 lds
  s_add_u32 m0, s46, 73728
  s_add_u32 s63, s62, 49152
  buffer_load_dwordx4 v3, s[12:15], s63 offen offset:0 sc1 lds
  buffer_load_dwordx4 v3, s[12:15], s63 offen offset:1024 sc1 lds
  buffer_load_dwordx4 v3, s[12:15], s63 offen offset:2048 sc1 lds
  buffer_load_dwordx4 v3, s[12:15], s63 offen offset:3072 sc1 lds
  s_waitcnt vmcnt(8)
  s_mov_b32 s55, 1
  s_branch L_bo_val1
L_bo_ok1:
  s_waitcnt lgkmcnt(0)
  s_barrier
  s_add_u32 m0, s53, s46
  s_nop 0
  buffer_load_dwordx4 v3, s[12:15], s45 offen offset:0 sc1 lds
  buffer_load_dwordx4 v3, s[12:15], s45 offen offset:1024 sc1 lds
  buffer_load_dwordx4 v3, s[12:15], s45 offen offset:2048 sc1 lds
  buffer_load_dwordx4 v3, s[12:15], s45 offen offset:3072 sc1 lds
  s_add_u32 s45, s45, 16384
  s_add_u32 s53, s53, 24576
  s_cmp_eq_u32 s53, 147456
  s_cselect_b32 s53, 0, s53
  v_add_u32 v63, 98304, v59
  ds_write_b128 v63, v[132:135] offset:0
  ds_write_b128 v63, v[136:139] offset:1024
  s_add_u32 m0, s53, s46
  s_nop 0
  buffer_load_dwordx4 v3, s[12:15], s45 offen offset:0 sc1 lds
  buffer_load_dwordx4 v3, s[12:15], s45 offen offset:1024 sc1 lds
  buffer_load_dwordx4 v3, s[12:15], s45 offen offset:2048 sc1 lds
  buffer_load_dwordx4 v3, s[12:15], s45 offen offset:3072 sc1 lds
  s_add_u32 s45, s45, 16384
  s_add_u32 s53, s53, 24576
  s_cmp_eq_u32 s53, 147456
  s_cselect_b32 s53, 0, s53
  v_add_u32 v63, 122880, v59
  ds_write_b128 v63, v[140:143] offset:0
  ds_write_b128 v63, v[144:147] offset:1024
  s_waitcnt vmcnt(12)
  s_cmp_eq_u32 s55, 0
  s_cbranch_scc1 L_bo_nr2
  s_waitcnt vmcnt(0)
  s_mov_b32 s55, 0
L_bo_nr2:
  s_mov_b32 s66, 4194304
L_bo_val2:
  v_add_u32 v61, 49152, v60
  ds_read_b128 v[64:67], v61 offset:0
  ds_read_b128 v[68:71], v61 offset:1024
  ds_read_b128 v[72:75], v61 offset:2048
  ds_read_b128 v[76:79], v61 offset:3072
  s_waitcnt lgkmcnt(0)
  v_max3_u32 v62, v64, v65, v66
  v_max3_u32 v62, v62, v67, v68
  v_max3_u32 v62, v62, v69, v70
  v_max3_u32 v62, v62, v71, v72
  v_max3_u32 v62, v62, v73, v74
  v_max3_u32 v62, v62, v75, v76
  v_max3_u32 v62, v62, v77, v78
  v_max_u32 v62, v62, v79
  v_cmp_eq_u32 vcc, -1, v62
  s_sub_u32 s66, s66, 1
  s_cbranch_scc1 L_bo_ok2
  s_cmp_eq_u64 vcc, 0
  s_cbranch_scc1 L_bo_ok2
  s_add_u32 m0, s46, 49152
  s_add_u32 s63, s62, 32768
  buffer_load_dwordx4 v3, s[12:15], s63 offen offset:0 sc1 lds
  buffer_load_dwordx4 v3, s[12:15], s63 offen offset:1024 sc1 lds
  buffer_load_dwordx4 v3, s[12:15], s63 offen offset:2048 sc1 lds
  buffer_load_dwordx4 v3, s[12:15], s63 offen offset:3072 sc1 lds
  s_add_u32 m0, s46, 73728
  s_add_u32 s63, s62, 49152
  buffer_load_dwordx4 v3, s[12:15], s63 offen offset:0 sc1 lds
  buffer_load_dwordx4 v3, s[12:15], s63 offen offset:1024 sc1 lds
  buffer_load_dwordx4 v3, s[12:15], s63 offen offset:2048 sc1 lds
  buffer_load_dwordx4 v3, s[12:15], s63 offen offset:3072 sc1 lds
  s_add_u32 m0, s46, 98304
  s_add_u32 s63, s62, 65536
  buffer_load_dwordx4 v3, s[12:15], s63 offen offset:0 sc1 lds
  buffer_load_dwordx4 v3, s[12:15], s63 offen offset:1024 sc1 lds
  buffer_load_dwordx4 v3, s[12:15], s63 offen offset:2048 sc1 lds
  buffer_load_dwordx4 v3, s[12:15], s63 offen offset:3072 sc1 lds
  s_add_u32 m0, s46, 122880
  s_add_u32 s63, s62, 81920
  buffer_load_dwordx4 v3, s[12:15], s63 offen offset:0 sc1 lds
  buffer_load_dwordx4 v3, s[12:15], s63 offen offset:1024 sc1 lds
  buffer_load_dwordx4 v3, s[12:15], s63 offen offset:2048 sc1 lds
  buffer_load_dwordx4 v3, s[12:15], s63 offen offset:3072 sc1 lds
  s_waitcnt vmcnt(12)
  s_mov_b32 s55, 1
  s_branch L_bo_val2
L_bo_ok2:
  s_waitcnt lgkmcnt(0)
  s_barrier
  s_add_u32 m0, s53, s46
  s_nop 0
  buffer_load_dwordx4 v3, s[12:15], s45 offen offset:0 sc1 lds
  buffer_load_dwordx4 v3, s[12:15], s45 offen offset:1024 sc1 lds
  buffer_load_dwordx4 v3, s[12:15], s45 offen offset:2048 sc1 lds
  buffer_load_dwordx4 v3, s[12:15], s45 offen offset:3072 sc1 lds
  s_add_u32 s45, s45, 16384
  s_add_u32 s53, s53, 24576
  s_cmp_eq_u32 s53, 147456
  s_cselect_b32 s53, 0, s53
  v_add_u32 v63, 0, v59
  ds_write_b128 v63, v[148:151] offset:0
  ds_write_b128 v63, v[152:155] offset:1024
  s_waitcnt vmcnt(12)
  s_cmp_eq_u32 s55, 0
  s_cbranch_scc1 L_bo_nr3
  s_waitcnt vmcnt(0)
  s_mov_b32 s55, 0
L_bo_nr3:
  s_mov_b32 s66, 4194304
L_bo_val3:
  v_add_u32 v61, 73728, v60
  ds_read_b128 v[64:67], v61 offset:0
  ds_read_b128 v[68:71], v61 offset:1024
  ds_read_b128 v[72:75], v61 offset:2048
  ds_read_b128 v[76:79], v61 offset:3072
  s_waitcnt lgkmcnt(0)
  v_max3_u32 v62, v64, v65, v66
  v_max3_u32 v62, v62, v67, v68
  v_max3_u32 v62, v62, v69, v70
  v_max3_u32 v62, v62, v71, v72
  v_max3_u32 v62, v62, v73, v74
  v_max3_u32 v62, v62, v75, v76
  v_max3_u32 v62, v62, v77, v78
  v_max_u32 v62, v62, v79
  v_cmp_eq_u32 vcc, -1, v62
  s_sub_u32 s66, s66, 1
  s_cbranch_scc1 L_bo_ok3
  s_cmp_eq_u64 vcc, 0
  s_cbranch_scc1 L_bo_ok3
  s_add_u32 m0, s46, 73728
  s_add_u32 s63, s62, 49152
  buffer_load_dwordx4 v3, s[12:15], s63 offen offset:0 sc1 lds
  buffer_load_dwordx4 v3, s[12:15], s63 offen offset:1024 sc1 lds
  buffer_load_dwordx4 v3, s[12:15], s63 offen offset:2048 sc1 lds
  buffer_load_dwordx4 v3, s[12:15], s63 offen offset:3072 sc1 lds
  s_add_u32 m0, s46, 98304
  s_add_u32 s63, s62, 65536
  buffer_load_dwordx4 v3, s[12:15], s63 offen offset:0 sc1 lds
  buffer_load_dwordx4 v3, s[12:15], s63 offen offset:1024 sc1 lds
  buffer_load_dwordx4 v3, s[12:15], s63 offen offset:2048 sc1 lds
  buffer_load_dwordx4 v3, s[12:15], s63 offen offset:3072 sc1 lds
  s_add_u32 m0, s46, 122880
  s_add_u32 s63, s62, 81920
  buffer_load_dwordx4 v3, s[12:15], s63 offen offset:0 sc1 lds
  buffer_load_dwordx4 v3, s[12:15], s63 offen offset:1024 sc1 lds
  buffer_load_dwordx4 v3, s[12:15], s63 offen offset:2048 sc1 lds
  buffer_load_dwordx4 v3, s[12:15], s63 offen offset:3072 sc1 lds
  s_add_u32 m0, s46, 0
  s_add_u32 s63, s62, 98304
  buffer_load_dwordx4 v3, s[12:15], s63 offen offset:0 sc1 lds
  buffer_load_dwordx4 v3, s[12:15], s63 offen offset:1024 sc1 lds
  buffer_load_dwordx4 v3, s[12:15], s63 offen offset:2048 sc1 lds
  buffer_load_dwordx4 v3, s[12:15], s63 offen offset:3072 sc1 lds
  s_waitcnt vmcnt(12)
  s_mov_b32 s55, 1
  s_branch L_bo_val3
L_bo_ok3:
  s_waitcnt lgkmcnt(0)
  s_barrier
  s_waitcnt vmcnt(8)
  s_cmp_eq_u32 s55, 0
  s_cbranch_scc1 L_bo_nr4
  s_waitcnt vmcnt(0)
  s_mov_b32 s55, 0
L_bo_nr4:
  s_mov_b32 s66, 4194304
L_bo_val4:
  v_add_u32 v61, 98304, v60
  ds_read_b128 v[64:67], v61 offset:0
  ds_read_b128 v[68:71], v61 offset:1024
  ds_read_b128 v[72:75], v61 offset:2048
  ds_read_b128 v[76:79], v61 offset:3072
  s_waitcnt lgkmcnt(0)
  v_max3_u32 v62, v64, v65, v66
  v_max3_u32 v62, v62, v67, v68
  v_max3_u32 v62, v62, v69, v70
  v_max3_u32 v62, v62, v71, v72
  v_max3_u32 v62, v62, v73, v74
  v_max3_u32 v62, v62, v75, v76
  v_max3_u32 v62, v62, v77, v78
  v_max_u32 v62, v62, v79
  v_cmp_eq_u32 vcc, -1, v62
  s_sub_u32 s66, s66, 1
  s_cbranch_scc1 L_bo_ok4
  s_cmp_eq_u64 vcc, 0
  s_cbranch_scc1 L_bo_ok4
  s_add_u32 m0, s46, 98304
  s_add_u32 s63, s62, 65536
  buffer_load_dwordx4 v3, s[12:15], s63 offen offset:0 sc1 lds
  buffer_load_dwordx4 v3, s[12:15], s63 offen offset:1024 sc1 lds
  buffer_load_dwordx4 v3, s[12:15], s63 offen offset:2048 sc1 lds
  buffer_load_dwordx4 v3, s[12:15], s63 offen offset:3072 sc1 lds
  s_add_u32 m0, s46, 122880
  s_add_u32 s63, s62, 81920
  buffer_load_dwordx4 v3, s[12:15], s63 offen offset:0 sc1 lds
  buffer_load_dwordx4 v3, s[12:15], s63 offen offset:1024 sc1 lds
  buffer_load_dwordx4 v3, s[12:15], s63 offen offset:2048 sc1 lds
  buffer_load_dwordx4 v3, s[12:15], s63 offen offset:3072 sc1 lds
  s_add_u32 m0, s46, 0
  s_add_u32 s63, s62, 98304
  buffer_load_dwordx4 v3, s[12:15], s63 offen offset:0 sc1 lds
  buffer_load_dwordx4 v3, s[12:15], s63 offen offset:1024 sc1 lds
  buffer_load_dwordx4 v3, s[12:15], s63 offen offset:2048 sc1 lds
  buffer_load_dwordx4 v3, s[12:15], s63 offen offset:3072 sc1 lds
  s_waitcnt vmcnt(8)
  s_mov_b32 s55, 1
  s_branch L_bo_val4
L_bo_ok4:
  s_waitcnt lgkmcnt(0)
  s_barrier
  s_waitcnt vmcnt(4)
  s_cmp_eq_u32 s55, 0
  s_cbranch_scc1 L_bo_nr5
  s_waitcnt vmcnt(0)
  s_mov_b32 s55, 0
L_bo_nr5:
  s_mov_b32 s66, 4194304
L_bo_val5:
  v_add_u32 v61, 122880, v60
  ds_read_b128 v[64:67], v61 offset:0
  ds_read_b128 v[68:71], v61 offset:1024
  ds_read_b128 v[72:75], v61 offset:2048
  ds_read_b128 v[76:79], v61 offset:3072
  s_waitcnt lgkmcnt(0)
  v_max3_u32 v62, v64, v65, v66
  v_max3_u32 v62, v62, v67, v68
  v_max3_u32 v62, v62, v69, v70
  v_max3_u32 v62, v62, v71, v72
  v_max3_u32 v62, v62, v73, v74
  v_max3_u32 v62, v62, v75, v76
  v_max3_u32 v62, v62, v77, v78
  v_max_u32 v62, v62, v79
  v_cmp_eq_u32 vcc, -1, v62
  s_sub_u32 s66, s66, 1
  s_cbranch_scc1 L_bo_ok5
  s_cmp_eq_u64 vcc, 0
  s_cbranch_scc1 L_bo_ok5
  s_add_u32 m0, s46, 122880
  s_add_u32 s63, s62, 81920
  buffer_load_dwordx4 v3, s[12:15], s63 offen offset:0 sc1 lds
  buffer_load_dwordx4 v3, s[12:15], s63 offen offset:1024 sc1 lds
  buffer_load_dwordx4 v3, s[12:15], s63 offen offset:2048 sc1 lds
  buffer_load_dwordx4 v3, s[12:15], s63 offen offset:3072 sc1 lds
  s_add_u32 m0, s46, 0
  s_add_u32 s63, s62, 98304
  buffer_load_dwordx4 v3, s[12:15], s63 offen offset:0 sc1 lds
  buffer_load_dwordx4 v3, s[12:15], s63 offen offset:1024 sc1 lds
  buffer_load_dwordx4 v3, s[12:15], s63 offen offset:2048 sc1 lds
  buffer_load_dwordx4 v3, s[12:15], s63 offen offset:3072 sc1 lds
  s_waitcnt vmcnt(4)
  s_mov_b32 s55, 1
  s_branch L_bo_val5
L_bo_ok5:
  s_waitcnt lgkmcnt(0)
  s_barrier
  s_add_u32 m0, s53, s46
  s_nop 0
  buffer_load_dwordx4 v3, s[12:15], s45 offen offset:0 sc1 lds
  buffer_load_dwordx4 v3, s[12:15], s45 offen offset:1024 sc1 lds
  buffer_load_dwordx4 v3, s[12:15], s45 offen offset:2048 sc1 lds
  buffer_load_dwordx4 v3, s[12:15], s45 offen offset:3072 sc1 lds
  s_add_u32 s45, s45, 16384
  s_add_u32 s53, s53, 24576
  s_cmp_eq_u32 s53, 147456
  s_cselect_b32 s53, 0, s53
  v_add_u32 v63, 24576, v59
  ds_write_b128 v63, v[156:159] offset:0
  ds_write_b128 v63, v[160:163] offset:1024
  s_add_u32 m0, s53, s46
  s_nop 0
  buffer_load_dwordx4 v3, s[12:15], s45 offen offset:0 sc1 lds
  buffer_load_dwordx4 v3, s[12:15], s45 offen offset:1024 sc1 lds
  buffer_load_dwordx4 v3, s[12:15], s45 offen offset:2048 sc1 lds
  buffer_load_dwordx4 v3, s[12:15], s45 offen offset:3072 sc1 lds
  s_add_u32 s45, s45, 16384
  s_add_u32 s53, s53, 24576
  s_cmp_eq_u32 s53, 147456
  s_cselect_b32 s53, 0, s53
  v_add_u32 v63, 49152, v59
  ds_write_b128 v63, v[164:167] offset:0
  ds_write_b128 v63, v[168:171] offset:1024
  s_add_u32 m0, s53, s46
  s_nop 0
  buffer_load_dwordx4 v3, s[12:15], s45 offen offset:0 sc1 lds
  buffer_load_dwordx4 v3, s[12:15], s45 offen offset:1024 sc1 lds
  buffer_load_dwordx4 v3, s[12:15], s45 offen offset:2048 sc1 lds
  buffer_load_dwordx4 v3, s[12:15], s45 offen offset:3072 sc1 lds
  s_add_u32 s45, s45, 16384
  s_add_u32 s53, s53, 24576
  s_cmp_eq_u32 s53, 147456
  s_cselect_b32 s53, 0, s53
  v_add_u32 v63, 73728, v59
  ds_write_b128 v63, v[172:175] offset:0
  ds_write_b128 v63, v[176:179] offset:1024
  s_waitcnt vmcnt(12)
  s_cmp_eq_u32 s55, 0
  s_cbranch_scc1 L_bo_nr6
  s_waitcnt vmcnt(0)
  s_mov_b32 s55, 0
L_bo_nr6:
  s_mov_b32 s66, 4194304
L_bo_val6:
  v_add_u32 v61, 0, v60
  ds_read_b128 v[64:67], v61 offset:0
  ds_read_b128 v[68:71], v61 offset:1024
  ds_read_b128 v[72:75], v61 offset:2048
  ds_read_b128 v[76:79], v61 offset:3072
  s_waitcnt lgkmcnt(0)
  v_max3_u32 v62, v64, v65, v66
  v_max3_u32 v62, v62, v67, v68
  v_max3_u32 v62, v62, v69, v70
  v_max3_u32 v62, v62, v71, v72
  v_max3_u32 v62, v62, v73, v74
  v_max3_u32 v62, v62, v75, v76
  v_max3_u32 v62, v62, v77, v78
  v_max_u32 v62, v62, v79
  v_cmp_eq_u32 vcc, -1, v62
  s_sub_u32 s66, s66, 1
  s_cbranch_scc1 L_bo_ok6
  s_cmp_eq_u64 vcc, 0
  s_cbranch_scc1 L_bo_ok6
  s_add_u32 m0, s46, 0
  s_add_u32 s63, s62, 98304
  buffer_load_dwordx4 v3, s[12:15], s63 offen offset:0 sc1 lds
  buffer_load_dwordx4 v3, s[12:15], s63 offen offset:1024 sc1 lds
  buffer_load_dwordx4 v3, s[12:15], s63 offen offset:2048 sc1 lds
  buffer_load_dwordx4 v3, s[12:15], s63 offen offset:3072 sc1 lds
  s_waitcnt vmcnt(0)
  s_mov_b32 s55, 1
  s_branch L_bo_val6
L_bo_ok6:
  s_waitcnt lgkmcnt(0)
  s_barrier
  s_add_u32 m0, s53, s46
  s_nop 0
  buffer_load_dwordx4 v3, s[12:15], s45 offen offset:0 sc1 lds
  buffer_load_dwordx4 v3, s[12:15], s45 offen offset:1024 sc1 lds
  buffer_load_dwordx4 v3, s[12:15], s45 offen offset:2048 sc1 lds
  buffer_load_dwordx4 v3, s[12:15], s45 offen offset:3072 sc1 lds
  s_add_u32 s45, s45, 16384
  s_add_u32 s53, s53, 24576
  s_cmp_eq_u32 s53, 147456
  s_cselect_b32 s53, 0, s53
  v_add_u32 v63, 98304, v59
  ds_write_b128 v63, v[180:183] offset:0
  ds_write_b128 v63, v[184:187] offset:1024
  s_add_u32 m0, s53, s46
  s_nop 0
  buffer_load_dwordx4 v3, s[12:15], s45 offen offset:0 sc1 lds
  buffer_load_dwordx4 v3, s[12:15], s45 offen offset:1024 sc1 lds
  buffer_load_dwordx4 v3, s[12:15], s45 offen offset:2048 sc1 lds
  buffer_load_dwordx4 v3, s[12:15], s45 offen offset:3072 sc1 lds
  s_add_u32 s45, s45, 16384
  s_add_u32 s53, s53, 24576
  s_cmp_eq_u32 s53, 147456
  s_cselect_b32 s53, 0, s53
  v_add_u32 v63, 122880, v59
  ds_write_b128 v63, v[188:191] offset:0
  ds_write_b128 v63, v[192:195] offset:1024
  s_waitcnt vmcnt(16)
  s_waitcnt lgkmcnt(0)
  s_barrier
  s_add_u32 m0, s53, s46
  s_nop 0
  buffer_load_dwordx4 v3, s[12:15], s45 offen offset:0 sc1 lds
  buffer_load_dwordx4 v3, s[12:15], s45 offen offset:1024 sc1 lds
  buffer_load_dwordx4 v3, s[12:15], s45 offen offset:2048 sc1 lds
  buffer_load_dwordx4 v3, s[12:15], s45 offen offset:3072 sc1 lds
  s_add_u32 s45, s45, 16384
  s_add_u32 s53, s53, 24576
  s_cmp_eq_u32 s53, 147456
  s_cselect_b32 s53, 0, s53
  v_add_u32 v63, 0, v59
  ds_write_b128 v63, v[196:199] offset:0
  ds_write_b128 v63, v[200:203] offset:1024
  s_waitcnt vmcnt(16)
  s_waitcnt lgkmcnt(0)
  s_barrier
  s_add_u32 m0, s53, s46
  s_nop 0
  buffer_load_dwordx4 v3, s[12:15], s45 offen offset:0 sc1 lds
  buffer_load_dwordx4 v3, s[12:15], s45 offen offset:1024 sc1 lds
  buffer_load_dwordx4 v3, s[12:15], s45 offen offset:2048 sc1 lds
  buffer_load_dwordx4 v3, s[12:15], s45 offen offset:3072 sc1 lds
  s_add_u32 s45, s45, 16384
  s_add_u32 s53, s53, 24576
  s_cmp_eq_u32 s53, 147456
  s_cselect_b32 s53, 0, s53
  v_add_u32 v63, 24576, v59
  ds_write_b128 v63, v[204:207] offset:0
  ds_write_b128 v63, v[208:211] offset:1024
  s_waitcnt vmcnt(16)
  s_waitcnt lgkmcnt(0)
  s_barrier
  s_add_u32 m0, s53, s46
  s_nop 0
  buffer_load_dwordx4 v3, s[12:15], s45 offen offset:0 sc1 lds
  buffer_load_dwordx4 v3, s[12:15], s45 offen offset:1024 sc1 lds
  buffer_load_dwordx4 v3, s[12:15], s45 offen offset:2048 sc1 lds
  buffer_load_dwordx4 v3, s[12:15], s45 offen offset:3072 sc1 lds
  s_add_u32 s45, s45, 16384
  s_add_u32 s53, s53, 24576
  s_cmp_eq_u32 s53, 147456
  s_cselect_b32 s53, 0, s53
  v_add_u32 v63, 49152, v59
  ds_write_b128 v63, v[212:215] offset:0
  ds_write_b128 v63, v[216:219] offset:1024
  s_waitcnt vmcnt(16)
  s_waitcnt lgkmcnt(0)
  s_barrier
  s_add_u32 m0, s53, s46
  s_nop 0
  buffer_load_dwordx4 v3, s[12:15], s45 offen offset:0 sc1 lds
  buffer_load_dwordx4 v3, s[12:15], s45 offen offset:1024 sc1 lds
  buffer_load_dwordx4 v3, s[12:15], s45 offen offset:2048 sc1 lds
  buffer_load_dwordx4 v3, s[12:15], s45 offen offset:3072 sc1 lds
  s_add_u32 s45, s45, 16384
  s_add_u32 s53, s53, 24576
  s_cmp_eq_u32 s53, 147456
  s_cselect_b32 s53, 0, s53
  v_add_u32 v63, 73728, v59
  ds_write_b128 v63, v[220:223] offset:0
  ds_write_b128 v63, v[224:227] offset:1024
  s_waitcnt vmcnt(16)
  s_waitcnt lgkmcnt(0)
  s_barrier
  s_waitcnt vmcnt(12)
  s_waitcnt lgkmcnt(0)
  s_barrier
  s_add_u32 s24, s10, 5505024
  s_addc_u32 s25, s11, 0
  s_and_b32 s25, s25, 0xffff
  s_mov_b32 s26, 16384
  s_mov_b32 s27, 0x20000
  v_lshlrev_b32 v51, 5, v2
  s_mov_b32 s58, 8192
  buffer_load_dword v28, v51, s[24:27], s58 offen sc1
  s_mov_b32 s58, 10240
  buffer_load_dword v29, v51, s[24:27], s58 offen sc1
  s_mov_b32 s58, 12288
  buffer_load_dword v30, v51, s[24:27], s58 offen sc1
  s_mov_b32 s58, 14336
  buffer_load_dword v31, v51, s[24:27], s58 offen sc1
  s_waitcnt vmcnt(12)
  s_waitcnt lgkmcnt(0)
  s_barrier
  s_waitcnt vmcnt(8)
  s_waitcnt lgkmcnt(0)
  s_barrier
  s_waitcnt vmcnt(4)
  s_waitcnt lgkmcnt(0)
  s_barrier
  s_waitcnt vmcnt(4)
  s_waitcnt lgkmcnt(0)
  s_barrier
  s_waitcnt vmcnt(0)
  v_min3_u32 v28, v28, v29, v30
  v_min_u32 v28, v28, v31
  v_cmp_gt_u32 vcc, 2, v28
  s_nop 0
  s_cmp_eq_u64 vcc, 0
  s_cbranch_scc1 L_psvd
  s_mov_b32 s66, 4194304
L_psv:
  s_mov_b32 s58, 8192
  buffer_load_dword v28, v51, s[24:27], s58 offen sc1
  s_mov_b32 s58, 10240
  buffer_load_dword v29, v51, s[24:27], s58 offen sc1
  s_mov_b32 s58, 12288
  buffer_load_dword v30, v51, s[24:27], s58 offen sc1
  s_mov_b32 s58, 14336
  buffer_load_dword v31, v51, s[24:27], s58 offen sc1
  s_waitcnt vmcnt(0)
  v_min3_u32 v28, v28, v29, v30
  v_min_u32 v28, v28, v31
  v_cmp_gt_u32 vcc, 2, v28
  s_sub_u32 s66, s66, 1
  s_cbranch_scc1 L_psvd
  s_cmp_lg_u64 vcc, 0
  s_cbranch_scc1 L_psv
L_psvd:
  s_and_b32 s40, s2, 7
  s_lshr_b32 s3, s2, 3
  s_and_b32 s41, s40, 3
  s_lshl_b32 s41, s41, 2
  s_lshr_b32 s40, s40, 2
  s_lshl_b32 s40, s40, 3
  s_and_b32 s39, s3, 7
  s_or_b32 s40, s40, s39
  s_lshr_b32 s39, s3, 3
  s_or_b32 s41, s41, s39
  s_add_u32 s12, s10, 14680064
  s_addc_u32 s13, s11, 0
  s_and_b32 s13, s13, 0xffff
  s_mov_b32 s14, 4194304
  s_mov_b32 s15, 0x20000
  s_add_u32 s16, s10, 37748736
  s_addc_u32 s17, s11, 0
  s_and_b32 s17, s17, 0xffff
  s_mov_b32 s18, 7340032
  s_mov_b32 s19, 0x20000
  s_sub_u32 s43, s42, 4
  s_mul_i32 s45, s40, 262144
  s_mul_i32 s46, s43, 2048
  s_add_u32 s45, s45, s46
  s_mul_i32 s47, s41, 458752
  s_mul_i32 s49, s43, 3584
  s_add_u32 s47, s47, s49
  s_add_u32 s49, s49, 8192
  s_mov_b32 s53, 0
  s_mov_b32 s62, s45
  s_add_u32 m0, s49, 0
  s_nop 0
  buffer_load_dwordx4 v3, s[16:19], s47 offen offset:0 sc1 lds
  buffer_load_dwordx4 v3, s[16:19], s47 offen offset:1024 sc1 lds
  buffer_load_dwordx4 v3, s[16:19], s47 offen offset:2048 sc1 lds
  s_mov_b32 exec_hi, 0
  buffer_load_dwordx4 v3, s[16:19], s47 offen offset:3072 sc1 lds
  s_mov_b32 exec_hi, -1
  s_add_u32 s47, s47, 14336
  s_add_u32 m0, s49, 22528
  s_nop 0
  buffer_load_dwordx4 v3, s[16:19], s47 offen offset:0 sc1 lds
  buffer_load_dwordx4 v3, s[16:19], s47 offen offset:1024 sc1 lds
  buffer_load_dwordx4 v3, s[16:19], s47 offen offset:2048 sc1 lds
  s_mov_b32 exec_hi, 0
  buffer_load_dwordx4 v3, s[16:19], s47 offen offset:3072 sc1 lds
  s_mov_b32 exec_hi, -1
  s_add_u32 s47, s47, 14336
  s_add_u32 s24, s10, 5767168
  s_addc_u32 s25, s11, 0
  s_and_b32 s25, s25, 0xffff
  s_mov_b32 s26, 524288
  s_mov_b32 s27, 0x20000
  v_lshlrev_b32 v6, 7, v2
  s_lshl_b32 s57, s40, 13
  s_barrier
  s_mov_b32 s55, 0
  v_add_u32 v60, s46, v3
  s_add_u32 m0, s53, s46
  s_nop 0
  buffer_load_dwordx4 v3, s[12:15], s45 offen offset:0 sc1 lds
  buffer_load_dwordx4 v3, s[12:15], s45 offen offset:1024 sc1 lds
  s_add_u32 s45, s45, 8192
  s_add_u32 s53, s53, 22528
  s_cmp_eq_u32 s53, 157696
  s_cselect_b32 s53, 0, s53
  s_add_u32 m0, s53, s46
  s_nop 0
  buffer_load_dwordx4 v3, s[12:15], s45 offen offset:0 sc1 lds
  buffer_load_dwordx4 v3, s[12:15], s45 offen offset:1024 sc1 lds
  s_add_u32 s45, s45, 8192
  s_add_u32 s53, s53, 22528
  s_cmp_eq_u32 s53, 157696
  s_cselect_b32 s53, 0, s53
  s_waitcnt vmcnt(2)
  s_mov_b32 s66, 4194304
L_b1_val0:
  v_add_u32 v61, 0, v60
  ds_read_b128 v[64:67], v61 offset:0
  ds_read_b128 v[68:71], v61 offset:1024
  s_waitcnt lgkmcnt(0)
  v_max3_u32 v62, v64, v65, v66
  v_max3_u32 v62, v62, v67, v68
  v_max3_u32 v62, v62, v69, v70
  v_max_u32 v62, v62, v71
  v_cmp_eq_u32 vcc, -1, v62
  s_sub_u32 s66, s66, 1
  s_cbranch_scc1 L_b1_ok0
  s_cmp_eq_u64 vcc, 0
  s_cbranch_scc1 L_b1_ok0
  s_add_u32 m0, s46, 0
  s_add_u32 s63, s62, 0
  buffer_load_dwordx4 v3, s[12:15], s63 offen offset:0 sc1 lds
  buffer_load_dwordx4 v3, s[12:15], s63 offen offset:1024 sc1 lds
  s_add_u32 m0, s46, 22528
  s_add_u32 s63, s62, 8192
  buffer_load_dwordx4 v3, s[12:15], s63 offen offset:0 sc1 lds
  buffer_load_dwordx4 v3, s[12:15], s63 offen offset:1024 sc1 lds
  s_waitcnt vmcnt(2)
  s_mov_b32 s55, 1
  s_branch L_b1_val0
L_b1_ok0:
  s_barrier
  s_add_u32 m0, s53, s46
  s_add_u32 s54, s53, s49
  buffer_load_dwordx4 v3, s[12:15], s45 offen offset:0 sc1 lds
  buffer_load_dwordx4 v3, s[12:15], s45 offen offset:1024 sc1 lds
  s_mov_b32 m0, s54
  s_add_u32 s45, s45, 8192
  buffer_load_dwordx4 v3, s[16:19], s47 offen offset:0 sc1 lds
  buffer_load_dwordx4 v3, s[16:19], s47 offen offset:1024 sc1 lds
  buffer_load_dwordx4 v3, s[16:19], s47 offen offset:2048 sc1 lds
  s_mov_b32 exec_hi, 0
  buffer_load_dwordx4 v3, s[16:19], s47 offen offset:3072 sc1 lds
  s_mov_b32 exec_hi, -1
  s_add_u32 s47, s47, 14336
  s_add_u32 s53, s53, 22528
  s_cmp_eq_u32 s53, 157696
  s_cselect_b32 s53, 0, s53
  s_add_u32 m0, s53, s46
  s_add_u32 s54, s53, s49
  buffer_load_dwordx4 v3, s[12:15], s45 offen offset:0 sc1 lds
  buffer_load_dwordx4 v3, s[12:15], s45 offen offset:1024 sc1 lds
  s_mov_b32 m0, s54
  s_add_u32 s45, s45, 8192
  buffer_load_dwordx4 v3, s[16:19], s47 offen offset:0 sc1 lds
  buffer_load_dwordx4 v3, s[16:19], s47 offen offset:1024 sc1 lds
  buffer_load_dwordx4 v3, s[16:19], s47 offen offset:2048 sc1 lds
  s_mov_b32 exec_hi, 0
  buffer_load_dwordx4 v3, s[16:19], s47 offen offset:3072 sc1 lds
  s_mov_b32 exec_hi, -1
  s_add_u32 s47, s47, 14336
  s_add_u32 s53, s53, 22528
  s_cmp_eq_u32 s53, 157696
  s_cselect_b32 s53, 0, s53
  s_waitcnt vmcnt(12)
  s_cmp_eq_u32 s55, 0
  s_cbranch_scc1 L_b1_nr1
  s_waitcnt vmcnt(0)
  s_mov_b32 s55, 0
L_b1_nr1:
  s_mov_b32 s66, 4194304
L_b1_val1:
  v_add_u32 v61, 22528, v60
  ds_read_b128 v[64:67], v61 offset:0
  ds_read_b128 v[68:71], v61 offset:1024
  s_waitcnt lgkmcnt(0)
  v_max3_u32 v62, v64, v65, v66
  v_max3_u32 v62, v62, v67, v68
  v_max3_u32 v62, v62, v69, v70
  v_max_u32 v62, v62, v71
  v_cmp_eq_u32 vcc, -1, v62
  s_sub_u32 s66, s66, 1
  s_cbranch_scc1 L_b1_ok1
  s_cmp_eq_u64 vcc, 0
  s_cbranch_scc1 L_b1_ok1
  s_add_u32 m0, s46, 22528
  s_add_u32 s63, s62, 8192
  buffer_load_dwordx4 v3, s[12:15], s63 offen offset:0 sc1 lds
  buffer_load_dwordx4 v3, s[12:15], s63 offen offset:1024 sc1 lds
  s_add_u32 m0, s46, 45056
  s_add_u32 s63, s62, 16384
  buffer_load_dwordx4 v3, s[12:15], s63 offen offset:0 sc1 lds
  buffer_load_dwordx4 v3, s[12:15], s63 offen offset:1024 sc1 lds
  s_add_u32 m0, s46, 67584
  s_add_u32 s63, s62, 24576
  buffer_load_dwordx4 v3, s[12:15], s63 offen offset:0 sc1 lds
  buffer_load_dwordx4 v3, s[12:15], s63 offen offset:1024 sc1 lds
  s_waitcnt vmcnt(4)
  s_mov_b32 s55, 1
  s_branch L_b1_val1
L_b1_ok1:
  s_barrier
  s_add_u32 m0, s53, s46
  s_add_u32 s54, s53, s49
  buffer_load_dwordx4 v3, s[12:15], s45 offen offset:0 sc1 lds
  buffer_load_dwordx4 v3, s[12:15], s45 offen offset:1024 sc1 lds
  s_mov_b32 m0, s54
  s_add_u32 s45, s45, 8192
  buffer_load_dwordx4 v3, s[16:19], s47 offen offset:0 sc1 lds
  buffer_load_dwordx4 v3, s[16:19], s47 offen offset:1024 sc1 lds
  buffer_load_dwordx4 v3, s[16:19], s47 offen offset:2048 sc1 lds
  s_mov_b32 exec_hi, 0
  buffer_load_dwordx4 v3, s[16:19], s47 offen offset:3072 sc1 lds
  s_mov_b32 exec_hi, -1
  s_add_u32 s47, s47, 14336
  s_add_u32 s53, s53, 22528
  s_cmp_eq_u32 s53, 157696
  s_cselect_b32 s53, 0, s53
  s_add_u32 m0, s53, s46
  s_add_u32 s54, s53, s49
  buffer_load_dwordx4 v3, s[12:15], s45 offen offset:0 sc1 lds
  buffer_load_dwordx4 v3, s[12:15], s45 offen offset:1024 sc1 lds
  s_mov_b32 m0, s54
  s_add_u32 s45, s45, 8192
  buffer_load_dwordx4 v3, s[16:19], s47 offen offset:0 sc1 lds
  buffer_load_dwordx4 v3, s[16:19], s47 offen offset:1024 sc1 lds
  buffer_load_dwordx4 v3, s[16:19], s47 offen offset:2048 sc1 lds
  s_mov_b32 exec_hi, 0
  buffer_load_dwordx4 v3, s[16:19], s47 offen offset:3072 sc1 lds
  s_mov_b32 exec_hi, -1
  s_add_u32 s47, s47, 14336
  s_add_u32 s53, s53, 22528
  s_cmp_eq_u32 s53, 157696
  s_cselect_b32 s53, 0, s53
  s_waitcnt vmcnt(18)
  s_cmp_eq_u32 s55, 0
  s_cbranch_scc1 L_b1_nr2
  s_waitcnt vmcnt(0)
  s_mov_b32 s55, 0
L_b1_nr2:
  s_mov_b32 s66, 4194304
L_b1_val2:
  v_add_u32 v61, 45056, v60
  ds_read_b128 v[64:67], v61 offset:0
  ds_read_b128 v[68:71], v61 offset:1024
  s_waitcnt lgkmcnt(0)
  v_max3_u32 v62, v64, v65, v66
  v_max3_u32 v62, v62, v67, v68
  v_max3_u32 v62, v62, v69, v70
  v_max_u32 v62, v62, v71
  v_cmp_eq_u32 vcc, -1, v62
  s_sub_u32 s66, s66, 1
  s_cbranch_scc1 L_b1_ok2
  s_cmp_eq_u64 vcc, 0
  s_cbranch_scc1 L_b1_ok2
  s_add_u32 m0, s46, 45056
  s_add_u32 s63, s62, 16384
  buffer_load_dwordx4 v3, s[12:15], s63 offen offset:0 sc1 lds
  buffer_load_dwordx4 v3, s[12:15], s63 offen offset:1024 sc1 lds
  s_add_u32 m0, s46, 67584
  s_add_u32 s63, s62, 24576
  buffer_load_dwordx4 v3, s[12:15], s63 offen offset:0 sc1 lds
  buffer_load_dwordx4 v3, s[12:15], s63 offen offset:1024 sc1 lds
  s_add_u32 m0, s46, 90112
  s_add_u32 s63, s62, 32768
  buffer_load_dwordx4 v3, s[12:15], s63 offen offset:0 sc1 lds
  buffer_load_dwordx4 v3, s[12:15], s63 offen offset:1024 sc1 lds
  s_add_u32 m0, s46, 112640
  s_add_u32 s63, s62, 40960
  buffer_load_dwordx4 v3, s[12:15], s63 offen offset:0 sc1 lds
  buffer_load_dwordx4 v3, s[12:15], s63 offen offset:1024 sc1 lds
  s_waitcnt vmcnt(6)
  s_mov_b32 s55, 1
  s_branch L_b1_val2
L_b1_ok2:
  s_barrier
  s_add_u32 m0, s53, s46
  s_add_u32 s54, s53, s49
  buffer_load_dwordx4 v3, s[12:15], s45 offen offset:0 sc1 lds
  buffer_load_dwordx4 v3, s[12:15], s45 offen offset:1024 sc1 lds
  s_mov_b32 m0, s54
  s_add_u32 s45, s45, 8192
  buffer_load_dwordx4 v3, s[16:19], s47 offen offset:0 sc1 lds
  buffer_load_dwordx4 v3, s[16:19], s47 offen offset:1024 sc1 lds
  buffer_load_dwordx4 v3, s[16:19], s47 offen offset:2048 sc1 lds
  s_mov_b32 exec_hi, 0
  buffer_load_dwordx4 v3, s[16:19], s47 offen offset:3072 sc1 lds
  s_mov_b32 exec_hi, -1
  s_add_u32 s47, s47, 14336
  s_add_u32 s53, s53, 22528
  s_cmp_eq_u32 s53, 157696
  s_cselect_b32 s53, 0, s53
  s_add_u32 m0, s53, s46
  s_add_u32 s54, s53, s49
  buffer_load_dwordx4 v3, s[12:15], s45 offen offset:0 sc1 lds
  buffer_load_dwordx4 v3, s[12:15], s45 offen offset:1024 sc1 lds
  s_mov_b32 m0, s54
  s_add_u32 s45, s45, 8192
  buffer_load_dwordx4 v3, s[16:19], s47 offen offset:0 sc1 lds
  buffer_load_dwordx4 v3, s[16:19], s47 offen offset:1024 sc1 lds
  buffer_load_dwordx4 v3, s[16:19], s47 offen offset:2048 sc1 lds
  s_mov_b32 exec_hi, 0
  buffer_load_dwordx4 v3, s[16:19], s47 offen offset:3072 sc1 lds
  s_mov_b32 exec_hi, -1
  s_add_u32 s47, s47, 14336
  s_add_u32 s53, s53, 22528
  s_cmp_eq_u32 s53, 157696
  s_cselect_b32 s53, 0, s53
  s_waitcnt vmcnt(24)
  s_cmp_eq_u32 s55, 0
  s_cbranch_scc1 L_b1_nr3
  s_waitcnt vmcnt(0)
  s_mov_b32 s55, 0
L_b1_nr3:
  s_mov_b32 s66, 4194304
L_b1_val3:
  v_add_u32 v61, 67584, v60
  ds_read_b128 v[64:67], v61 offset:0
  ds_read_b128 v[68:71], v61 offset:1024
  s_waitcnt lgkmcnt(0)
  v_max3_u32 v62, v64, v65, v66
  v_max3_u32 v62, v62, v67, v68
  v_max3_u32 v62, v62, v69, v70
  v_max_u32 v62, v62, v71
  v_cmp_eq_u32 vcc, -1, v62
  s_sub_u32 s66, s66, 1
  s_cbranch_scc1 L_b1_ok3
  s_cmp_eq_u64 vcc, 0
  s_cbranch_scc1 L_b1_ok3
  s_add_u32 m0, s46, 67584
  s_add_u32 s63, s62, 24576
  buffer_load_dwordx4 v3, s[12:15], s63 offen offset:0 sc1 lds
  buffer_load_dwordx4 v3, s[12:15], s63 offen offset:1024 sc1 lds
  s_add_u32 m0, s46, 90112
  s_add_u32 s63, s62, 32768
  buffer_load_dwordx4 v3, s[12:15], s63 offen offset:0 sc1 lds
  buffer_load_dwordx4 v3, s[12:15], s63 offen offset:1024 sc1 lds
  s_add_u32 m0, s46, 112640
  s_add_u32 s63, s62, 40960
  buffer_load_dwordx4 v3, s[12:15], s63 offen offset:0 sc1 lds
  buffer_load_dwordx4 v3, s[12:15], s63 offen offset:1024 sc1 lds
  s_add_u32 m0, s46, 135168
  s_add_u32 s63, s62, 49152
  buffer_load_dwordx4 v3, s[12:15], s63 offen offset:0 sc1 lds
  buffer_load_dwordx4 v3, s[12:15], s63 offen offset:1024 sc1 lds
  s_add_u32 m0, s46, 0
  s_add_u32 s63, s62, 57344
  buffer_load_dwordx4 v3, s[12:15], s63 offen offset:0 sc1 lds
  buffer_load_dwordx4 v3, s[12:15], s63 offen offset:1024 sc1 lds
  s_waitcnt vmcnt(8)
  s_mov_b32 s55, 1
  s_branch L_b1_val3
L_b1_ok3:
  s_barrier
  s_add_u32 m0, s53, s46
  s_add_u32 s54, s53, s49
  buffer_load_dwordx4 v3, s[12:15], s45 offen offset:0 sc1 lds
  buffer_load_dwordx4 v3, s[12:15], s45 offen offset:1024 sc1 lds
  s_mov_b32 m0, s54
  s_add_u32 s45, s45, 8192
  buffer_load_dwordx4 v3, s[16:19], s47 offen offset:0 sc1 lds
  buffer_load_dwordx4 v3, s[16:19], s47 offen offset:1024 sc1 lds
  buffer_load_dwordx4 v3, s[16:19], s47 offen offset:2048 sc1 lds
  s_mov_b32 exec_hi, 0
  buffer_load_dwordx4 v3, s[16:19], s47 offen offset:3072 sc1 lds
  s_mov_b32 exec_hi, -1
  s_add_u32 s47, s47, 14336
  s_add_u32 s53, s53, 22528
  s_cmp_eq_u32 s53, 157696
  s_cselect_b32 s53, 0, s53
  s_add_u32 m0, s53, s46
  s_add_u32 s54, s53, s49
  buffer_load_dwordx4 v3, s[12:15], s45 offen offset:0 sc1 lds
  buffer_load_dwordx4 v3, s[12:15], s45 offen offset:1024 sc1 lds
  s_mov_b32 m0, s54
  s_add_u32 s45, s45, 8192
  buffer_load_dwordx4 v3, s[16:19], s47 offen offset:0 sc1 lds
  buffer_load_dwordx4 v3, s[16:19], s47 offen offset:1024 sc1 lds
  buffer_load_dwordx4 v3, s[16:19], s47 offen offset:2048 sc1 lds
  s_mov_b32 exec_hi, 0
  buffer_load_dwordx4 v3, s[16:19], s47 offen offset:3072 sc1 lds
  s_mov_b32 exec_hi, -1
  s_add_u32 s47, s47, 14336
  s_add_u32 s53, s53, 22528
  s_cmp_eq_u32 s53, 157696
  s_cselect_b32 s53, 0, s53
  s_waitcnt vmcnt(30)
  s_cmp_eq_u32 s55, 0
  s_cbranch_scc1 L_b1_nr4
  s_waitcnt vmcnt(0)
  s_mov_b32 s55, 0
L_b1_nr4:
  s_mov_b32 s66, 4194304
L_b1_val4:
  v_add_u32 v61, 90112, v60
  ds_read_b128 v[64:67], v61 offset:0
  ds_read_b128 v[68:71], v61 offset:1024
  s_waitcnt lgkmcnt(0)
  v_max3_u32 v62, v64, v65, v66
  v_max3_u32 v62, v62, v67, v68
  v_max3_u32 v62, v62, v69, v70
  v_max_u32 v62, v62, v71
  v_cmp_eq_u32 vcc, -1, v62
  s_sub_u32 s66, s66, 1
  s_cbranch_scc1 L_b1_ok4
  s_cmp_eq_u64 vcc, 0
  s_cbranch_scc1 L_b1_ok4
  s_add_u32 m0, s46, 90112
  s_add_u32 s63, s62, 32768
  buffer_load_dwordx4 v3, s[12:15], s63 offen offset:0 sc1 lds
  buffer_load_dwordx4 v3, s[12:15], s63 offen offset:1024 sc1 lds
  s_add_u32 m0, s46, 112640
  s_add_u32 s63, s62, 40960
  buffer_load_dwordx4 v3, s[12:15], s63 offen offset:0 sc1 lds
  buffer_load_dwordx4 v3, s[12:15], s63 offen offset:1024 sc1 lds
  s_add_u32 m0, s46, 135168
  s_add_u32 s63, s62, 49152
  buffer_load_dwordx4 v3, s[12:15], s63 offen offset:0 sc1 lds
  buffer_load_dwordx4 v3, s[12:15], s63 offen offset:1024 sc1 lds
  s_add_u32 m0, s46, 0
  s_add_u32 s63, s62, 57344
  buffer_load_dwordx4 v3, s[12:15], s63 offen offset:0 sc1 lds
  buffer_load_dwordx4 v3, s[12:15], s63 offen offset:1024 sc1 lds
  s_add_u32 m0, s46, 22528
  s_add_u32 s63, s62, 65536
  buffer_load_dwordx4 v3, s[12:15], s63 offen offset:0 sc1 lds
  buffer_load_dwordx4 v3, s[12:15], s63 offen offset:1024 sc1 lds
  s_add_u32 m0, s46, 45056
  s_add_u32 s63, s62, 73728
  buffer_load_dwordx4 v3, s[12:15], s63 offen offset:0 sc1 lds
  buffer_load_dwordx4 v3, s[12:15], s63 offen offset:1024 sc1 lds
  s_waitcnt vmcnt(10)
  s_mov_b32 s55, 1
  s_branch L_b1_val4
L_b1_ok4:
  s_barrier
  s_add_u32 m0, s53, s46
  s_add_u32 s54, s53, s49
  buffer_load_dwordx4 v3, s[12:15], s45 offen offset:0 sc1 lds
  buffer_load_dwordx4 v3, s[12:15], s45 offen offset:1024 sc1 lds
  s_mov_b32 m0, s54
  s_add_u32 s45, s45, 8192
  buffer_load_dwordx4 v3, s[16:19], s47 offen offset:0 sc1 lds
  buffer_load_dwordx4 v3, s[16:19], s47 offen offset:1024 sc1 lds
  buffer_load_dwordx4 v3, s[16:19], s47 offen offset:2048 sc1 lds
  s_mov_b32 exec_hi, 0
  buffer_load_dwordx4 v3, s[16:19], s47 offen offset:3072 sc1 lds
  s_mov_b32 exec_hi, -1
  s_add_u32 s47, s47, 14336
  s_add_u32 s53, s53, 22528
  s_cmp_eq_u32 s53, 157696
  s_cselect_b32 s53, 0, s53
  s_waitcnt vmcnt(30)
  s_cmp_eq_u32 s55, 0
  s_cbranch_scc1 L_b1_nr5
  s_waitcnt vmcnt(0)
  s_mov_b32 s55, 0
L_b1_nr5:
  s_mov_b32 s66, 4194304
L_b1_val5:
  v_add_u32 v61, 112640, v60
  ds_read_b128 v[64:67], v61 offset:0
  ds_read_b128 v[68:71], v61 offset:1024
  s_waitcnt lgkmcnt(0)
  v_max3_u32 v62, v64, v65, v66
  v_max3_u32 v62, v62, v67, v68
  v_max3_u32 v62, v62, v69, v70
  v_max_u32 v62, v62, v71
  v_cmp_eq_u32 vcc, -1, v62
  s_sub_u32 s66, s66, 1
  s_cbranch_scc1 L_b1_ok5
  s_cmp_eq_u64 vcc, 0
  s_cbranch_scc1 L_b1_ok5
  s_add_u32 m0, s46, 112640
  s_add_u32 s63, s62, 40960
  buffer_load_dwordx4 v3, s[12:15], s63 offen offset:0 sc1 lds
  buffer_load_dwordx4 v3, s[12:15], s63 offen offset:1024 sc1 lds
  s_add_u32 m0, s46, 135168
  s_add_u32 s63, s62, 49152
  buffer_load_dwordx4 v3, s[12:15], s63 offen offset:0 sc1 lds
  buffer_load_dwordx4 v3, s[12:15], s63 offen offset:1024 sc1 lds
  s_add_u32 m0, s46, 0
  s_add_u32 s63, s62, 57344
  buffer_load_dwordx4 v3, s[12:15], s63 offen offset:0 sc1 lds
  buffer_load_dwordx4 v3, s[12:15], s63 offen offset:1024 sc1 lds
  s_add_u32 m0, s46, 22528
  s_add_u32 s63, s62, 65536
  buffer_load_dwordx4 v3, s[12:15], s63 offen offset:0 sc1 lds
  buffer_load_dwordx4 v3, s[12:15], s63 offen offset:1024 sc1 lds
  s_add_u32 m0, s46, 45056
  s_add_u32 s63, s62, 73728
  buffer_load_dwordx4 v3, s[12:15], s63 offen offset:0 sc1 lds
  buffer_load_dwordx4 v3, s[12:15], s63 offen offset:1024 sc1 lds
  s_add_u32 m0, s46, 67584
  s_add_u32 s63, s62, 81920
  buffer_load_dwordx4 v3, s[12:15], s63 offen offset:0 sc1 lds
  buffer_load_dwordx4 v3, s[12:15], s63 offen offset:1024 sc1 lds
  s_waitcnt vmcnt(10)
  s_mov_b32 s55, 1
  s_branch L_b1_val5
L_b1_ok5:
  s_barrier
  s_waitcnt vmcnt(24)
  s_cmp_eq_u32 s55, 0
  s_cbranch_scc1 L_b1_nr6
  s_waitcnt vmcnt(0)
  s_mov_b32 s55, 0
L_b1_nr6:
  s_mov_b32 s66, 4194304
L_b1_val6:
  v_add_u32 v61, 135168, v60
  ds_read_b128 v[64:67], v61 offset:0
  ds_read_b128 v[68:71], v61 offset:1024
  s_waitcnt lgkmcnt(0)
  v_max3_u32 v62, v64, v65, v66
  v_max3_u32 v62, v62, v67, v68
  v_max3_u32 v62, v62, v69, v70
  v_max_u32 v62, v62, v71
  v_cmp_eq_u32 vcc, -1, v62
  s_sub_u32 s66, s66, 1
  s_cbranch_scc1 L_b1_ok6
  s_cmp_eq_u64 vcc, 0
  s_cbranch_scc1 L_b1_ok6
  s_add_u32 m0, s46, 135168
  s_add_u32 s63, s62, 49152
  buffer_load_dwordx4 v3, s[12:15], s63 offen offset:0 sc1 lds
  buffer_load_dwordx4 v3, s[12:15], s63 offen offset:1024 sc1 lds
  s_add_u32 m0, s46, 0
  s_add_u32 s63, s62, 57344
  buffer_load_dwordx4 v3, s[12:15], s63 offen offset:0 sc1 lds
  buffer_load_dwordx4 v3, s[12:15], s63 offen offset:1024 sc1 lds
  s_add_u32 m0, s46, 22528
  s_add_u32 s63, s62, 65536
  buffer_load_dwordx4 v3, s[12:15], s63 offen offset:0 sc1 lds
  buffer_load_dwordx4 v3, s[12:15], s63 offen offset:1024 sc1 lds
  s_add_u32 m0, s46, 45056
  s_add_u32 s63, s62, 73728
  buffer_load_dwordx4 v3, s[12:15], s63 offen offset:0 sc1 lds
  buffer_load_dwordx4 v3, s[12:15], s63 offen offset:1024 sc1 lds
  s_add_u32 m0, s46, 67584
  s_add_u32 s63, s62, 81920
  buffer_load_dwordx4 v3, s[12:15], s63 offen offset:0 sc1 lds
  buffer_load_dwordx4 v3, s[12:15], s63 offen offset:1024 sc1 lds
  s_waitcnt vmcnt(8)
  s_mov_b32 s55, 1
  s_branch L_b1_val6
L_b1_ok6:
  s_barrier
  s_waitcnt vmcnt(18)
  s_cmp_eq_u32 s55, 0
  s_cbranch_scc1 L_b1_nr7
  s_waitcnt vmcnt(0)
  s_mov_b32 s55, 0
L_b1_nr7:
  s_mov_b32 s66, 4194304
L_b1_val7:
  v_add_u32 v61, 0, v60
  ds_read_b128 v[64:67], v61 offset:0
  ds_read_b128 v[68:71], v61 offset:1024
  s_waitcnt lgkmcnt(0)
  v_max3_u32 v62, v64, v65, v66
  v_max3_u32 v62, v62, v67, v68
  v_max3_u32 v62, v62, v69, v70
  v_max_u32 v62, v62, v71
  v_cmp_eq_u32 vcc, -1, v62
  s_sub_u32 s66, s66, 1
  s_cbranch_scc1 L_b1_ok7
  s_cmp_eq_u64 vcc, 0
  s_cbranch_scc1 L_b1_ok7
  s_add_u32 m0, s46, 0
  s_add_u32 s63, s62, 57344
  buffer_load_dwordx4 v3, s[12:15], s63 offen offset:0 sc1 lds
  buffer_load_dwordx4 v3, s[12:15], s63 offen offset:1024 sc1 lds
  s_add_u32 m0, s46, 22528
  s_add_u32 s63, s62, 65536
  buffer_load_dwordx4 v3, s[12:15], s63 offen offset:0 sc1 lds
  buffer_load_dwordx4 v3, s[12:15], s63 offen offset:1024 sc1 lds
  s_add_u32 m0, s46, 45056
  s_add_u32 s63, s62, 73728
  buffer_load_dwordx4 v3, s[12:15], s63 offen offset:0 sc1 lds
  buffer_load_dwordx4 v3, s[12:15], s63 offen offset:1024 sc1 lds
  s_add_u32 m0, s46, 67584
  s_add_u32 s63, s62, 81920
  buffer_load_dwordx4 v3, s[12:15], s63 offen offset:0 sc1 lds
  buffer_load_dwordx4 v3, s[12:15], s63 offen offset:1024 sc1 lds
  s_waitcnt vmcnt(6)
  s_mov_b32 s55, 1
  s_branch L_b1_val7
L_b1_ok7:
  s_barrier
  s_add_u32 m0, s53, s46
  s_add_u32 s54, s53, s49
  buffer_load_dwordx4 v3, s[12:15], s45 offen offset:0 sc1 lds
  buffer_load_dwordx4 v3, s[12:15], s45 offen offset:1024 sc1 lds
  s_mov_b32 m0, s54
  s_add_u32 s45, s45, 8192
  buffer_load_dwordx4 v3, s[16:19], s47 offen offset:0 sc1 lds
  buffer_load_dwordx4 v3, s[16:19], s47 offen offset:1024 sc1 lds
  buffer_load_dwordx4 v3, s[16:19], s47 offen offset:2048 sc1 lds
  s_mov_b32 exec_hi, 0
  buffer_load_dwordx4 v3, s[16:19], s47 offen offset:3072 sc1 lds
  s_mov_b32 exec_hi, -1
  s_add_u32 s47, s47, 14336
  s_add_u32 s53, s53, 22528
  s_cmp_eq_u32 s53, 157696
  s_cselect_b32 s53, 0, s53
  s_add_u32 m0, s53, s46
  s_add_u32 s54, s53, s49
  buffer_load_dwordx4 v3, s[12:15], s45 offen offset:0 sc1 lds
  buffer_load_dwordx4 v3, s[12:15], s45 offen offset:1024 sc1 lds
  s_mov_b32 m0, s54
  s_add_u32 s45, s45, 8192
  buffer_load_dwordx4 v3, s[16:19], s47 offen offset:0 sc1 lds
  buffer_load_dwordx4 v3, s[16:19], s47 offen offset:1024 sc1 lds
  buffer_load_dwordx4 v3, s[16:19], s47 offen offset:2048 sc1 lds
  s_mov_b32 exec_hi, 0
  buffer_load_dwordx4 v3, s[16:19], s47 offen offset:3072 sc1 lds
  s_mov_b32 exec_hi, -1
  s_add_u32 s47, s47, 14336
  s_add_u32 s53, s53, 22528
  s_cmp_eq_u32 s53, 157696
  s_cselect_b32 s53, 0, s53
  s_add_u32 m0, s53, s46
  s_add_u32 s54, s53, s49
  buffer_load_dwordx4 v3, s[12:15], s45 offen offset:0 sc1 lds
  buffer_load_dwordx4 v3, s[12:15], s45 offen offset:1024 sc1 lds
  s_mov_b32 m0, s54
  s_add_u32 s45, s45, 8192
  buffer_load_dwordx4 v3, s[16:19], s47 offen offset:0 sc1 lds
  buffer_load_dwordx4 v3, s[16:19], s47 offen offset:1024 sc1 lds
  buffer_load_dwordx4 v3, s[16:19], s47 offen offset:2048 sc1 lds
  s_mov_b32 exec_hi, 0
  buffer_load_dwordx4 v3, s[16:19], s47 offen offset:3072 sc1 lds
  s_mov_b32 exec_hi, -1
  s_add_u32 s47, s47, 14336
  s_add_u32 s53, s53, 22528
  s_cmp_eq_u32 s53, 157696
  s_cselect_b32 s53, 0, s53
  s_waitcnt vmcnt(30)
  s_cmp_eq_u32 s55, 0
  s_cbranch_scc1 L_b1_nr8
  s_waitcnt vmcnt(0)
  s_mov_b32 s55, 0
L_b1_nr8:
  s_mov_b32 s66, 4194304
L_b1_val8:
  v_add_u32 v61, 22528, v60
  ds_read_b128 v[64:67], v61 offset:0
  ds_read_b128 v[68:71], v61 offset:1024
  s_waitcnt lgkmcnt(0)
  v_max3_u32 v62, v64, v65, v66
  v_max3_u32 v62, v62, v67, v68
  v_max3_u32 v62, v62, v69, v70
  v_max_u32 v62, v62, v71
  v_cmp_eq_u32 vcc, -1, v62
  s_sub_u32 s66, s66, 1
  s_cbranch_scc1 L_b1_ok8
  s_cmp_eq_u64 vcc, 0
  s_cbranch_scc1 L_b1_ok8
  s_add_u32 m0, s46, 22528
  s_add_u32 s63, s62, 65536
  buffer_load_dwordx4 v3, s[12:15], s63 offen offset:0 sc1 lds
  buffer_load_dwordx4 v3, s[12:15], s63 offen offset:1024 sc1 lds
  s_add_u32 m0, s46, 45056
  s_add_u32 s63, s62, 73728
  buffer_load_dwordx4 v3, s[12:15], s63 offen offset:0 sc1 lds
  buffer_load_dwordx4 v3, s[12:15], s63 offen offset:1024 sc1 lds
  s_add_u32 m0, s46, 67584
  s_add_u32 s63, s62, 81920
  buffer_load_dwordx4 v3, s[12:15], s63 offen offset:0 sc1 lds
  buffer_load_dwordx4 v3, s[12:15], s63 offen offset:1024 sc1 lds
  s_waitcnt vmcnt(4)
  s_mov_b32 s55, 1
  s_branch L_b1_val8
L_b1_ok8:
  s_barrier
  s_add_u32 m0, s53, s46
  s_add_u32 s54, s53, s49
  buffer_load_dwordx4 v3, s[12:15], s45 offen offset:0 sc1 lds
  buffer_load_dwordx4 v3, s[12:15], s45 offen offset:1024 sc1 lds
  s_mov_b32 m0, s54
  s_add_u32 s45, s45, 8192
  buffer_load_dwordx4 v3, s[16:19], s47 offen offset:0 sc1 lds
  buffer_load_dwordx4 v3, s[16:19], s47 offen offset:1024 sc1 lds
  buffer_load_dwordx4 v3, s[16:19], s47 offen offset:2048 sc1 lds
  s_mov_b32 exec_hi, 0
  buffer_load_dwordx4 v3, s[16:19], s47 offen offset:3072 sc1 lds
  s_mov_b32 exec_hi, -1
  s_add_u32 s47, s47, 14336
  s_add_u32 s53, s53, 22528
  s_cmp_eq_u32 s53, 157696
  s_cselect_b32 s53, 0, s53
  s_waitcnt vmcnt(30)
  s_cmp_eq_u32 s55, 0
  s_cbranch_scc1 L_b1_nr9
  s_waitcnt vmcnt(0)
  s_mov_b32 s55, 0
L_b1_nr9:
  s_mov_b32 s66, 4194304
L_b1_val9:
  v_add_u32 v61, 45056, v60
  ds_read_b128 v[64:67], v61 offset:0
  ds_read_b128 v[68:71], v61 offset:1024
  s_waitcnt lgkmcnt(0)
  v_max3_u32 v62, v64, v65, v66
  v_max3_u32 v62, v62, v67, v68
  v_max3_u32 v62, v62, v69, v70
  v_max_u32 v62, v62, v71
  v_cmp_eq_u32 vcc, -1, v62
  s_sub_u32 s66, s66, 1
  s_cbranch_scc1 L_b1_ok9
  s_cmp_eq_u64 vcc, 0
  s_cbranch_scc1 L_b1_ok9
  s_add_u32 m0, s46, 45056
  s_add_u32 s63, s62, 73728
  buffer_load_dwordx4 v3, s[12:15], s63 offen offset:0 sc1 lds
  buffer_load_dwordx4 v3, s[12:15], s63 offen offset:1024 sc1 lds
  s_add_u32 m0, s46, 67584
  s_add_u32 s63, s62, 81920
  buffer_load_dwordx4 v3, s[12:15], s63 offen offset:0 sc1 lds
  buffer_load_dwordx4 v3, s[12:15], s63 offen offset:1024 sc1 lds
  s_waitcnt vmcnt(2)
  s_mov_b32 s55, 1
  s_branch L_b1_val9
L_b1_ok9:
  s_barrier
  s_add_u32 m0, s53, s46
  s_add_u32 s54, s53, s49
  buffer_load_dwordx4 v3, s[12:15], s45 offen offset:0 sc1 lds
  buffer_load_dwordx4 v3, s[12:15], s45 offen offset:1024 sc1 lds
  s_mov_b32 m0, s54
  s_add_u32 s45, s45, 8192
  buffer_load_dwordx4 v3, s[16:19], s47 offen offset:0 sc1 lds
  buffer_load_dwordx4 v3, s[16:19], s47 offen offset:1024 sc1 lds
  buffer_load_dwordx4 v3, s[16:19], s47 offen offset:2048 sc1 lds
  s_mov_b32 exec_hi, 0
  buffer_load_dwordx4 v3, s[16:19], s47 offen offset:3072 sc1 lds
  s_mov_b32 exec_hi, -1
  s_add_u32 s47, s47, 14336
  s_add_u32 s53, s53, 22528
  s_cmp_eq_u32 s53, 157696
  s_cselect_b32 s53, 0, s53
  s_waitcnt vmcnt(30)
  s_cmp_eq_u32 s55, 0
  s_cbranch_scc1 L_b1_nr10
  s_waitcnt vmcnt(0)
  s_mov_b32 s55, 0
L_b1_nr10:
  s_mov_b32 s66, 4194304
L_b1_val10:
  v_add_u32 v61, 67584, v60
  ds_read_b128 v[64:67], v61 offset:0
  ds_read_b128 v[68:71], v61 offset:1024
  s_waitcnt lgkmcnt(0)
  v_max3_u32 v62, v64, v65, v66
  v_max3_u32 v62, v62, v67, v68
  v_max3_u32 v62, v62, v69, v70
  v_max_u32 v62, v62, v71
  v_cmp_eq_u32 vcc, -1, v62
  s_sub_u32 s66, s66, 1
  s_cbranch_scc1 L_b1_ok10
  s_cmp_eq_u64 vcc, 0
  s_cbranch_scc1 L_b1_ok10
  s_add_u32 m0, s46, 67584
  s_add_u32 s63, s62, 81920
  buffer_load_dwordx4 v3, s[12:15], s63 offen offset:0 sc1 lds
  buffer_load_dwordx4 v3, s[12:15], s63 offen offset:1024 sc1 lds
  s_waitcnt vmcnt(0)
  s_mov_b32 s55, 1
  s_branch L_b1_val10
L_b1_ok10:
  s_barrier
  s_add_u32 m0, s53, s46
  s_add_u32 s54, s53, s49
  buffer_load_dwordx4 v3, s[12:15], s45 offen offset:0 sc1 lds
  buffer_load_dwordx4 v3, s[12:15], s45 offen offset:1024 sc1 lds
  s_mov_b32 m0, s54
  s_add_u32 s45, s45, 8192
  buffer_load_dwordx4 v3, s[16:19], s47 offen offset:0 sc1 lds
  buffer_load_dwordx4 v3, s[16:19], s47 offen offset:1024 sc1 lds
  buffer_load_dwordx4 v3, s[16:19], s47 offen offset:2048 sc1 lds
  s_mov_b32 exec_hi, 0
  buffer_load_dwordx4 v3, s[16:19], s47 offen offset:3072 sc1 lds
  s_mov_b32 exec_hi, -1
  s_add_u32 s47, s47, 14336
  s_add_u32 s53, s53, 22528
  s_cmp_eq_u32 s53, 157696
  s_cselect_b32 s53, 0, s53
  s_mov_b32 s56, 15
L_b1_lloop:
  s_waitcnt vmcnt(30)
  s_barrier
  s_add_u32 m0, s53, s46
  s_add_u32 s54, s53, s49
  buffer_load_dwordx4 v3, s[12:15], s45 offen offset:0 sc1 lds
  buffer_load_dwordx4 v3, s[12:15], s45 offen offset:1024 sc1 lds
  s_mov_b32 m0, s54
  s_add_u32 s45, s45, 8192
  buffer_load_dwordx4 v3, s[16:19], s47 offen offset:0 sc1 lds
  buffer_load_dwordx4 v3, s[16:19], s47 offen offset:1024 sc1 lds
  buffer_load_dwordx4 v3, s[16:19], s47 offen offset:2048 sc1 lds
  s_mov_b32 exec_hi, 0
  buffer_load_dwordx4 v3, s[16:19], s47 offen offset:3072 sc1 lds
  s_mov_b32 exec_hi, -1
  s_add_u32 s47, s47, 14336
  s_add_u32 s53, s53, 22528
  s_cmp_eq_u32 s53, 157696
  s_cselect_b32 s53, 0, s53
  s_sub_u32 s56, s56, 1
  s_cmp_lg_u32 s56, 0
  s_cbranch_scc1 L_b1_lloop
  s_waitcnt vmcnt(30)
  s_barrier
  s_add_u32 s32, s10, 524288
  s_addc_u32 s33, s11, 0
  s_and_b32 s33, s33, 0xffff
  s_mov_b32 s34, 524288
  s_mov_b32 s35, 0x20000
  s_lshl_b32 s67, s40, 15
  s_lshl_b32 s58, s43, 8
  s_add_u32 s67, s67, s58
  v_and_b32 v4, 15, v2
  v_lshrrev_b32 v5, 4, v2
  v_lshlrev_b32 v44, 10, v5
  v_lshl_add_u32 v44, v4, 4, v44
  s_add_u32 s58, s67, 0
  buffer_load_dwordx4 v[8:11], v44, s[32:35], s58 offen sc1
  s_add_u32 s58, s67, 4096
  buffer_load_dwordx4 v[12:15], v44, s[32:35], s58 offen sc1
  s_add_u32 s58, s67, 8192
  buffer_load_dwordx4 v[16:19], v44, s[32:35], s58 offen sc1
  s_add_u32 s58, s67, 12288
  buffer_load_dwordx4 v[20:23], v44, s[32:35], s58 offen sc1
  s_add_u32 s58, s67, 16384
  buffer_load_dwordx4 v[24:27], v44, s[32:35], s58 offen sc1
  s_add_u32 s58, s67, 20480
  buffer_load_dwordx4 v[28:31], v44, s[32:35], s58 offen sc1
  s_add_u32 s58, s67, 24576
  buffer_load_dwordx4 v[32:35], v44, s[32:35], s58 offen sc1
  s_add_u32 s58, s67, 28672
  buffer_load_dwordx4 v[36:39], v44, s[32:35], s58 offen sc1
  s_waitcnt vmcnt(32)
  s_barrier
  s_add_u32 s36, s10, 56623104
  s_addc_u32 s37, s11, 0
  s_and_b32 s37, s37, 0xffff
  s_mov_b32 s38, 917504
  s_mov_b32 s39, 0x20000
  s_and_b32 s58, s43, 1
  s_mul_i32 s58, s58, 14336
  s_lshr_b32 s59, s43, 1
  s_mul_i32 s59, s59, 448
  s_add_u32 s58, s58, s59
  s_mul_i32 s59, s41, 896
  s_add_u32 s58, s58, s59
  v_and_b32 v45, 0x1f0, v3
  v_lshrrev_b32 v46, 5, v2
  v_mul_u32_u24 v46, 28672, v46
  v_add_u32 v46, v46, v45
  buffer_load_dwordx4 v[100:103], v46, s[36:39], s58 offen sc1
  s_add_u32 s58, s58, 57344
  buffer_load_dwordx4 v[104:107], v46, s[36:39], s58 offen sc1
  s_add_u32 s58, s58, 57344
  buffer_load_dwordx4 v[108:111], v46, s[36:39], s58 offen sc1
  s_add_u32 s58, s58, 57344
  buffer_load_dwordx4 v[112:115], v46, s[36:39], s58 offen sc1
  s_add_u32 s58, s58, 57344
  buffer_load_dwordx4 v[116:119], v46, s[36:39], s58 offen sc1
  s_add_u32 s58, s58, 57344
  buffer_load_dwordx4 v[120:123], v46, s[36:39], s58 offen sc1
  s_add_u32 s58, s58, 57344
  buffer_load_dwordx4 v[124:127], v46, s[36:39], s58 offen sc1
  s_add_u32 s58, s58, 57344
  buffer_load_dwordx4 v[128:131], v46, s[36:39], s58 offen sc1
  s_add_u32 s58, s58, 57344
  buffer_load_dwordx4 v[132:135], v46, s[36:39], s58 offen sc1
  s_add_u32 s58, s58, 57344
  buffer_load_dwordx4 v[136:139], v46, s[36:39], s58 offen sc1
  s_add_u32 s58, s58, 57344
  buffer_load_dwordx4 v[140:143], v46, s[36:39], s58 offen sc1
  s_add_u32 s58, s58, 57344
  buffer_load_dwordx4 v[144:147], v46, s[36:39], s58 offen sc1
  s_add_u32 s58, s58, 57344
  buffer_load_dwordx4 v[148:151], v46, s[36:39], s58 offen sc1
  s_add_u32 s58, s58, 57344
  buffer_load_dwordx4 v[152:155], v46, s[36:39], s58 offen sc1
  s_add_u32 s58, s58, 57344
  buffer_load_dwordx4 v[156:159], v46, s[36:39], s58 offen sc1
  s_add_u32 s58, s58, 57344
  buffer_load_dwordx4 v[160:163], v46, s[36:39], s58 offen sc1
  s_add_u32 s58, s58, 57344
  s_waitcnt vmcnt(42)
  s_barrier
  s_add_u32 s28, s10, 45088768
  s_addc_u32 s29, s11, 0
  s_and_b32 s29, s29, 0xffff
  s_mov_b32 s30, 7340032
  s_mov_b32 s31, 0x20000
  s_lshr_b32 s58, s2, 5
  s_lshl_b32 s58, s58, 1
  s_and_b32 s59, s2, 1
  s_add_u32 s58, s58, s59
  s_mul_i32 s58, s58, 458752
  s_bfe_u32 s59, s2, 0x20003
  s_lshl_b32 s59, s59, 2
  s_add_u32 s59, s59, s43
  s_lshl_b32 s59, s59, 13
  s_add_u32 s58, s58, s59
  buffer_load_dword v47, v6, s[28:31], s58 offen sc1
  s_add_u32 s58, s58, 131072
  buffer_load_dword v47, v6, s[28:31], s58 offen sc1
  s_add_u32 s58, s58, 131072
  s_waitcnt vmcnt(38)
  s_barrier
  s_waitcnt vmcnt(32)
  s_barrier
  s_waitcnt vmcnt(18)
  v_pk_add_f32 v[8:9], v[8:9], v[12:13]
  v_pk_add_f32 v[10:11], v[10:11], v[14:15]
  v_pk_add_f32 v[8:9], v[8:9], v[16:17]
  v_pk_add_f32 v[10:11], v[10:11], v[18:19]
  v_pk_add_f32 v[8:9], v[8:9], v[20:21]
  v_pk_add_f32 v[10:11], v[10:11], v[22:23]
  v_pk_add_f32 v[8:9], v[8:9], v[24:25]
  v_pk_add_f32 v[10:11], v[10:11], v[26:27]
  v_pk_add_f32 v[8:9], v[8:9], v[28:29]
  v_pk_add_f32 v[10:11], v[10:11], v[30:31]
  v_pk_add_f32 v[8:9], v[8:9], v[32:33]
  v_pk_add_f32 v[10:11], v[10:11], v[34:35]
  v_pk_add_f32 v[8:9], v[8:9], v[36:37]
  v_pk_add_f32 v[10:11], v[10:11], v[38:39]
  s_lshl_b32 s58, s43, 8
  s_add_u32 s58, s58, 160768
  v_permlane16_swap_b32 v8, v10
  v_permlane16_swap_b32 v9, v11
  v_pk_add_f32 v[8:9], v[8:9], v[10:11]
  v_and_b32 v5, 1, v5
  v_lshlrev_b32 v5, 3, v5
  v_mov_b64 v[10:11], v[8:9]
  v_lshl_add_u32 v5, v4, 4, v5
  v_add_u32 v5, s58, v5
  v_permlane32_swap_b32 v8, v10
  v_permlane32_swap_b32 v9, v11
  v_pk_add_f32 v[8:9], v[8:9], v[10:11]
  v_mul_f32 v10, 0xba800000, v8
  v_mul_f32 v9, 0x3a800000, v9
  v_fma_f32 v9, -v10, v10, v9
  v_max_f32 v9, 0, v9
  v_cvt_pk_bf16_f32 v9, v9, v9
  v_and_b32 v9, 0xffff0000, v9
  v_add_f32 v9, 0x3727c5ac, v9
  v_cvt_pk_bf16_f32 v9, v9, v9
  v_and_b32 v9, 0xffff0000, v9
  v_sqrt_f32 v9, v9
  s_nop 0
  v_cvt_pk_bf16_f32 v9, v9, v9
  v_and_b32 v9, 0xffff0000, v9
  v_rcp_f32 v9, v9
  v_cvt_pk_bf16_f32 v10, v10, v10
  v_and_b32 v10, 0xffff0000, v10
  v_mul_f32 v8, v10, v9
  ds_write_b64 v5, v[8:9]
  s_waitcnt vmcnt(26)
  s_barrier
  s_waitcnt vmcnt(2)
  v_pk_add_f32 v[100:101], v[100:101], v[104:105]
  v_pk_add_f32 v[102:103], v[102:103], v[106:107]
  v_pk_add_f32 v[100:101], v[100:101], v[108:109]
  v_pk_add_f32 v[102:103], v[102:103], v[110:111]
  v_pk_add_f32 v[100:101], v[100:101], v[112:113]
  v_pk_add_f32 v[102:103], v[102:103], v[114:115]
  v_pk_add_f32 v[100:101], v[100:101], v[116:117]
  v_pk_add_f32 v[102:103], v[102:103], v[118:119]
  v_pk_add_f32 v[100:101], v[100:101], v[120:121]
  v_pk_add_f32 v[102:103], v[102:103], v[122:123]
  v_pk_add_f32 v[100:101], v[100:101], v[124:125]
  v_pk_add_f32 v[102:103], v[102:103], v[126:127]
  v_pk_add_f32 v[100:101], v[100:101], v[128:129]
  v_pk_add_f32 v[102:103], v[102:103], v[130:131]
  v_pk_add_f32 v[100:101], v[100:101], v[132:133]
  v_pk_add_f32 v[102:103], v[102:103], v[134:135]
  v_pk_add_f32 v[100:101], v[100:101], v[136:137]
  v_pk_add_f32 v[102:103], v[102:103], v[138:139]
  v_pk_add_f32 v[100:101], v[100:101], v[140:141]
  v_pk_add_f32 v[102:103], v[102:103], v[142:143]
  v_pk_add_f32 v[100:101], v[100:101], v[144:145]
  v_pk_add_f32 v[102:103], v[102:103], v[146:147]
  v_pk_add_f32 v[100:101], v[100:101], v[148:149]
  v_pk_add_f32 v[102:103], v[102:103], v[150:151]
  v_pk_add_f32 v[100:101], v[100:101], v[152:153]
  v_pk_add_f32 v[102:103], v[102:103], v[154:155]
  v_pk_add_f32 v[100:101], v[100:101], v[156:157]
  v_pk_add_f32 v[102:103], v[102:103], v[158:159]
  v_pk_add_f32 v[100:101], v[100:101], v[160:161]
  v_pk_add_f32 v[102:103], v[102:103], v[162:163]
  s_and_b32 s58, s43, 1
  s_mul_i32 s58, s58, 896
  s_lshr_b32 s59, s43, 1
  s_mul_i32 s59, s59, 448
  s_add_u32 s58, s58, s59
  s_add_u32 s58, s58, 157696
  v_mov_b64 v[104:105], v[100:101]
  v_mov_b64 v[106:107], v[102:103]
  v_add_u32 v45, s58, v45
  s_nop 0
  v_permlane32_swap_b32 v100, v104
  v_permlane32_swap_b32 v101, v105
  v_permlane32_swap_b32 v102, v106
  v_permlane32_swap_b32 v103, v107
  v_pk_add_f32 v[100:101], v[100:101], v[104:105]
  v_pk_add_f32 v[102:103], v[102:103], v[106:107]
  s_mov_b64 exec, 0xfffffff
  ds_write_b128 v45, v[100:103]
  s_mov_b64 exec, -1
  s_waitcnt lgkmcnt(0)
  s_waitcnt vmcnt(26)
  s_barrier
  s_and_b32 s61, s2, 1
  s_bfe_u32 s40, s2, 0x20001
  s_lshl_b32 s40, s40, 2
  s_bfe_u32 s3, s2, 0x20003
  s_add_u32 s40, s40, s3
  s_lshr_b32 s41, s2, 5
  s_add_u32 s12, s10, 18874368
  s_addc_u32 s13, s11, 0
  s_and_b32 s13, s13, 0xffff
  s_mov_b32 s14, 14680064
  s_mov_b32 s15, 0x20000
  s_add_u32 s16, s10, 45088768
  s_addc_u32 s17, s11, 0
  s_and_b32 s17, s17, 0xffff
  s_mov_b32 s18, 7340032
  s_mov_b32 s19, 0x20000
  v_and_b32 v6, 0xf80, v6
  s_lshl_b32 s57, s40, 13
  s_lshl_b32 s58, s61, 12
  s_add_u32 s57, s57, s58
  s_add_u32 s57, s57, 131072
  s_sub_u32 s43, s42, 4
  s_mul_i32 s45, s40, 917504
  s_mul_i32 s46, s43, 4096
  s_add_u32 s45, s45, s46
  s_mul_i32 s47, s41, 917504
  s_mul_i32 s49, s43, 4096
  s_add_u32 s47, s47, s49
  s_add_u32 s49, s49, 16384
  s_mov_b32 s53, 0
  s_mul_i32 s48, s61, 458752
  s_add_u32 s45, s45, s48
  s_mul_i32 s48, s61, 458752
  s_add_u32 s47, s47, s48
  s_mov_b32 s62, s45
  s_add_u32 m0, s49, 0
  s_nop 0
  buffer_load_dwordx4 v3, s[16:19], s47 offen offset:0 sc1 lds
  buffer_load_dwordx4 v3, s[16:19], s47 offen offset:1024 sc1 lds
  buffer_load_dwordx4 v3, s[16:19], s47 offen offset:2048 sc1 lds
  buffer_load_dwordx4 v3, s[16:19], s47 offen offset:3072 sc1 lds
  s_add_u32 s47, s47, 16384
  s_add_u32 m0, s49, 32768
  s_nop 0
  buffer_load_dwordx4 v3, s[16:19], s47 offen offset:0 sc1 lds
  buffer_load_dwordx4 v3, s[16:19], s47 offen offset:1024 sc1 lds
  buffer_load_dwordx4 v3, s[16:19], s47 offen offset:2048 sc1 lds
  buffer_load_dwordx4 v3, s[16:19], s47 offen offset:3072 sc1 lds
  s_add_u32 s47, s47, 16384
  s_add_u32 m0, s49, 65536
  s_nop 0
  buffer_load_dwordx4 v3, s[16:19], s47 offen offset:0 sc1 lds
  buffer_load_dwordx4 v3, s[16:19], s47 offen offset:1024 sc1 lds
  buffer_load_dwordx4 v3, s[16:19], s47 offen offset:2048 sc1 lds
  buffer_load_dwordx4 v3, s[16:19], s47 offen offset:3072 sc1 lds
  s_add_u32 s47, s47, 16384
  s_barrier
  s_mov_b32 s55, 0
  v_add_u32 v60, s46, v3
  s_add_u32 m0, s53, s46
  s_nop 0
  buffer_load_dwordx4 v3, s[12:15], s45 offen offset:0 sc1 lds
  buffer_load_dwordx4 v3, s[12:15], s45 offen offset:1024 sc1 lds
  buffer_load_dwordx4 v3, s[12:15], s45 offen offset:2048 sc1 lds
  buffer_load_dwordx4 v3, s[12:15], s45 offen offset:3072 sc1 lds
  s_add_u32 s45, s45, 16384
  s_add_u32 s53, s53, 32768
  s_cmp_eq_u32 s53, 131072
  s_cselect_b32 s53, 0, s53
  s_add_u32 m0, s53, s46
  s_nop 0
  buffer_load_dwordx4 v3, s[12:15], s45 offen offset:0 sc1 lds
  buffer_load_dwordx4 v3, s[12:15], s45 offen offset:1024 sc1 lds
  buffer_load_dwordx4 v3, s[12:15], s45 offen offset:2048 sc1 lds
  buffer_load_dwordx4 v3, s[12:15], s45 offen offset:3072 sc1 lds
  s_add_u32 s45, s45, 16384
  s_add_u32 s53, s53, 32768
  s_cmp_eq_u32 s53, 131072
  s_cselect_b32 s53, 0, s53
  s_waitcnt vmcnt(4)
  s_mov_b32 s66, 4194304
L_b2_val0:
  v_add_u32 v61, 0, v60
  ds_read_b128 v[64:67], v61 offset:0
  ds_read_b128 v[68:71], v61 offset:1024
  ds_read_b128 v[72:75], v61 offset:2048
  ds_read_b128 v[76:79], v61 offset:3072
  s_waitcnt lgkmcnt(0)
  v_max3_u32 v62, v64, v65, v66
  v_max3_u32 v62, v62, v67, v68
  v_max3_u32 v62, v62, v69, v70
  v_max3_u32 v62, v62, v71, v72
  v_max3_u32 v62, v62, v73, v74
  v_max3_u32 v62, v62, v75, v76
  v_max3_u32 v62, v62, v77, v78
  v_max_u32 v62, v62, v79
  v_cmp_eq_u32 vcc, -1, v62
  s_sub_u32 s66, s66, 1
  s_cbranch_scc1 L_b2_ok0
  s_cmp_eq_u64 vcc, 0
  s_cbranch_scc1 L_b2_ok0
  s_add_u32 m0, s46, 0
  s_add_u32 s63, s62, 0
  buffer_load_dwordx4 v3, s[12:15], s63 offen offset:0 sc1 lds
  buffer_load_dwordx4 v3, s[12:15], s63 offen offset:1024 sc1 lds
  buffer_load_dwordx4 v3, s[12:15], s63 offen offset:2048 sc1 lds
  buffer_load_dwordx4 v3, s[12:15], s63 offen offset:3072 sc1 lds
  s_add_u32 m0, s46, 32768
  s_add_u32 s63, s62, 16384
  buffer_load_dwordx4 v3, s[12:15], s63 offen offset:0 sc1 lds
  buffer_load_dwordx4 v3, s[12:15], s63 offen offset:1024 sc1 lds
  buffer_load_dwordx4 v3, s[12:15], s63 offen offset:2048 sc1 lds
  buffer_load_dwordx4 v3, s[12:15], s63 offen offset:3072 sc1 lds
  s_waitcnt vmcnt(4)
  s_mov_b32 s55, 1
  s_branch L_b2_val0
L_b2_ok0:
  s_barrier
  s_add_u32 m0, s53, s46
  s_nop 0
  buffer_load_dwordx4 v3, s[12:15], s45 offen offset:0 sc1 lds
  buffer_load_dwordx4 v3, s[12:15], s45 offen offset:1024 sc1 lds
  buffer_load_dwordx4 v3, s[12:15], s45 offen offset:2048 sc1 lds
  buffer_load_dwordx4 v3, s[12:15], s45 offen offset:3072 sc1 lds
  s_add_u32 s45, s45, 16384
  s_add_u32 s53, s53, 32768
  s_cmp_eq_u32 s53, 131072
  s_cselect_b32 s53, 0, s53
  s_add_u32 m0, s53, s46
  s_add_u32 s54, s53, s49
  buffer_load_dwordx4 v3, s[12:15], s45 offen offset:0 sc1 lds
  buffer_load_dwordx4 v3, s[12:15], s45 offen offset:1024 sc1 lds
  buffer_load_dwordx4 v3, s[12:15], s45 offen offset:2048 sc1 lds
  buffer_load_dwordx4 v3, s[12:15], s45 offen offset:3072 sc1 lds
  s_mov_b32 m0, s54
  s_add_u32 s45, s45, 16384
  buffer_load_dwordx4 v3, s[16:19], s47 offen offset:0 sc1 lds
  buffer_load_dwordx4 v3, s[16:19], s47 offen offset:1024 sc1 lds
  buffer_load_dwordx4 v3, s[16:19], s47 offen offset:2048 sc1 lds
  buffer_load_dwordx4 v3, s[16:19], s47 offen offset:3072 sc1 lds
  s_add_u32 s47, s47, 16384
  s_add_u32 s53, s53, 32768
  s_cmp_eq_u32 s53, 131072
  s_cselect_b32 s53, 0, s53
  s_waitcnt vmcnt(12)
  s_cmp_eq_u32 s55, 0
  s_cbranch_scc1 L_b2_nr1
  s_waitcnt vmcnt(0)
  s_mov_b32 s55, 0
L_b2_nr1:
  s_mov_b32 s66, 4194304
L_b2_val1:
  v_add_u32 v61, 32768, v60
  ds_read_b128 v[64:67], v61 offset:0
  ds_read_b128 v[68:71], v61 offset:1024
  ds_read_b128 v[72:75], v61 offset:2048
  ds_read_b128 v[76:79], v61 offset:3072
  s_waitcnt lgkmcnt(0)
  v_max3_u32 v62, v64, v65, v66
  v_max3_u32 v62, v62, v67, v68
  v_max3_u32 v62, v62, v69, v70
  v_max3_u32 v62, v62, v71, v72
  v_max3_u32 v62, v62, v73, v74
  v_max3_u32 v62, v62, v75, v76
  v_max3_u32 v62, v62, v77, v78
  v_max_u32 v62, v62, v79
  v_cmp_eq_u32 vcc, -1, v62
  s_sub_u32 s66, s66, 1
  s_cbranch_scc1 L_b2_ok1
  s_cmp_eq_u64 vcc, 0
  s_cbranch_scc1 L_b2_ok1
  s_add_u32 m0, s46, 32768
  s_add_u32 s63, s62, 16384
  buffer_load_dwordx4 v3, s[12:15], s63 offen offset:0 sc1 lds
  buffer_load_dwordx4 v3, s[12:15], s63 offen offset:1024 sc1 lds
  buffer_load_dwordx4 v3, s[12:15], s63 offen offset:2048 sc1 lds
  buffer_load_dwordx4 v3, s[12:15], s63 offen offset:3072 sc1 lds
  s_add_u32 m0, s46, 65536
  s_add_u32 s63, s62, 32768
  buffer_load_dwordx4 v3, s[12:15], s63 offen offset:0 sc1 lds
  buffer_load_dwordx4 v3, s[12:15], s63 offen offset:1024 sc1 lds
  buffer_load_dwordx4 v3, s[12:15], s63 offen offset:2048 sc1 lds
  buffer_load_dwordx4 v3, s[12:15], s63 offen offset:3072 sc1 lds
  s_add_u32 m0, s46, 98304
  s_add_u32 s63, s62, 49152
  buffer_load_dwordx4 v3, s[12:15], s63 offen offset:0 sc1 lds
  buffer_load_dwordx4 v3, s[12:15], s63 offen offset:1024 sc1 lds
  buffer_load_dwordx4 v3, s[12:15], s63 offen offset:2048 sc1 lds
  buffer_load_dwordx4 v3, s[12:15], s63 offen offset:3072 sc1 lds
  s_waitcnt vmcnt(8)
  s_mov_b32 s55, 1
  s_branch L_b2_val1
L_b2_ok1:
  s_barrier
  s_add_u32 m0, s53, s46
  s_add_u32 s54, s53, s49
  buffer_load_dwordx4 v3, s[12:15], s45 offen offset:0 sc1 lds
  buffer_load_dwordx4 v3, s[12:15], s45 offen offset:1024 sc1 lds
  buffer_load_dwordx4 v3, s[12:15], s45 offen offset:2048 sc1 lds
  buffer_load_dwordx4 v3, s[12:15], s45 offen offset:3072 sc1 lds
  s_mov_b32 m0, s54
  s_add_u32 s45, s45, 16384
  buffer_load_dwordx4 v3, s[16:19], s47 offen offset:0 sc1 lds
  buffer_load_dwordx4 v3, s[16:19], s47 offen offset:1024 sc1 lds
  buffer_load_dwordx4 v3, s[16:19], s47 offen offset:2048 sc1 lds
  buffer_load_dwordx4 v3, s[16:19], s47 offen offset:3072 sc1 lds
  s_add_u32 s47, s47, 16384
  s_add_u32 s53, s53, 32768
  s_cmp_eq_u32 s53, 131072
  s_cselect_b32 s53, 0, s53
  s_waitcnt vmcnt(16)
  s_cmp_eq_u32 s55, 0
  s_cbranch_scc1 L_b2_nr2
  s_waitcnt vmcnt(0)
  s_mov_b32 s55, 0
L_b2_nr2:
  s_mov_b32 s66, 4194304
L_b2_val2:
  v_add_u32 v61, 65536, v60
  ds_read_b128 v[64:67], v61 offset:0
  ds_read_b128 v[68:71], v61 offset:1024
  ds_read_b128 v[72:75], v61 offset:2048
  ds_read_b128 v[76:79], v61 offset:3072
  s_waitcnt lgkmcnt(0)
  v_max3_u32 v62, v64, v65, v66
  v_max3_u32 v62, v62, v67, v68
  v_max3_u32 v62, v62, v69, v70
  v_max3_u32 v62, v62, v71, v72
  v_max3_u32 v62, v62, v73, v74
  v_max3_u32 v62, v62, v75, v76
  v_max3_u32 v62, v62, v77, v78
  v_max_u32 v62, v62, v79
  v_cmp_eq_u32 vcc, -1, v62
  s_sub_u32 s66, s66, 1
  s_cbranch_scc1 L_b2_ok2
  s_cmp_eq_u64 vcc, 0
  s_cbranch_scc1 L_b2_ok2
  s_add_u32 m0, s46, 65536
  s_add_u32 s63, s62, 32768
  buffer_load_dwordx4 v3, s[12:15], s63 offen offset:0 sc1 lds
  buffer_load_dwordx4 v3, s[12:15], s63 offen offset:1024 sc1 lds
  buffer_load_dwordx4 v3, s[12:15], s63 offen offset:2048 sc1 lds
  buffer_load_dwordx4 v3, s[12:15], s63 offen offset:3072 sc1 lds
  s_add_u32 m0, s46, 98304
  s_add_u32 s63, s62, 49152
  buffer_load_dwordx4 v3, s[12:15], s63 offen offset:0 sc1 lds
  buffer_load_dwordx4 v3, s[12:15], s63 offen offset:1024 sc1 lds
  buffer_load_dwordx4 v3, s[12:15], s63 offen offset:2048 sc1 lds
  buffer_load_dwordx4 v3, s[12:15], s63 offen offset:3072 sc1 lds
  s_add_u32 m0, s46, 0
  s_add_u32 s63, s62, 65536
  buffer_load_dwordx4 v3, s[12:15], s63 offen offset:0 sc1 lds
  buffer_load_dwordx4 v3, s[12:15], s63 offen offset:1024 sc1 lds
  buffer_load_dwordx4 v3, s[12:15], s63 offen offset:2048 sc1 lds
  buffer_load_dwordx4 v3, s[12:15], s63 offen offset:3072 sc1 lds
  s_waitcnt vmcnt(8)
  s_mov_b32 s55, 1
  s_branch L_b2_val2
L_b2_ok2:
  s_barrier
  s_add_u32 m0, s53, s46
  s_add_u32 s54, s53, s49
  buffer_load_dwordx4 v3, s[12:15], s45 offen offset:0 sc1 lds
  buffer_load_dwordx4 v3, s[12:15], s45 offen offset:1024 sc1 lds
  buffer_load_dwordx4 v3, s[12:15], s45 offen offset:2048 sc1 lds
  buffer_load_dwordx4 v3, s[12:15], s45 offen offset:3072 sc1 lds
  s_mov_b32 m0, s54
  s_add_u32 s45, s45, 16384
  buffer_load_dwordx4 v3, s[16:19], s47 offen offset:0 sc1 lds
  buffer_load_dwordx4 v3, s[16:19], s47 offen offset:1024 sc1 lds
  buffer_load_dwordx4 v3, s[16:19], s47 offen offset:2048 sc1 lds
  buffer_load_dwordx4 v3, s[16:19], s47 offen offset:3072 sc1 lds
  s_add_u32 s47, s47, 16384
  s_add_u32 s53, s53, 32768
  s_cmp_eq_u32 s53, 131072
  s_cselect_b32 s53, 0, s53
  s_waitcnt vmcnt(16)
  s_cmp_eq_u32 s55, 0
  s_cbranch_scc1 L_b2_nr3
  s_waitcnt vmcnt(0)
  s_mov_b32 s55, 0
L_b2_nr3:
  s_mov_b32 s66, 4194304
L_b2_val3:
  v_add_u32 v61, 98304, v60
  ds_read_b128 v[64:67], v61 offset:0
  ds_read_b128 v[68:71], v61 offset:1024
  ds_read_b128 v[72:75], v61 offset:2048
  ds_read_b128 v[76:79], v61 offset:3072
  s_waitcnt lgkmcnt(0)
  v_max3_u32 v62, v64, v65, v66
  v_max3_u32 v62, v62, v67, v68
  v_max3_u32 v62, v62, v69, v70
  v_max3_u32 v62, v62, v71, v72
  v_max3_u32 v62, v62, v73, v74
  v_max3_u32 v62, v62, v75, v76
  v_max3_u32 v62, v62, v77, v78
  v_max_u32 v62, v62, v79
  v_cmp_eq_u32 vcc, -1, v62
  s_sub_u32 s66, s66, 1
  s_cbranch_scc1 L_b2_ok3
  s_cmp_eq_u64 vcc, 0
  s_cbranch_scc1 L_b2_ok3
  s_add_u32 m0, s46, 98304
  s_add_u32 s63, s62, 49152
  buffer_load_dwordx4 v3, s[12:15], s63 offen offset:0 sc1 lds
  buffer_load_dwordx4 v3, s[12:15], s63 offen offset:1024 sc1 lds
  buffer_load_dwordx4 v3, s[12:15], s63 offen offset:2048 sc1 lds
  buffer_load_dwordx4 v3, s[12:15], s63 offen offset:3072 sc1 lds
  s_add_u32 m0, s46, 0
  s_add_u32 s63, s62, 65536
  buffer_load_dwordx4 v3, s[12:15], s63 offen offset:0 sc1 lds
  buffer_load_dwordx4 v3, s[12:15], s63 offen offset:1024 sc1 lds
  buffer_load_dwordx4 v3, s[12:15], s63 offen offset:2048 sc1 lds
  buffer_load_dwordx4 v3, s[12:15], s63 offen offset:3072 sc1 lds
  s_add_u32 m0, s46, 32768
  s_add_u32 s63, s62, 81920
  buffer_load_dwordx4 v3, s[12:15], s63 offen offset:0 sc1 lds
  buffer_load_dwordx4 v3, s[12:15], s63 offen offset:1024 sc1 lds
  buffer_load_dwordx4 v3, s[12:15], s63 offen offset:2048 sc1 lds
  buffer_load_dwordx4 v3, s[12:15], s63 offen offset:3072 sc1 lds
  s_waitcnt vmcnt(8)
  s_mov_b32 s55, 1
  s_branch L_b2_val3
L_b2_ok3:
  s_barrier
  s_add_u32 m0, s53, s46
  s_add_u32 s54, s53, s49
  buffer_load_dwordx4 v3, s[12:15], s45 offen offset:0 sc1 lds
  buffer_load_dwordx4 v3, s[12:15], s45 offen offset:1024 sc1 lds
  buffer_load_dwordx4 v3, s[12:15], s45 offen offset:2048 sc1 lds
  buffer_load_dwordx4 v3, s[12:15], s45 offen offset:3072 sc1 lds
  s_mov_b32 m0, s54
  s_add_u32 s45, s45, 16384
  buffer_load_dwordx4 v3, s[16:19], s47 offen offset:0 sc1 lds
  buffer_load_dwordx4 v3, s[16:19], s47 offen offset:1024 sc1 lds
  buffer_load_dwordx4 v3, s[16:19], s47 offen offset:2048 sc1 lds
  buffer_load_dwordx4 v3, s[16:19], s47 offen offset:3072 sc1 lds
  s_add_u32 s47, s47, 16384
  s_add_u32 s53, s53, 32768
  s_cmp_eq_u32 s53, 131072
  s_cselect_b32 s53, 0, s53
  s_waitcnt vmcnt(16)
  s_cmp_eq_u32 s55, 0
  s_cbranch_scc1 L_b2_nr4
  s_waitcnt vmcnt(0)
  s_mov_b32 s55, 0
L_b2_nr4:
  s_mov_b32 s66, 4194304
L_b2_val4:
  v_add_u32 v61, 0, v60
  ds_read_b128 v[64:67], v61 offset:0
  ds_read_b128 v[68:71], v61 offset:1024
  ds_read_b128 v[72:75], v61 offset:2048
  ds_read_b128 v[76:79], v61 offset:3072
  s_waitcnt lgkmcnt(0)
  v_max3_u32 v62, v64, v65, v66
  v_max3_u32 v62, v62, v67, v68
  v_max3_u32 v62, v62, v69, v70
  v_max3_u32 v62, v62, v71, v72
  v_max3_u32 v62, v62, v73, v74
  v_max3_u32 v62, v62, v75, v76
  v_max3_u32 v62, v62, v77, v78
  v_max_u32 v62, v62, v79
  v_cmp_eq_u32 vcc, -1, v62
  s_sub_u32 s66, s66, 1
  s_cbranch_scc1 L_b2_ok4
  s_cmp_eq_u64 vcc, 0
  s_cbranch_scc1 L_b2_ok4
  s_add_u32 m0, s46, 0
  s_add_u32 s63, s62, 65536
  buffer_load_dwordx4 v3, s[12:15], s63 offen offset:0 sc1 lds
  buffer_load_dwordx4 v3, s[12:15], s63 offen offset:1024 sc1 lds
  buffer_load_dwordx4 v3, s[12:15], s63 offen offset:2048 sc1 lds
  buffer_load_dwordx4 v3, s[12:15], s63 offen offset:3072 sc1 lds
  s_add_u32 m0, s46, 32768
  s_add_u32 s63, s62, 81920
  buffer_load_dwordx4 v3, s[12:15], s63 offen offset:0 sc1 lds
  buffer_load_dwordx4 v3, s[12:15], s63 offen offset:1024 sc1 lds
  buffer_load_dwordx4 v3, s[12:15], s63 offen offset:2048 sc1 lds
  buffer_load_dwordx4 v3, s[12:15], s63 offen offset:3072 sc1 lds
  s_add_u32 m0, s46, 65536
  s_add_u32 s63, s62, 98304
  buffer_load_dwordx4 v3, s[12:15], s63 offen offset:0 sc1 lds
  buffer_load_dwordx4 v3, s[12:15], s63 offen offset:1024 sc1 lds
  buffer_load_dwordx4 v3, s[12:15], s63 offen offset:2048 sc1 lds
  buffer_load_dwordx4 v3, s[12:15], s63 offen offset:3072 sc1 lds
  s_waitcnt vmcnt(8)
  s_mov_b32 s55, 1
  s_branch L_b2_val4
L_b2_ok4:
  s_barrier
  s_add_u32 m0, s53, s46
  s_add_u32 s54, s53, s49
  buffer_load_dwordx4 v3, s[12:15], s45 offen offset:0 sc1 lds
  buffer_load_dwordx4 v3, s[12:15], s45 offen offset:1024 sc1 lds
  buffer_load_dwordx4 v3, s[12:15], s45 offen offset:2048 sc1 lds
  buffer_load_dwordx4 v3, s[12:15], s45 offen offset:3072 sc1 lds
  s_mov_b32 m0, s54
  s_add_u32 s45, s45, 16384
  buffer_load_dwordx4 v3, s[16:19], s47 offen offset:0 sc1 lds
  buffer_load_dwordx4 v3, s[16:19], s47 offen offset:1024 sc1 lds
  buffer_load_dwordx4 v3, s[16:19], s47 offen offset:2048 sc1 lds
  buffer_load_dwordx4 v3, s[16:19], s47 offen offset:3072 sc1 lds
  s_add_u32 s47, s47, 16384
  s_add_u32 s53, s53, 32768
  s_cmp_eq_u32 s53, 131072
  s_cselect_b32 s53, 0, s53
  s_waitcnt vmcnt(16)
  s_cmp_eq_u32 s55, 0
  s_cbranch_scc1 L_b2_nr5
  s_waitcnt vmcnt(0)
  s_mov_b32 s55, 0
L_b2_nr5:
  s_mov_b32 s66, 4194304
L_b2_val5:
  v_add_u32 v61, 32768, v60
  ds_read_b128 v[64:67], v61 offset:0
  ds_read_b128 v[68:71], v61 offset:1024
  ds_read_b128 v[72:75], v61 offset:2048
  ds_read_b128 v[76:79], v61 offset:3072
  s_waitcnt lgkmcnt(0)
  v_max3_u32 v62, v64, v65, v66
  v_max3_u32 v62, v62, v67, v68
  v_max3_u32 v62, v62, v69, v70
  v_max3_u32 v62, v62, v71, v72
  v_max3_u32 v62, v62, v73, v74
  v_max3_u32 v62, v62, v75, v76
  v_max3_u32 v62, v62, v77, v78
  v_max_u32 v62, v62, v79
  v_cmp_eq_u32 vcc, -1, v62
  s_sub_u32 s66, s66, 1
  s_cbranch_scc1 L_b2_ok5
  s_cmp_eq_u64 vcc, 0
  s_cbranch_scc1 L_b2_ok5
  s_add_u32 m0, s46, 32768
  s_add_u32 s63, s62, 81920
  buffer_load_dwordx4 v3, s[12:15], s63 offen offset:0 sc1 lds
  buffer_load_dwordx4 v3, s[12:15], s63 offen offset:1024 sc1 lds
  buffer_load_dwordx4 v3, s[12:15], s63 offen offset:2048 sc1 lds
  buffer_load_dwordx4 v3, s[12:15], s63 offen offset:3072 sc1 lds
  s_add_u32 m0, s46, 65536
  s_add_u32 s63, s62, 98304
  buffer_load_dwordx4 v3, s[12:15], s63 offen offset:0 sc1 lds
  buffer_load_dwordx4 v3, s[12:15], s63 offen offset:1024 sc1 lds
  buffer_load_dwordx4 v3, s[12:15], s63 offen offset:2048 sc1 lds
  buffer_load_dwordx4 v3, s[12:15], s63 offen offset:3072 sc1 lds
  s_add_u32 m0, s46, 98304
  s_add_u32 s63, s62, 114688
  buffer_load_dwordx4 v3, s[12:15], s63 offen offset:0 sc1 lds
  buffer_load_dwordx4 v3, s[12:15], s63 offen offset:1024 sc1 lds
  buffer_load_dwordx4 v3, s[12:15], s63 offen offset:2048 sc1 lds
  buffer_load_dwordx4 v3, s[12:15], s63 offen offset:3072 sc1 lds
  s_waitcnt vmcnt(8)
  s_mov_b32 s55, 1
  s_branch L_b2_val5
L_b2_ok5:
  s_barrier
  s_add_u32 m0, s53, s46
  s_add_u32 s54, s53, s49
  buffer_load_dwordx4 v3, s[12:15], s45 offen offset:0 sc1 lds
  buffer_load_dwordx4 v3, s[12:15], s45 offen offset:1024 sc1 lds
  buffer_load_dwordx4 v3, s[12:15], s45 offen offset:2048 sc1 lds
  buffer_load_dwordx4 v3, s[12:15], s45 offen offset:3072 sc1 lds
  s_mov_b32 m0, s54
  s_add_u32 s45, s45, 16384
  buffer_load_dwordx4 v3, s[16:19], s47 offen offset:0 sc1 lds
  buffer_load_dwordx4 v3, s[16:19], s47 offen offset:1024 sc1 lds
  buffer_load_dwordx4 v3, s[16:19], s47 offen offset:2048 sc1 lds
  buffer_load_dwordx4 v3, s[16:19], s47 offen offset:3072 sc1 lds
  s_add_u32 s47, s47, 16384
  s_add_u32 s53, s53, 32768
  s_cmp_eq_u32 s53, 131072
  s_cselect_b32 s53, 0, s53
  s_waitcnt vmcnt(16)
  s_cmp_eq_u32 s55, 0
  s_cbranch_scc1 L_b2_nr6
  s_waitcnt vmcnt(0)
  s_mov_b32 s55, 0
L_b2_nr6:
  s_mov_b32 s66, 4194304
L_b2_val6:
  v_add_u32 v61, 65536, v60
  ds_read_b128 v[64:67], v61 offset:0
  ds_read_b128 v[68:71], v61 offset:1024
  ds_read_b128 v[72:75], v61 offset:2048
  ds_read_b128 v[76:79], v61 offset:3072
  s_waitcnt lgkmcnt(0)
  v_max3_u32 v62, v64, v65, v66
  v_max3_u32 v62, v62, v67, v68
  v_max3_u32 v62, v62, v69, v70
  v_max3_u32 v62, v62, v71, v72
  v_max3_u32 v62, v62, v73, v74
  v_max3_u32 v62, v62, v75, v76
  v_max3_u32 v62, v62, v77, v78
  v_max_u32 v62, v62, v79
  v_cmp_eq_u32 vcc, -1, v62
  s_sub_u32 s66, s66, 1
  s_cbranch_scc1 L_b2_ok6
  s_cmp_eq_u64 vcc, 0
  s_cbranch_scc1 L_b2_ok6
  s_add_u32 m0, s46, 65536
  s_add_u32 s63, s62, 98304
  buffer_load_dwordx4 v3, s[12:15], s63 offen offset:0 sc1 lds
  buffer_load_dwordx4 v3, s[12:15], s63 offen offset:1024 sc1 lds
  buffer_load_dwordx4 v3, s[12:15], s63 offen offset:2048 sc1 lds
  buffer_load_dwordx4 v3, s[12:15], s63 offen offset:3072 sc1 lds
  s_add_u32 m0, s46, 98304
  s_add_u32 s63, s62, 114688
  buffer_load_dwordx4 v3, s[12:15], s63 offen offset:0 sc1 lds
  buffer_load_dwordx4 v3, s[12:15], s63 offen offset:1024 sc1 lds
  buffer_load_dwordx4 v3, s[12:15], s63 offen offset:2048 sc1 lds
  buffer_load_dwordx4 v3, s[12:15], s63 offen offset:3072 sc1 lds
  s_waitcnt vmcnt(4)
  s_mov_b32 s55, 1
  s_branch L_b2_val6
L_b2_ok6:
  s_barrier
  s_add_u32 m0, s53, s46
  s_add_u32 s54, s53, s49
  buffer_load_dwordx4 v3, s[12:15], s45 offen offset:0 sc1 lds
  buffer_load_dwordx4 v3, s[12:15], s45 offen offset:1024 sc1 lds
  buffer_load_dwordx4 v3, s[12:15], s45 offen offset:2048 sc1 lds
  buffer_load_dwordx4 v3, s[12:15], s45 offen offset:3072 sc1 lds
  s_mov_b32 m0, s54
  s_add_u32 s45, s45, 16384
  buffer_load_dwordx4 v3, s[16:19], s47 offen offset:0 sc1 lds
  buffer_load_dwordx4 v3, s[16:19], s47 offen offset:1024 sc1 lds
  buffer_load_dwordx4 v3, s[16:19], s47 offen offset:2048 sc1 lds
  buffer_load_dwordx4 v3, s[16:19], s47 offen offset:3072 sc1 lds
  s_add_u32 s47, s47, 16384
  s_add_u32 s53, s53, 32768
  s_cmp_eq_u32 s53, 131072
  s_cselect_b32 s53, 0, s53
  s_waitcnt vmcnt(16)
  s_cmp_eq_u32 s55, 0
  s_cbranch_scc1 L_b2_nr7
  s_waitcnt vmcnt(0)
  s_mov_b32 s55, 0
L_b2_nr7:
  s_mov_b32 s66, 4194304
L_b2_val7:
  v_add_u32 v61, 98304, v60
  ds_read_b128 v[64:67], v61 offset:0
  ds_read_b128 v[68:71], v61 offset:1024
  ds_read_b128 v[72:75], v61 offset:2048
  ds_read_b128 v[76:79], v61 offset:3072
  s_waitcnt lgkmcnt(0)
  v_max3_u32 v62, v64, v65, v66
  v_max3_u32 v62, v62, v67, v68
  v_max3_u32 v62, v62, v69, v70
  v_max3_u32 v62, v62, v71, v72
  v_max3_u32 v62, v62, v73, v74
  v_max3_u32 v62, v62, v75, v76
  v_max3_u32 v62, v62, v77, v78
  v_max_u32 v62, v62, v79
  v_cmp_eq_u32 vcc, -1, v62
  s_sub_u32 s66, s66, 1
  s_cbranch_scc1 L_b2_ok7
  s_cmp_eq_u64 vcc, 0
  s_cbranch_scc1 L_b2_ok7
  s_add_u32 m0, s46, 98304
  s_add_u32 s63, s62, 114688
  buffer_load_dwordx4 v3, s[12:15], s63 offen offset:0 sc1 lds
  buffer_load_dwordx4 v3, s[12:15], s63 offen offset:1024 sc1 lds
  buffer_load_dwordx4 v3, s[12:15], s63 offen offset:2048 sc1 lds
  buffer_load_dwordx4 v3, s[12:15], s63 offen offset:3072 sc1 lds
  s_waitcnt vmcnt(0)
  s_mov_b32 s55, 1
  s_branch L_b2_val7
L_b2_ok7:
  s_barrier
  s_add_u32 m0, s53, s46
  s_add_u32 s54, s53, s49
  buffer_load_dwordx4 v3, s[12:15], s45 offen offset:0 sc1 lds
  buffer_load_dwordx4 v3, s[12:15], s45 offen offset:1024 sc1 lds
  buffer_load_dwordx4 v3, s[12:15], s45 offen offset:2048 sc1 lds
  buffer_load_dwordx4 v3, s[12:15], s45 offen offset:3072 sc1 lds
  s_mov_b32 m0, s54
  s_add_u32 s45, s45, 16384
  buffer_load_dwordx4 v3, s[16:19], s47 offen offset:0 sc1 lds
  buffer_load_dwordx4 v3, s[16:19], s47 offen offset:1024 sc1 lds
  buffer_load_dwordx4 v3, s[16:19], s47 offen offset:2048 sc1 lds
  buffer_load_dwordx4 v3, s[16:19], s47 offen offset:3072 sc1 lds
  s_add_u32 s47, s47, 16384
  s_add_u32 s53, s53, 32768
  s_cmp_eq_u32 s53, 131072
  s_cselect_b32 s53, 0, s53
  s_mov_b32 s56, 17
L_b2_lloop:
  s_waitcnt vmcnt(16)
  s_barrier
  s_add_u32 m0, s53, s46
  s_add_u32 s54, s53, s49
  buffer_load_dwordx4 v3, s[12:15], s45 offen offset:0 sc1 lds
  buffer_load_dwordx4 v3, s[12:15], s45 offen offset:1024 sc1 lds
  buffer_load_dwordx4 v3, s[12:15], s45 offen offset:2048 sc1 lds
  buffer_load_dwordx4 v3, s[12:15], s45 offen offset:3072 sc1 lds
  s_mov_b32 m0, s54
  s_add_u32 s45, s45, 16384
  buffer_load_dwordx4 v3, s[16:19], s47 offen offset:0 sc1 lds
  buffer_load_dwordx4 v3, s[16:19], s47 offen offset:1024 sc1 lds
  buffer_load_dwordx4 v3, s[16:19], s47 offen offset:2048 sc1 lds
  buffer_load_dwordx4 v3, s[16:19], s47 offen offset:3072 sc1 lds
  s_add_u32 s47, s47, 16384
  s_add_u32 s53, s53, 32768
  s_cmp_eq_u32 s53, 131072
  s_cselect_b32 s53, 0, s53
  s_sub_u32 s56, s56, 1
  s_cmp_lg_u32 s56, 0
  s_cbranch_scc1 L_b2_lloop
  s_waitcnt vmcnt(16)
  s_barrier
  s_waitcnt vmcnt(8)
  s_barrier
  s_waitcnt vmcnt(0)
  s_barrier
  s_waitcnt vmcnt(0)
  s_barrier
  s_endpgm
L_attn_qcomp:
  s_load_dwordx2 s[6:7], s[0:1], 0
  s_load_dwordx2 s[8:9], s[0:1], 80
  s_and_b32 s43, s42, 1
  s_lshr_b32 s44, s42, 1
  s_waitcnt lgkmcnt(0)
  s_lshl_b32 s45, s43, 12
  v_add_u32 v8, s45, v3
  s_mul_i32 s46, s44, 2048
  s_add_u32 s46, s46, 16384
  v_add_u32 v9, s46, v3
  s_mov_b32 s53, 65536
  v_mov_b32 v112, 0
  v_mov_b32 v113, 0
  v_mov_b32 v114, 0
  v_mov_b32 v115, 0
  v_mov_b32 v116, 0
  v_mov_b32 v117, 0
  v_mov_b32 v118, 0
  v_mov_b32 v119, 0
  v_mov_b32 v120, 0
  v_mov_b32 v121, 0
  v_mov_b32 v122, 0
  v_mov_b32 v123, 0
  v_mov_b32 v124, 0
  v_mov_b32 v125, 0
  v_mov_b32 v126, 0
  v_mov_b32 v127, 0
  v_mov_b32 v128, 0
  v_mov_b32 v129, 0
  v_mov_b32 v130, 0
  v_mov_b32 v131, 0
  v_mov_b32 v132, 0
  v_mov_b32 v133, 0
  v_mov_b32 v134, 0
  v_mov_b32 v135, 0
  v_mov_b32 v136, 0
  v_mov_b32 v137, 0
  v_mov_b32 v138, 0
  v_mov_b32 v139, 0
  v_mov_b32 v140, 0
  v_mov_b32 v141, 0
  v_mov_b32 v142, 0
  v_mov_b32 v143, 0
  v_add_u32 v10, s53, v8
  v_add_u32 v11, s53, v9
  s_add_u32 s53, s53, 24576
  s_cmp_eq_u32 s53, 163840
  s_cselect_b32 s53, 65536, s53
  s_barrier
  ds_read_b128 v[32:35], v11 offset:0
  ds_read_b128 v[16:19], v10 offset:0
  ds_read_b128 v[20:23], v10 offset:1024
  ds_read_b128 v[24:27], v10 offset:2048
  ds_read_b128 v[28:31], v10 offset:3072
  ds_read_b128 v[36:39], v11 offset:1024
  ds_read_b128 v[56:59], v11 offset:4096
  ds_read_b128 v[40:43], v10 offset:8192
  ds_read_b128 v[44:47], v10 offset:9216
  ds_read_b128 v[48:51], v10 offset:10240
  ds_read_b128 v[52:55], v10 offset:11264
  ds_read_b128 v[60:63], v11 offset:5120
  v_add_u32 v10, s53, v8
  v_add_u32 v11, s53, v9
  s_add_u32 s53, s53, 24576
  s_cmp_eq_u32 s53, 163840
  s_cselect_b32 s53, 65536, s53
  s_mov_b32 s56, 8
  s_waitcnt lgkmcnt(0)
.p2align 6
L_attnq_cloop:
  s_barrier
  v_mfma_f32_16x16x32_bf16 v[112:115], v[32:35], v[16:19], v[112:115]
  ds_read_b128 v[80:83], v11 offset:0
  ds_read_b128 v[64:67], v10 offset:0
  v_mfma_f32_16x16x32_bf16 v[112:115], v[56:59], v[40:43], v[112:115]
  ds_read_b128 v[68:71], v10 offset:1024
  v_mfma_f32_16x16x32_bf16 v[120:123], v[32:35], v[20:23], v[120:123]
  ds_read_b128 v[72:75], v10 offset:2048
  v_mfma_f32_16x16x32_bf16 v[120:123], v[56:59], v[44:47], v[120:123]
  ds_read_b128 v[76:79], v10 offset:3072
  v_mfma_f32_16x16x32_bf16 v[128:131], v[32:35], v[24:27], v[128:131]
  ds_read_b128 v[84:87], v11 offset:1024
  v_mfma_f32_16x16x32_bf16 v[128:131], v[56:59], v[48:51], v[128:131]
  ds_read_b128 v[104:107], v11 offset:4096
  v_mfma_f32_16x16x32_bf16 v[136:139], v[32:35], v[28:31], v[136:139]
  ds_read_b128 v[88:91], v10 offset:8192
  v_mfma_f32_16x16x32_bf16 v[136:139], v[56:59], v[52:55], v[136:139]
  ds_read_b128 v[92:95], v10 offset:9216
  ds_read_b128 v[96:99], v10 offset:10240
  v_mfma_f32_16x16x32_bf16 v[140:143], v[36:39], v[28:31], v[140:143]
  ds_read_b128 v[100:103], v10 offset:11264
  v_mfma_f32_16x16x32_bf16 v[140:143], v[60:63], v[52:55], v[140:143]
  ds_read_b128 v[108:111], v11 offset:5120
  v_mfma_f32_16x16x32_bf16 v[132:135], v[36:39], v[24:27], v[132:135]
  v_add_u32 v10, s53, v8
  v_mfma_f32_16x16x32_bf16 v[132:135], v[60:63], v[48:51], v[132:135]
  v_add_u32 v11, s53, v9
  v_mfma_f32_16x16x32_bf16 v[124:127], v[36:39], v[20:23], v[124:127]
  s_add_u32 s53, s53, 24576
  v_mfma_f32_16x16x32_bf16 v[124:127], v[60:63], v[44:47], v[124:127]
  s_cmp_eq_u32 s53, 163840
  v_mfma_f32_16x16x32_bf16 v[116:119], v[36:39], v[16:19], v[116:119]
  s_cselect_b32 s53, 65536, s53
  v_mfma_f32_16x16x32_bf16 v[116:119], v[60:63], v[40:43], v[116:119]
  s_waitcnt lgkmcnt(0)
  s_barrier
  v_mfma_f32_16x16x32_bf16 v[112:115], v[80:83], v[64:67], v[112:115]
  ds_read_b128 v[32:35], v11 offset:0
  ds_read_b128 v[16:19], v10 offset:0
  v_mfma_f32_16x16x32_bf16 v[112:115], v[104:107], v[88:91], v[112:115]
  ds_read_b128 v[20:23], v10 offset:1024
  v_mfma_f32_16x16x32_bf16 v[120:123], v[80:83], v[68:71], v[120:123]
  ds_read_b128 v[24:27], v10 offset:2048
  v_mfma_f32_16x16x32_bf16 v[120:123], v[104:107], v[92:95], v[120:123]
  ds_read_b128 v[28:31], v10 offset:3072
  v_mfma_f32_16x16x32_bf16 v[128:131], v[80:83], v[72:75], v[128:131]
  ds_read_b128 v[36:39], v11 offset:1024
  v_mfma_f32_16x16x32_bf16 v[128:131], v[104:107], v[96:99], v[128:131]
  ds_read_b128 v[56:59], v11 offset:4096
  v_mfma_f32_16x16x32_bf16 v[136:139], v[80:83], v[76:79], v[136:139]
  ds_read_b128 v[40:43], v10 offset:8192
  v_mfma_f32_16x16x32_bf16 v[136:139], v[104:107], v[100:103], v[136:139]
  ds_read_b128 v[44:47], v10 offset:9216
  ds_read_b128 v[48:51], v10 offset:10240
  v_mfma_f32_16x16x32_bf16 v[140:143], v[84:87], v[76:79], v[140:143]
  ds_read_b128 v[52:55], v10 offset:11264
  v_mfma_f32_16x16x32_bf16 v[140:143], v[108:111], v[100:103], v[140:143]
  ds_read_b128 v[60:63], v11 offset:5120
  v_mfma_f32_16x16x32_bf16 v[132:135], v[84:87], v[72:75], v[132:135]
  v_add_u32 v10, s53, v8
  v_mfma_f32_16x16x32_bf16 v[132:135], v[108:111], v[96:99], v[132:135]
  v_add_u32 v11, s53, v9
  v_mfma_f32_16x16x32_bf16 v[124:127], v[84:87], v[68:71], v[124:127]
  s_add_u32 s53, s53, 24576
  v_mfma_f32_16x16x32_bf16 v[124:127], v[108:111], v[92:95], v[124:127]
  s_cmp_eq_u32 s53, 163840
  v_mfma_f32_16x16x32_bf16 v[116:119], v[84:87], v[64:67], v[116:119]
  s_cselect_b32 s53, 65536, s53
  v_mfma_f32_16x16x32_bf16 v[116:119], v[108:111], v[88:91], v[116:119]
  s_waitcnt lgkmcnt(0)
  s_sub_u32 s56, s56, 1
  s_cmp_lg_u32 s56, 0
  s_cbranch_scc1 L_attnq_cloop
  s_mov_b32 s50, 0x3e8293ee
  v_mov_b64 v[32:33], 0
  v_mov_b64 v[34:35], 0
  v_mov_b64 v[36:37], 0
  v_mov_b64 v[38:39], 0
  v_mov_b64 v[40:41], 0
  v_mov_b64 v[42:43], 0
  v_mov_b64 v[44:45], 0
  v_mov_b64 v[46:47], 0
  v_pk_mul_f32 v[112:113], v[112:113], s[50:51] op_sel_hi:[1,0]
  v_pk_mul_f32 v[114:115], v[114:115], s[50:51] op_sel_hi:[1,0]
  v_pk_mul_f32 v[116:117], v[116:117], s[50:51] op_sel_hi:[1,0]
  v_pk_mul_f32 v[118:119], v[118:119], s[50:51] op_sel_hi:[1,0]
  v_pk_mul_f32 v[120:121], v[120:121], s[50:51] op_sel_hi:[1,0]
  v_pk_mul_f32 v[122:123], v[122:123], s[50:51] op_sel_hi:[1,0]
  v_pk_mul_f32 v[124:125], v[124:125], s[50:51] op_sel_hi:[1,0]
  v_pk_mul_f32 v[126:127], v[126:127], s[50:51] op_sel_hi:[1,0]
  v_pk_mul_f32 v[128:129], v[128:129], s[50:51] op_sel_hi:[1,0]
  v_pk_mul_f32 v[130:131], v[130:131], s[50:51] op_sel_hi:[1,0]
  v_pk_mul_f32 v[132:133], v[132:133], s[50:51] op_sel_hi:[1,0]
  v_pk_mul_f32 v[134:135], v[134:135], s[50:51] op_sel_hi:[1,0]
  v_pk_mul_f32 v[136:137], v[136:137], s[50:51] op_sel_hi:[1,0]
  v_pk_mul_f32 v[138:139], v[138:139], s[50:51] op_sel_hi:[1,0]
  v_pk_mul_f32 v[140:141], v[140:141], s[50:51] op_sel_hi:[1,0]
  v_pk_mul_f32 v[142:143], v[142:143], s[50:51] op_sel_hi:[1,0]
  v_cvt_pk_bf16_f32 v144, v112, v113
  v_cvt_pk_bf16_f32 v145, v114, v115
  v_cvt_pk_bf16_f32 v146, v116, v117
  v_cvt_pk_bf16_f32 v147, v118, v119
  v_cvt_pk_bf16_f32 v148, v120, v121
  v_cvt_pk_bf16_f32 v149, v122, v123
  v_cvt_pk_bf16_f32 v150, v124, v125
  v_cvt_pk_bf16_f32 v151, v126, v127
  v_cvt_pk_bf16_f32 v152, v128, v129
  v_cvt_pk_bf16_f32 v153, v130, v131
  v_cvt_pk_bf16_f32 v154, v132, v133
  v_cvt_pk_bf16_f32 v155, v134, v135
  v_cvt_pk_bf16_f32 v156, v136, v137
  v_cvt_pk_bf16_f32 v157, v138, v139
  v_cvt_pk_bf16_f32 v158, v140, v141
  v_cvt_pk_bf16_f32 v159, v142, v143
  s_barrier
  ds_read_b128 v[112:115], v3
  ds_read_b128 v[116:119], v3 offset:1024
  ds_read_b128 v[120:123], v3 offset:2048
  ds_read_b128 v[124:127], v3 offset:3072
  ds_read_b128 v[160:163], v3 offset:4096
  ds_read_b128 v[164:167], v3 offset:5120
  ds_read_b128 v[168:171], v3 offset:6144
  v_permlane16_swap_b32 v144, v148
  v_permlane16_swap_b32 v145, v149
  v_permlane16_swap_b32 v146, v150
  v_permlane16_swap_b32 v147, v151
  v_permlane16_swap_b32 v152, v156
  v_permlane16_swap_b32 v153, v157
  v_permlane16_swap_b32 v154, v158
  v_permlane16_swap_b32 v155, v159
  s_add_u32 s24, s10, 6291456
  s_addc_u32 s25, s11, 0
  s_and_b32 s25, s25, 0xffff
  s_mov_b32 s26, 4194304
  s_mov_b32 s27, 0x20000
  v_mov_b32 v140, 0xdddddddd
  v_and_b32 v12, 7, v2
  v_mov_b32 v13, 0x3f803f80
  s_waitcnt lgkmcnt(5)
  v_mfma_f32_32x32x16_bf16 v[16:31], v[112:115], v[144:147], 0
  v_cmp_eq_u32 vcc, 0, v12
  v_mfma_f32_32x32x16_bf16 v[96:111], v[112:115], v[152:155], 0
  v_mov_b32 v141, v3
  v_add_u32 v142, 0x8000, v3
  v_cndmask_b32 v136, 0, v13, vcc
  v_cndmask_b32 v137, 0, v13, vcc
  v_mfma_f32_32x32x16_bf16 v[16:31], v[116:119], v[148:151], v[16:31]
  v_cmp_eq_u32 vcc, 4, v12
  v_mfma_f32_32x32x16_bf16 v[96:111], v[116:119], v[156:159], v[96:111]
  v_mov_b64 v[172:173], 0
  v_mov_b64 v[174:175], 0
  v_cndmask_b32 v138, 0, v13, vcc
  v_cndmask_b32 v139, 0, v13, vcc
  v_mov_b64 v[48:49], 0
  v_mov_b64 v[64:65], 0
  v_mov_b64 v[50:51], 0
  v_mov_b64 v[66:67], 0
  v_mov_b64 v[52:53], 0
  v_mov_b64 v[68:69], 0
  v_mov_b64 v[54:55], 0
  v_mov_b64 v[70:71], 0
  v_mov_b64 v[56:57], 0
  v_mov_b64 v[72:73], 0
  v_mov_b64 v[58:59], 0
  v_mov_b64 v[74:75], 0
  v_mov_b64 v[60:61], 0
  v_mov_b64 v[76:77], 0
  v_mov_b64 v[62:63], 0
  v_mov_b64 v[78:79], 0
  v_mov_b64 v[128:129], 0
  v_mov_b64 v[132:133], 0
  v_mov_b64 v[130:131], 0
  v_mov_b64 v[134:135], 0
  v_max3_f32 v12, v16, v17, v18
  v_max3_f32 v12, v12, v19, v20
  v_max3_f32 v12, v12, v21, v22
  v_max3_f32 v12, v12, v23, v24
  v_max3_f32 v12, v12, v25, v26
  v_max3_f32 v12, v12, v27, v28
  v_max3_f32 v12, v12, v29, v30
  v_max_f32 v12, v12, v31
  v_max3_f32 v14, v96, v97, v98
  v_max3_f32 v14, v14, v99, v100
  v_max3_f32 v14, v14, v101, v102
  v_max3_f32 v14, v14, v103, v104
  v_max3_f32 v14, v14, v105, v106
  v_max3_f32 v14, v14, v107, v108
  v_max3_f32 v14, v14, v109, v110
  v_max_f32 v14, v14, v111
  v_mov_b32 v13, v12
  v_mov_b32 v15, v14
  s_nop 1
  v_permlane32_swap_b32 v12, v13
  v_permlane32_swap_b32 v14, v15
  v_max_f32 v12, v12, v13
  v_max_f32 v14, v14, v15
  v_sub_f32 v12, 0, v12
  v_sub_f32 v14, 0, v14
  v_mov_b32 v13, v12
  v_mov_b32 v15, v14
  v_mov_b64 v[80:81], v[12:13]
  v_mov_b64 v[82:83], v[12:13]
  v_mov_b64 v[84:85], v[12:13]
  v_mov_b64 v[86:87], v[12:13]
  v_mov_b64 v[88:89], v[12:13]
  v_mov_b64 v[90:91], v[12:13]
  v_mov_b64 v[92:93], v[12:13]
  v_mov_b64 v[94:95], v[12:13]
  v_mov_b64 v[96:97], v[14:15]
  v_mov_b64 v[98:99], v[14:15]
  v_mov_b64 v[100:101], v[14:15]
  v_mov_b64 v[102:103], v[14:15]
  v_mov_b64 v[104:105], v[14:15]
  v_mov_b64 v[106:107], v[14:15]
  v_mov_b64 v[108:109], v[14:15]
  v_mov_b64 v[110:111], v[14:15]
  v_pk_add_f32 v[16:17], v[16:17], v[12:13]
  v_pk_add_f32 v[18:19], v[18:19], v[12:13]
  v_pk_add_f32 v[20:21], v[20:21], v[12:13]
  v_pk_add_f32 v[22:23], v[22:23], v[12:13]
  v_pk_add_f32 v[24:25], v[24:25], v[12:13]
  v_pk_add_f32 v[26:27], v[26:27], v[12:13]
  v_pk_add_f32 v[28:29], v[28:29], v[12:13]
  v_pk_add_f32 v[30:31], v[30:31], v[12:13]
  s_mov_b32 s56, 0
  s_mov_b32 s61, 0x8000
  s_waitcnt lgkmcnt(0)
.p2align 6
L_attn_loop:
  v_exp_f32 v16, v16
  v_exp_f32 v17, v17
  v_smfmac_f32_32x32x32_bf16 v[64:79], v[172:175], v[40:47], v140
  s_add_u32 s61, s61, 0x8000
  v_exp_f32 v18, v18
  v_exp_f32 v19, v19
  v_exp_f32 v20, v20
  v_smfmac_f32_16x16x64_bf16 v[132:135], v[136:139], v[40:47], v140
  ds_read_b128 v[172:175], v141 offset:7168
  v_exp_f32 v21, v21
  v_mfma_f32_32x32x16_bf16 v[32:47], v[112:115], v[152:155], v[96:111]
  v_exp_f32 v22, v22
  v_exp_f32 v23, v23
  v_exp_f32 v24, v24
  v_mfma_f32_32x32x16_bf16 v[32:47], v[116:119], v[156:159], v[32:47]
  s_waitcnt lgkmcnt(2)
  v_exp_f32 v25, v25
  v_exp_f32 v26, v26
  v_exp_f32 v27, v27
  v_smfmac_f32_32x32x32_bf16 v[48:63], v[120:123], v[16:23], v140
  s_nop 0
  v_exp_f32 v28, v28
  v_exp_f32 v29, v29
  v_exp_f32 v30, v30
  v_smfmac_f32_16x16x64_bf16 v[128:131], v[136:139], v[16:23], v140
  ds_read_b128 v[112:115], v141 offset:8192
  v_exp_f32 v31, v31
  v_exp_f32 v32, v32
  v_exp_f32 v33, v33
  v_smfmac_f32_32x32x32_bf16 v[48:63], v[124:127], v[24:31], v140
  s_and_b32 s61, s61, 0x1ffff
  v_exp_f32 v34, v34
  v_exp_f32 v35, v35
  v_exp_f32 v36, v36
  v_smfmac_f32_16x16x64_bf16 v[128:131], v[136:139], v[24:31], v140
  ds_read_b128 v[116:119], v141 offset:9216
  v_exp_f32 v37, v37
  v_mfma_f32_32x32x16_bf16 v[16:31], v[160:163], v[144:147], v[80:95]
  v_exp_f32 v38, v38
  v_exp_f32 v39, v39
  v_exp_f32 v40, v40
  v_mfma_f32_32x32x16_bf16 v[16:31], v[164:167], v[148:151], v[16:31]
  s_waitcnt lgkmcnt(3)
  v_exp_f32 v41, v41
  v_exp_f32 v42, v42
  v_exp_f32 v43, v43
  v_smfmac_f32_32x32x32_bf16 v[64:79], v[120:123], v[32:39], v140
  s_nop 0
  v_exp_f32 v44, v44
  v_exp_f32 v45, v45
  v_exp_f32 v46, v46
  v_smfmac_f32_16x16x64_bf16 v[132:135], v[136:139], v[32:39], v140
  ds_read_b128 v[120:123], v141 offset:10240
  v_exp_f32 v47, v47
  v_exp_f32 v16, v16
  v_exp_f32 v17, v17
  v_smfmac_f32_32x32x32_bf16 v[64:79], v[124:127], v[40:47], v140
  v_exp_f32 v18, v18
  v_exp_f32 v19, v19
  v_exp_f32 v20, v20
  v_smfmac_f32_16x16x64_bf16 v[132:135], v[136:139], v[40:47], v140
  ds_read_b128 v[124:127], v141 offset:11264
  v_exp_f32 v21, v21
  v_mfma_f32_32x32x16_bf16 v[32:47], v[160:163], v[152:155], v[96:111]
  v_exp_f32 v22, v22
  v_exp_f32 v23, v23
  v_exp_f32 v24, v24
  v_mfma_f32_32x32x16_bf16 v[32:47], v[164:167], v[156:159], v[32:47]
  s_waitcnt lgkmcnt(2)
  v_exp_f32 v25, v25
  v_exp_f32 v26, v26
  v_exp_f32 v27, v27
  v_smfmac_f32_32x32x32_bf16 v[48:63], v[168:171], v[16:23], v140
  s_nop 0
  v_exp_f32 v28, v28
  v_exp_f32 v29, v29
  v_exp_f32 v30, v30
  v_smfmac_f32_16x16x64_bf16 v[128:131], v[136:139], v[16:23], v140
  ds_read_b128 v[160:163], v141 offset:12288
  v_exp_f32 v31, v31
  v_exp_f32 v32, v32
  v_exp_f32 v33, v33
  v_smfmac_f32_32x32x32_bf16 v[48:63], v[172:175], v[24:31], v140
  v_exp_f32 v34, v34
  v_exp_f32 v35, v35
  v_exp_f32 v36, v36
  v_smfmac_f32_16x16x64_bf16 v[128:131], v[136:139], v[24:31], v140
  ds_read_b128 v[164:167], v141 offset:13312
  v_exp_f32 v37, v37
  v_mfma_f32_32x32x16_bf16 v[16:31], v[112:115], v[144:147], v[80:95]
  v_exp_f32 v38, v38
  v_exp_f32 v39, v39
  v_exp_f32 v40, v40
  v_mfma_f32_32x32x16_bf16 v[16:31], v[116:119], v[148:151], v[16:31]
  s_waitcnt lgkmcnt(3)
  v_exp_f32 v41, v41
  v_exp_f32 v42, v42
  v_exp_f32 v43, v43
  v_smfmac_f32_32x32x32_bf16 v[64:79], v[168:171], v[32:39], v140
  s_nop 0
  v_exp_f32 v44, v44
  v_exp_f32 v45, v45
  v_exp_f32 v46, v46
  v_smfmac_f32_16x16x64_bf16 v[132:135], v[136:139], v[32:39], v140
  ds_read_b128 v[168:171], v141 offset:14336
  v_exp_f32 v47, v47
  v_exp_f32 v16, v16
  v_exp_f32 v17, v17
  v_smfmac_f32_32x32x32_bf16 v[64:79], v[172:175], v[40:47], v140
  v_exp_f32 v18, v18
  v_exp_f32 v19, v19
  v_exp_f32 v20, v20
  v_smfmac_f32_16x16x64_bf16 v[132:135], v[136:139], v[40:47], v140
  ds_read_b128 v[172:175], v141 offset:15360
  v_exp_f32 v21, v21
  v_mfma_f32_32x32x16_bf16 v[32:47], v[112:115], v[152:155], v[96:111]
  v_exp_f32 v22, v22
  v_exp_f32 v23, v23
  v_exp_f32 v24, v24
  v_mfma_f32_32x32x16_bf16 v[32:47], v[116:119], v[156:159], v[32:47]
  s_waitcnt lgkmcnt(2)
  v_exp_f32 v25, v25
  v_exp_f32 v26, v26
  v_exp_f32 v27, v27
  v_smfmac_f32_32x32x32_bf16 v[48:63], v[120:123], v[16:23], v140
  s_nop 0
  v_exp_f32 v28, v28
  v_exp_f32 v29, v29
  v_exp_f32 v30, v30
  v_smfmac_f32_16x16x64_bf16 v[128:131], v[136:139], v[16:23], v140
  ds_read_b128 v[112:115], v141 offset:16384
  v_exp_f32 v31, v31
  v_exp_f32 v32, v32
  v_exp_f32 v33, v33
  v_smfmac_f32_32x32x32_bf16 v[48:63], v[124:127], v[24:31], v140
  v_exp_f32 v34, v34
  v_exp_f32 v35, v35
  v_exp_f32 v36, v36
  v_smfmac_f32_16x16x64_bf16 v[128:131], v[136:139], v[24:31], v140
  ds_read_b128 v[116:119], v141 offset:17408
  v_exp_f32 v37, v37
  v_mfma_f32_32x32x16_bf16 v[16:31], v[160:163], v[144:147], v[80:95]
  v_exp_f32 v38, v38
  v_exp_f32 v39, v39
  v_exp_f32 v40, v40
  v_mfma_f32_32x32x16_bf16 v[16:31], v[164:167], v[148:151], v[16:31]
  s_waitcnt lgkmcnt(3)
  v_exp_f32 v41, v41
  v_exp_f32 v42, v42
  v_exp_f32 v43, v43
  v_smfmac_f32_32x32x32_bf16 v[64:79], v[120:123], v[32:39], v140
  s_nop 0
  v_exp_f32 v44, v44
  v_exp_f32 v45, v45
  v_exp_f32 v46, v46
  v_smfmac_f32_16x16x64_bf16 v[132:135], v[136:139], v[32:39], v140
  ds_read_b128 v[120:123], v141 offset:18432
  v_exp_f32 v47, v47
  v_exp_f32 v16, v16
  v_exp_f32 v17, v17
  v_smfmac_f32_32x32x32_bf16 v[64:79], v[124:127], v[40:47], v140
  v_exp_f32 v18, v18
  v_exp_f32 v19, v19
  v_exp_f32 v20, v20
  v_smfmac_f32_16x16x64_bf16 v[132:135], v[136:139], v[40:47], v140
  ds_read_b128 v[124:127], v141 offset:19456
  v_exp_f32 v21, v21
  v_mfma_f32_32x32x16_bf16 v[32:47], v[160:163], v[152:155], v[96:111]
  v_exp_f32 v22, v22
  v_exp_f32 v23, v23
  v_exp_f32 v24, v24
  v_mfma_f32_32x32x16_bf16 v[32:47], v[164:167], v[156:159], v[32:47]
  s_waitcnt lgkmcnt(2)
  v_exp_f32 v25, v25
  v_exp_f32 v26, v26
  v_exp_f32 v27, v27
  v_smfmac_f32_32x32x32_bf16 v[48:63], v[168:171], v[16:23], v140
  s_nop 0
  v_exp_f32 v28, v28
  v_exp_f32 v29, v29
  v_exp_f32 v30, v30
  v_smfmac_f32_16x16x64_bf16 v[128:131], v[136:139], v[16:23], v140
  ds_read_b128 v[160:163], v141 offset:20480
  v_exp_f32 v31, v31
  v_exp_f32 v32, v32
  v_exp_f32 v33, v33
  v_smfmac_f32_32x32x32_bf16 v[48:63], v[172:175], v[24:31], v140
  v_exp_f32 v34, v34
  v_exp_f32 v35, v35
  v_exp_f32 v36, v36
  v_smfmac_f32_16x16x64_bf16 v[128:131], v[136:139], v[24:31], v140
  ds_read_b128 v[164:167], v141 offset:21504
  v_exp_f32 v37, v37
  v_mfma_f32_32x32x16_bf16 v[16:31], v[112:115], v[144:147], v[80:95]
  v_exp_f32 v38, v38
  v_exp_f32 v39, v39
  v_exp_f32 v40, v40
  v_mfma_f32_32x32x16_bf16 v[16:31], v[116:119], v[148:151], v[16:31]
  s_waitcnt lgkmcnt(3)
  v_exp_f32 v41, v41
  v_exp_f32 v42, v42
  v_exp_f32 v43, v43
  v_smfmac_f32_32x32x32_bf16 v[64:79], v[168:171], v[32:39], v140
  s_nop 0
  v_exp_f32 v44, v44
  v_exp_f32 v45, v45
  v_exp_f32 v46, v46
  v_smfmac_f32_16x16x64_bf16 v[132:135], v[136:139], v[32:39], v140
  ds_read_b128 v[168:171], v141 offset:22528
  v_exp_f32 v47, v47
  v_exp_f32 v16, v16
  v_exp_f32 v17, v17
  v_smfmac_f32_32x32x32_bf16 v[64:79], v[172:175], v[40:47], v140
  v_exp_f32 v18, v18
  v_exp_f32 v19, v19
  v_exp_f32 v20, v20
  v_smfmac_f32_16x16x64_bf16 v[132:135], v[136:139], v[40:47], v140
  ds_read_b128 v[172:175], v141 offset:23552
  v_exp_f32 v21, v21
  v_mfma_f32_32x32x16_bf16 v[32:47], v[112:115], v[152:155], v[96:111]
  v_exp_f32 v22, v22
  v_exp_f32 v23, v23
  v_exp_f32 v24, v24
  v_mfma_f32_32x32x16_bf16 v[32:47], v[116:119], v[156:159], v[32:47]
  s_waitcnt lgkmcnt(2)
  v_exp_f32 v25, v25
  v_exp_f32 v26, v26
  v_exp_f32 v27, v27
  v_smfmac_f32_32x32x32_bf16 v[48:63], v[120:123], v[16:23], v140
  s_nop 0
  v_exp_f32 v28, v28
  v_exp_f32 v29, v29
  v_exp_f32 v30, v30
  v_smfmac_f32_16x16x64_bf16 v[128:131], v[136:139], v[16:23], v140
  ds_read_b128 v[112:115], v141 offset:24576
  v_exp_f32 v31, v31
  v_exp_f32 v32, v32
  v_exp_f32 v33, v33
  v_smfmac_f32_32x32x32_bf16 v[48:63], v[124:127], v[24:31], v140
  v_exp_f32 v34, v34
  v_exp_f32 v35, v35
  v_exp_f32 v36, v36
  v_smfmac_f32_16x16x64_bf16 v[128:131], v[136:139], v[24:31], v140
  ds_read_b128 v[116:119], v141 offset:25600
  v_exp_f32 v37, v37
  v_mfma_f32_32x32x16_bf16 v[16:31], v[160:163], v[144:147], v[80:95]
  v_exp_f32 v38, v38
  v_exp_f32 v39, v39
  v_exp_f32 v40, v40
  v_mfma_f32_32x32x16_bf16 v[16:31], v[164:167], v[148:151], v[16:31]
  s_waitcnt lgkmcnt(3)
  v_exp_f32 v41, v41
  v_exp_f32 v42, v42
  v_exp_f32 v43, v43
  v_smfmac_f32_32x32x32_bf16 v[64:79], v[120:123], v[32:39], v140
  s_nop 0
  v_exp_f32 v44, v44
  v_exp_f32 v45, v45
  v_exp_f32 v46, v46
  v_smfmac_f32_16x16x64_bf16 v[132:135], v[136:139], v[32:39], v140
  ds_read_b128 v[120:123], v141 offset:26624
  v_exp_f32 v47, v47
  v_exp_f32 v16, v16
  v_exp_f32 v17, v17
  v_smfmac_f32_32x32x32_bf16 v[64:79], v[124:127], v[40:47], v140
  v_exp_f32 v18, v18
  v_exp_f32 v19, v19
  v_exp_f32 v20, v20
  v_smfmac_f32_16x16x64_bf16 v[132:135], v[136:139], v[40:47], v140
  ds_read_b128 v[124:127], v141 offset:27648
  v_exp_f32 v21, v21
  v_mfma_f32_32x32x16_bf16 v[32:47], v[160:163], v[152:155], v[96:111]
  v_exp_f32 v22, v22
  v_exp_f32 v23, v23
  v_exp_f32 v24, v24
  v_mfma_f32_32x32x16_bf16 v[32:47], v[164:167], v[156:159], v[32:47]
  s_waitcnt lgkmcnt(2)
  v_exp_f32 v25, v25
  v_exp_f32 v26, v26
  v_exp_f32 v27, v27
  v_smfmac_f32_32x32x32_bf16 v[48:63], v[168:171], v[16:23], v140
  s_nop 0
  v_exp_f32 v28, v28
  v_exp_f32 v29, v29
  v_exp_f32 v30, v30
  v_smfmac_f32_16x16x64_bf16 v[128:131], v[136:139], v[16:23], v140
  ds_read_b128 v[160:163], v141 offset:28672
  v_exp_f32 v31, v31
  v_exp_f32 v32, v32
  v_exp_f32 v33, v33
  v_smfmac_f32_32x32x32_bf16 v[48:63], v[172:175], v[24:31], v140
  v_exp_f32 v34, v34
  v_exp_f32 v35, v35
  v_exp_f32 v36, v36
  v_smfmac_f32_16x16x64_bf16 v[128:131], v[136:139], v[24:31], v140
  ds_read_b128 v[164:167], v141 offset:29696
  v_exp_f32 v37, v37
  v_mfma_f32_32x32x16_bf16 v[16:31], v[112:115], v[144:147], v[80:95]
  v_exp_f32 v38, v38
  v_exp_f32 v39, v39
  v_exp_f32 v40, v40
  v_mfma_f32_32x32x16_bf16 v[16:31], v[116:119], v[148:151], v[16:31]
  s_waitcnt lgkmcnt(3)
  v_exp_f32 v41, v41
  v_exp_f32 v42, v42
  v_exp_f32 v43, v43
  v_smfmac_f32_32x32x32_bf16 v[64:79], v[168:171], v[32:39], v140
  s_nop 0
  v_exp_f32 v44, v44
  v_exp_f32 v45, v45
  v_exp_f32 v46, v46
  v_smfmac_f32_16x16x64_bf16 v[132:135], v[136:139], v[32:39], v140
  ds_read_b128 v[168:171], v141 offset:30720
  v_exp_f32 v47, v47
  v_exp_f32 v16, v16
  v_exp_f32 v17, v17
  v_smfmac_f32_32x32x32_bf16 v[64:79], v[172:175], v[40:47], v140
  v_exp_f32 v18, v18
  v_exp_f32 v19, v19
  v_exp_f32 v20, v20
  v_smfmac_f32_16x16x64_bf16 v[132:135], v[136:139], v[40:47], v140
  ds_read_b128 v[172:175], v141 offset:31744
  v_exp_f32 v21, v21
  v_mfma_f32_32x32x16_bf16 v[32:47], v[112:115], v[152:155], v[96:111]
  s_bitcmp1_b32 0x2a, s56
  v_exp_f32 v22, v22
  v_exp_f32 v23, v23
  v_exp_f32 v24, v24
  v_mfma_f32_32x32x16_bf16 v[32:47], v[116:119], v[156:159], v[32:47]
  s_waitcnt lgkmcnt(2)
  v_exp_f32 v25, v25
  v_exp_f32 v26, v26
  v_exp_f32 v27, v27
  v_smfmac_f32_32x32x32_bf16 v[48:63], v[120:123], v[16:23], v140
  s_cbranch_scc1 L_attn_bar
L_attn_barret:
  v_exp_f32 v28, v28
  v_exp_f32 v29, v29
  v_exp_f32 v30, v30
  v_smfmac_f32_16x16x64_bf16 v[128:131], v[136:139], v[16:23], v140
  ds_read_b128 v[112:115], v142 offset:0
  v_exp_f32 v31, v31
  v_exp_f32 v32, v32
  v_exp_f32 v33, v33
  v_smfmac_f32_32x32x32_bf16 v[48:63], v[124:127], v[24:31], v140
  v_exp_f32 v34, v34
  v_exp_f32 v35, v35
  v_exp_f32 v36, v36
  v_smfmac_f32_16x16x64_bf16 v[128:131], v[136:139], v[24:31], v140
  ds_read_b128 v[116:119], v142 offset:1024
  v_exp_f32 v37, v37
  v_mfma_f32_32x32x16_bf16 v[16:31], v[160:163], v[144:147], v[80:95]
  v_exp_f32 v38, v38
  v_exp_f32 v39, v39
  v_exp_f32 v40, v40
  v_mfma_f32_32x32x16_bf16 v[16:31], v[164:167], v[148:151], v[16:31]
  s_waitcnt lgkmcnt(3)
  v_exp_f32 v41, v41
  v_exp_f32 v42, v42
  v_exp_f32 v43, v43
  v_smfmac_f32_32x32x32_bf16 v[64:79], v[120:123], v[32:39], v140
  s_nop 0
  v_exp_f32 v44, v44
  v_exp_f32 v45, v45
  v_exp_f32 v46, v46
  v_smfmac_f32_16x16x64_bf16 v[132:135], v[136:139], v[32:39], v140
  ds_read_b128 v[120:123], v142 offset:2048
  v_exp_f32 v47, v47
  v_exp_f32 v16, v16
  v_exp_f32 v17, v17
  v_smfmac_f32_32x32x32_bf16 v[64:79], v[124:127], v[40:47], v140
  v_exp_f32 v18, v18
  v_exp_f32 v19, v19
  v_exp_f32 v20, v20
  v_smfmac_f32_16x16x64_bf16 v[132:135], v[136:139], v[40:47], v140
  ds_read_b128 v[124:127], v142 offset:3072
  v_exp_f32 v21, v21
  v_mfma_f32_32x32x16_bf16 v[32:47], v[160:163], v[152:155], v[96:111]
  v_exp_f32 v22, v22
  v_exp_f32 v23, v23
  v_exp_f32 v24, v24
  v_mfma_f32_32x32x16_bf16 v[32:47], v[164:167], v[156:159], v[32:47]
  s_waitcnt lgkmcnt(2)
  v_exp_f32 v25, v25
  v_exp_f32 v26, v26
  v_exp_f32 v27, v27
  v_smfmac_f32_32x32x32_bf16 v[48:63], v[168:171], v[16:23], v140
  s_nop 0
  v_exp_f32 v28, v28
  v_exp_f32 v29, v29
  v_exp_f32 v30, v30
  v_smfmac_f32_16x16x64_bf16 v[128:131], v[136:139], v[16:23], v140
  ds_read_b128 v[160:163], v142 offset:4096
  v_exp_f32 v31, v31
  v_exp_f32 v32, v32
  v_exp_f32 v33, v33
  v_smfmac_f32_32x32x32_bf16 v[48:63], v[172:175], v[24:31], v140
  s_add_u32 s56, s56, 1
  v_exp_f32 v34, v34
  v_exp_f32 v35, v35
  v_exp_f32 v36, v36
  v_smfmac_f32_16x16x64_bf16 v[128:131], v[136:139], v[24:31], v140
  ds_read_b128 v[164:167], v142 offset:5120
  v_exp_f32 v37, v37
  v_mfma_f32_32x32x16_bf16 v[16:31], v[112:115], v[144:147], v[80:95]
  v_exp_f32 v38, v38
  v_exp_f32 v39, v39
  v_exp_f32 v40, v40
  v_mfma_f32_32x32x16_bf16 v[16:31], v[116:119], v[148:151], v[16:31]
  s_waitcnt lgkmcnt(3)
  v_exp_f32 v41, v41
  v_exp_f32 v42, v42
  v_exp_f32 v43, v43
  v_smfmac_f32_32x32x32_bf16 v[64:79], v[168:171], v[32:39], v140
  s_cmp_lt_u32 s56, 8
  v_exp_f32 v44, v44
  v_exp_f32 v45, v45
  v_exp_f32 v46, v46
  v_smfmac_f32_16x16x64_bf16 v[132:135], v[136:139], v[32:39], v140
  ds_read_b128 v[168:171], v142 offset:6144
  v_mov_b32 v141, v142
  v_add_u32 v142, s61, v3
  v_exp_f32 v47, v47
  s_cbranch_scc1 L_attn_loop
  s_nop 0
  v_smfmac_f32_32x32x32_bf16 v[64:79], v[172:175], v[40:47], v140
  v_smfmac_f32_16x16x64_bf16 v[132:135], v[136:139], v[40:47], v140
  s_mov_b32 s52, 0x7f000000
  s_mov_b32 s53, 0x67800000
  v_max3_f32 v12, |v48|, |v49|, |v50|
  v_max3_f32 v12, v12, |v51|, |v52|
  v_max3_f32 v12, v12, |v53|, |v54|
  v_max3_f32 v12, v12, |v55|, |v56|
  v_max3_f32 v12, v12, |v57|, |v58|
  v_max3_f32 v12, v12, |v59|, |v60|
  v_max3_f32 v12, v12, |v61|, |v62|
  v_cmp_nlt_f32 s[48:49], v128, s53
  v_cmp_nlt_f32 vcc, v132, s53
  s_nop 0
  v_max3_f32 v12, v12, |v63|, |v64|
  v_max3_f32 v12, v12, |v65|, |v66|
  v_max3_f32 v12, v12, |v67|, |v68|
  v_max3_f32 v12, v12, |v69|, |v70|
  v_max3_f32 v12, v12, |v71|, |v72|
  v_max3_f32 v12, v12, |v73|, |v74|
  v_max3_f32 v12, v12, |v75|, |v76|
  v_max3_f32 v12, v12, |v77|, |v78|
  v_max_f32 v12, v12, |v79|
  v_cmp_nlt_f32 s[54:55], v12, s52
  s_or_b64 s[48:49], s[48:49], vcc
  s_or_b64 s[54:55], s[54:55], s[48:49]
  s_cbranch_scc1 L_attn_fallback
L_attn_norm:
  v_rcp_f32 v128, v128
  v_rcp_f32 v132, v132
  v_bfe_u32 v11, v2, 4, 1
  v_lshlrev_b32 v11, 10, v11
  v_lshrrev_b32 v15, 5, v2
  v_lshl_add_u32 v11, v15, 8, v11
  v_and_b32 v15, 15, v2
  v_lshl_add_u32 v11, v15, 4, v11
  s_lshl_b32 s50, s40, 18
  s_lshl_b32 s51, s41, 14
  s_add_u32 s50, s50, s51
  s_lshl_b32 s51, s42, 12
  s_add_u32 s50, s50, s51
  v_pk_mul_f32 v[48:49], v[48:49], v[128:129] op_sel_hi:[1,0]
  v_pk_mul_f32 v[50:51], v[50:51], v[128:129] op_sel_hi:[1,0]
  v_pk_mul_f32 v[52:53], v[52:53], v[128:129] op_sel_hi:[1,0]
  v_pk_mul_f32 v[54:55], v[54:55], v[128:129] op_sel_hi:[1,0]
  v_cvt_pk_bf16_f32 v16, v48, v49
  v_cvt_pk_bf16_f32 v17, v50, v51
  v_cvt_pk_bf16_f32 v18, v52, v53
  v_cvt_pk_bf16_f32 v19, v54, v55
  v_min_u32 v16, -2, v16
  v_min_u32 v17, -2, v17
  v_min_u32 v18, -2, v18
  v_min_u32 v19, -2, v19
  buffer_store_dwordx4 v[16:19], v11, s[24:27], s50 offen offset:0 sc0 sc1
  v_pk_mul_f32 v[56:57], v[56:57], v[128:129] op_sel_hi:[1,0]
  v_pk_mul_f32 v[58:59], v[58:59], v[128:129] op_sel_hi:[1,0]
  v_pk_mul_f32 v[60:61], v[60:61], v[128:129] op_sel_hi:[1,0]
  v_pk_mul_f32 v[62:63], v[62:63], v[128:129] op_sel_hi:[1,0]
  v_cvt_pk_bf16_f32 v20, v56, v57
  v_cvt_pk_bf16_f32 v21, v58, v59
  v_cvt_pk_bf16_f32 v22, v60, v61
  v_cvt_pk_bf16_f32 v23, v62, v63
  v_min_u32 v20, -2, v20
  v_min_u32 v21, -2, v21
  v_min_u32 v22, -2, v22
  v_min_u32 v23, -2, v23
  buffer_store_dwordx4 v[20:23], v11, s[24:27], s50 offen offset:512 sc0 sc1
  v_pk_mul_f32 v[64:65], v[64:65], v[132:133] op_sel_hi:[1,0]
  v_pk_mul_f32 v[66:67], v[66:67], v[132:133] op_sel_hi:[1,0]
  v_pk_mul_f32 v[68:69], v[68:69], v[132:133] op_sel_hi:[1,0]
  v_pk_mul_f32 v[70:71], v[70:71], v[132:133] op_sel_hi:[1,0]
  v_cvt_pk_bf16_f32 v24, v64, v65
  v_cvt_pk_bf16_f32 v25, v66, v67
  v_cvt_pk_bf16_f32 v26, v68, v69
  v_cvt_pk_bf16_f32 v27, v70, v71
  v_min_u32 v24, -2, v24
  v_min_u32 v25, -2, v25
  v_min_u32 v26, -2, v26
  v_min_u32 v27, -2, v27
  buffer_store_dwordx4 v[24:27], v11, s[24:27], s50 offen offset:2048 sc0 sc1
  v_pk_mul_f32 v[72:73], v[72:73], v[132:133] op_sel_hi:[1,0]
  v_pk_mul_f32 v[74:75], v[74:75], v[132:133] op_sel_hi:[1,0]
  v_pk_mul_f32 v[76:77], v[76:77], v[132:133] op_sel_hi:[1,0]
  v_pk_mul_f32 v[78:79], v[78:79], v[132:133] op_sel_hi:[1,0]
  v_cvt_pk_bf16_f32 v28, v72, v73
  v_cvt_pk_bf16_f32 v29, v74, v75
  v_cvt_pk_bf16_f32 v30, v76, v77
  v_cvt_pk_bf16_f32 v31, v78, v79
  v_min_u32 v28, -2, v28
  v_min_u32 v29, -2, v29
  v_min_u32 v30, -2, v30
  v_min_u32 v31, -2, v31
  buffer_store_dwordx4 v[28:31], v11, s[24:27], s50 offen offset:2560 sc0 sc1
  s_add_u32 s32, s10, 5767168
  s_addc_u32 s33, s11, 0
  s_and_b32 s33, s33, 0xffff
  s_mov_b32 s34, 524288
  s_mov_b32 s35, 0x20000
  s_lshr_b32 s50, s50, 5
  s_add_u32 s50, s50, 262144
  v_mov_b32 v12, 0
  v_mov_b32 v13, 1
  s_waitcnt lgkmcnt(0)
  s_barrier
  s_waitcnt vmcnt(0)
  buffer_store_dword v13, v12, s[32:35], s50 offen sc0 sc1
  s_and_b32 s43, s42, 1
  s_lshr_b32 s44, s42, 1
  v_and_b32 v4, 15, v2
  v_lshrrev_b32 v5, 4, v2
  s_add_u32 s20, s10, 10485760
  s_addc_u32 s21, s11, 0
  s_and_b32 s21, s21, 0xffff
  s_mov_b32 s22, 8388608
  s_mov_b32 s23, 0x20000
  s_mov_b32 s28, s6
  s_and_b32 s29, s7, 0xffff
  s_mov_b32 s30, 4194304
  s_mov_b32 s31, 0x20000
  s_add_u32 s32, s10, 5767168
  s_addc_u32 s33, s11, 0
  s_and_b32 s33, s33, 0xffff
  s_mov_b32 s34, 524288
  s_mov_b32 s35, 0x20000
  s_lshl_b32 s59, s40, 18
  s_lshl_b32 s58, s41, 14
  s_add_u32 s59, s59, s58
  s_lshl_b32 s58, s42, 12
  s_add_u32 s59, s59, s58
  s_lshl_b32 s60, s40, 18
  s_lshl_b32 s58, s43, 17
  s_add_u32 s60, s60, s58
  s_lshl_b32 s58, s41, 7
  s_add_u32 s60, s60, s58
  s_lshl_b32 s58, s44, 6
  s_add_u32 s60, s60, s58
  s_lshl_b32 s58, s44, 7
  s_add_u32 s58, s58, 159744
  v_lshl_add_u32 v6, v5, 4, s58
  v_lshlrev_b32 v7, 11, v4
  v_lshl_add_u32 v7, v5, 3, v7
  v_mov_b32 v230, 0
  v_lshlrev_b32 v228, 7, v2
  s_lshl_b32 s65, s40, 13
  s_add_u32 s65, s65, 262144
  s_lshl_b32 s45, s43, 12
  v_add_u32 v8, s45, v3
  s_mul_i32 s46, s44, 2048
  s_add_u32 s46, s46, 16384
  v_add_u32 v9, s46, v3
  s_mov_b32 s53, 0
  v_mov_b32 v108, 0
  v_mov_b32 v109, 0
  v_mov_b32 v110, 0
  v_mov_b32 v111, 0
  v_mov_b32 v112, 0
  v_mov_b32 v113, 0
  v_mov_b32 v114, 0
  v_mov_b32 v115, 0
  v_mov_b32 v116, 0
  v_mov_b32 v117, 0
  v_mov_b32 v118, 0
  v_mov_b32 v119, 0
  v_mov_b32 v120, 0
  v_mov_b32 v121, 0
  v_mov_b32 v122, 0
  v_mov_b32 v123, 0
  v_mov_b32 v124, 0
  v_mov_b32 v125, 0
  v_mov_b32 v126, 0
  v_mov_b32 v127, 0
  v_mov_b32 v128, 0
  v_mov_b32 v129, 0
  v_mov_b32 v130, 0
  v_mov_b32 v131, 0
  v_mov_b32 v132, 0
  v_mov_b32 v133, 0
  v_mov_b32 v134, 0
  v_mov_b32 v135, 0
  v_mov_b32 v136, 0
  v_mov_b32 v137, 0
  v_mov_b32 v138, 0
  v_mov_b32 v139, 0
  v_add_u32 v10, s53, v8
  v_add_u32 v11, s53, v9
  s_add_u32 s53, s53, 24576
  s_cmp_eq_u32 s53, 147456
  s_cselect_b32 s53, 0, s53
  s_barrier
  ds_read_b128 v[28:31], v11 offset:0
  ds_read_b128 v[12:15], v10 offset:0
  ds_read_b128 v[16:19], v10 offset:1024
  ds_read_b128 v[20:23], v10 offset:2048
  ds_read_b128 v[24:27], v10 offset:3072
  ds_read_b128 v[32:35], v11 offset:1024
  ds_read_b128 v[52:55], v11 offset:4096
  ds_read_b128 v[36:39], v10 offset:8192
  ds_read_b128 v[40:43], v10 offset:9216
  ds_read_b128 v[44:47], v10 offset:10240
  ds_read_b128 v[48:51], v10 offset:11264
  ds_read_b128 v[56:59], v11 offset:5120
  v_add_u32 v10, s53, v8
  v_add_u32 v11, s53, v9
  s_add_u32 s53, s53, 24576
  s_cmp_eq_u32 s53, 147456
  s_cselect_b32 s53, 0, s53
  s_mov_b32 s56, 8
  s_waitcnt lgkmcnt(0)
.p2align 6
L_bo_cloop:
  s_barrier
  v_mfma_f32_16x16x32_bf16 v[108:111], v[28:31], v[12:15], v[108:111]
  ds_read_b128 v[76:79], v11 offset:0
  ds_read_b128 v[60:63], v10 offset:0
  v_mfma_f32_16x16x32_bf16 v[108:111], v[52:55], v[36:39], v[108:111]
  ds_read_b128 v[64:67], v10 offset:1024
  v_mfma_f32_16x16x32_bf16 v[116:119], v[28:31], v[16:19], v[116:119]
  ds_read_b128 v[68:71], v10 offset:2048
  v_mfma_f32_16x16x32_bf16 v[116:119], v[52:55], v[40:43], v[116:119]
  ds_read_b128 v[72:75], v10 offset:3072
  v_mfma_f32_16x16x32_bf16 v[124:127], v[28:31], v[20:23], v[124:127]
  ds_read_b128 v[80:83], v11 offset:1024
  v_mfma_f32_16x16x32_bf16 v[124:127], v[52:55], v[44:47], v[124:127]
  ds_read_b128 v[100:103], v11 offset:4096
  v_mfma_f32_16x16x32_bf16 v[132:135], v[28:31], v[24:27], v[132:135]
  ds_read_b128 v[84:87], v10 offset:8192
  v_mfma_f32_16x16x32_bf16 v[132:135], v[52:55], v[48:51], v[132:135]
  ds_read_b128 v[88:91], v10 offset:9216
  ds_read_b128 v[92:95], v10 offset:10240
  v_mfma_f32_16x16x32_bf16 v[136:139], v[32:35], v[24:27], v[136:139]
  ds_read_b128 v[96:99], v10 offset:11264
  v_mfma_f32_16x16x32_bf16 v[136:139], v[56:59], v[48:51], v[136:139]
  ds_read_b128 v[104:107], v11 offset:5120
  v_mfma_f32_16x16x32_bf16 v[128:131], v[32:35], v[20:23], v[128:131]
  v_add_u32 v10, s53, v8
  v_mfma_f32_16x16x32_bf16 v[128:131], v[56:59], v[44:47], v[128:131]
  v_add_u32 v11, s53, v9
  v_mfma_f32_16x16x32_bf16 v[120:123], v[32:35], v[16:19], v[120:123]
  s_add_u32 s53, s53, 24576
  v_mfma_f32_16x16x32_bf16 v[120:123], v[56:59], v[40:43], v[120:123]
  s_cmp_eq_u32 s53, 147456
  v_mfma_f32_16x16x32_bf16 v[112:115], v[32:35], v[12:15], v[112:115]
  s_cselect_b32 s53, 0, s53
  v_mfma_f32_16x16x32_bf16 v[112:115], v[56:59], v[36:39], v[112:115]
  s_waitcnt lgkmcnt(0)
  s_barrier
  v_mfma_f32_16x16x32_bf16 v[108:111], v[76:79], v[60:63], v[108:111]
  ds_read_b128 v[28:31], v11 offset:0
  ds_read_b128 v[12:15], v10 offset:0
  v_mfma_f32_16x16x32_bf16 v[108:111], v[100:103], v[84:87], v[108:111]
  ds_read_b128 v[16:19], v10 offset:1024
  v_mfma_f32_16x16x32_bf16 v[116:119], v[76:79], v[64:67], v[116:119]
  ds_read_b128 v[20:23], v10 offset:2048
  v_mfma_f32_16x16x32_bf16 v[116:119], v[100:103], v[88:91], v[116:119]
  ds_read_b128 v[24:27], v10 offset:3072
  v_mfma_f32_16x16x32_bf16 v[124:127], v[76:79], v[68:71], v[124:127]
  ds_read_b128 v[32:35], v11 offset:1024
  v_mfma_f32_16x16x32_bf16 v[124:127], v[100:103], v[92:95], v[124:127]
  ds_read_b128 v[52:55], v11 offset:4096
  v_mfma_f32_16x16x32_bf16 v[132:135], v[76:79], v[72:75], v[132:135]
  ds_read_b128 v[36:39], v10 offset:8192
  v_mfma_f32_16x16x32_bf16 v[132:135], v[100:103], v[96:99], v[132:135]
  ds_read_b128 v[40:43], v10 offset:9216
  ds_read_b128 v[44:47], v10 offset:10240
  v_mfma_f32_16x16x32_bf16 v[136:139], v[80:83], v[72:75], v[136:139]
  ds_read_b128 v[48:51], v10 offset:11264
  v_mfma_f32_16x16x32_bf16 v[136:139], v[104:107], v[96:99], v[136:139]
  ds_read_b128 v[56:59], v11 offset:5120
  v_mfma_f32_16x16x32_bf16 v[128:131], v[80:83], v[68:71], v[128:131]
  v_add_u32 v10, s53, v8
  v_mfma_f32_16x16x32_bf16 v[128:131], v[104:107], v[92:95], v[128:131]
  v_add_u32 v11, s53, v9
  v_mfma_f32_16x16x32_bf16 v[120:123], v[80:83], v[64:67], v[120:123]
  s_add_u32 s53, s53, 24576
  v_mfma_f32_16x16x32_bf16 v[120:123], v[104:107], v[88:91], v[120:123]
  s_cmp_eq_u32 s53, 147456
  v_mfma_f32_16x16x32_bf16 v[112:115], v[80:83], v[60:63], v[112:115]
  s_cselect_b32 s53, 0, s53
  v_mfma_f32_16x16x32_bf16 v[112:115], v[104:107], v[84:87], v[112:115]
  s_waitcnt lgkmcnt(0)
  s_bitcmp1_b32 0x190, s56
  s_cbranch_scc1 L_bo_hook
L_bo_hookret:
  s_sub_u32 s56, s56, 1
  s_cmp_lg_u32 s56, 0
  s_cbranch_scc1 L_bo_cloop
  s_branch L_bo_cdone
L_bo_hook:
  s_cmp_lg_u32 s56, 4
  s_cbranch_scc1 L_bo_hk4
  s_add_u32 s58, s60, 0
  buffer_load_dwordx2 v[148:149], v7, s[28:31], s58 offen
  buffer_load_dwordx2 v[150:151], v7, s[28:31], s58 offen offset:32
  s_add_u32 s58, s60, 32768
  buffer_load_dwordx2 v[152:153], v7, s[28:31], s58 offen
  buffer_load_dwordx2 v[154:155], v7, s[28:31], s58 offen offset:32
  s_add_u32 s58, s60, 65536
  buffer_load_dwordx2 v[156:157], v7, s[28:31], s58 offen
  buffer_load_dwordx2 v[158:159], v7, s[28:31], s58 offen offset:32
  s_add_u32 s58, s60, 98304
  buffer_load_dwordx2 v[160:161], v7, s[28:31], s58 offen
  buffer_load_dwordx2 v[162:163], v7, s[28:31], s58 offen offset:32
  s_branch L_bo_hookret
L_bo_hk4:
  s_cmp_lg_u32 s56, 7
  s_cbranch_scc1 L_bo_hk7
  s_waitcnt vmcnt(0)
  v_cmp_eq_u32 vcc, 0, v229
  s_nop 0
  s_cmp_eq_u64 vcc, 0
  s_cbranch_scc1 L_cgod
  s_mov_b32 s66, 4194304
L_cgo:
  buffer_load_dword v229, v228, s[32:35], s65 offen sc1
  s_waitcnt vmcnt(0)
  v_cmp_eq_u32 vcc, 0, v229
  s_sub_u32 s66, s66, 1
  s_cbranch_scc1 L_cgod
  s_cmp_lg_u64 vcc, 0
  s_cbranch_scc1 L_cgo
L_cgod:
  s_branch L_bo_hookret
L_bo_hk7:
  buffer_load_dword v229, v228, s[32:35], s65 offen sc1
  s_branch L_bo_hookret
L_bo_cdone:
  ds_read_b128 v[140:143], v6
  ds_read_b128 v[144:147], v6 offset:64
  ds_read_b128 v[172:175], v6 offset:512
  ds_read_b128 v[176:179], v6 offset:576
  s_waitcnt vmcnt(0)
  v_lshlrev_b32 v12, 16, v148
  v_and_b32 v13, 0xffff0000, v148
  v_lshlrev_b32 v14, 16, v149
  v_and_b32 v15, 0xffff0000, v149
  v_lshlrev_b32 v16, 16, v150
  v_and_b32 v17, 0xffff0000, v150
  v_lshlrev_b32 v18, 16, v151
  v_and_b32 v19, 0xffff0000, v151
  v_lshlrev_b32 v20, 16, v152
  v_and_b32 v21, 0xffff0000, v152
  v_lshlrev_b32 v22, 16, v153
  v_and_b32 v23, 0xffff0000, v153
  v_lshlrev_b32 v24, 16, v154
  v_and_b32 v25, 0xffff0000, v154
  v_lshlrev_b32 v26, 16, v155
  v_and_b32 v27, 0xffff0000, v155
  v_lshlrev_b32 v28, 16, v156
  v_and_b32 v29, 0xffff0000, v156
  v_lshlrev_b32 v30, 16, v157
  v_and_b32 v31, 0xffff0000, v157
  v_lshlrev_b32 v32, 16, v158
  v_and_b32 v33, 0xffff0000, v158
  v_lshlrev_b32 v34, 16, v159
  v_and_b32 v35, 0xffff0000, v159
  v_lshlrev_b32 v36, 16, v160
  v_and_b32 v37, 0xffff0000, v160
  v_lshlrev_b32 v38, 16, v161
  v_and_b32 v39, 0xffff0000, v161
  v_lshlrev_b32 v40, 16, v162
  v_and_b32 v41, 0xffff0000, v162
  v_lshlrev_b32 v42, 16, v163
  v_and_b32 v43, 0xffff0000, v163
  s_waitcnt lgkmcnt(0)
  v_pk_fma_f32 v[12:13], v[108:109], v[140:141], v[12:13]
  v_pk_fma_f32 v[14:15], v[110:111], v[142:143], v[14:15]
  v_pk_fma_f32 v[16:17], v[112:113], v[144:145], v[16:17]
  v_pk_fma_f32 v[18:19], v[114:115], v[146:147], v[18:19]
  v_pk_fma_f32 v[20:21], v[116:117], v[140:141], v[20:21]
  v_pk_fma_f32 v[22:23], v[118:119], v[142:143], v[22:23]
  v_pk_fma_f32 v[24:25], v[120:121], v[144:145], v[24:25]
  v_pk_fma_f32 v[26:27], v[122:123], v[146:147], v[26:27]
  v_pk_fma_f32 v[28:29], v[124:125], v[140:141], v[28:29]
  v_pk_fma_f32 v[30:31], v[126:127], v[142:143], v[30:31]
  v_pk_fma_f32 v[32:33], v[128:129], v[144:145], v[32:33]
  v_pk_fma_f32 v[34:35], v[130:131], v[146:147], v[34:35]
  v_pk_fma_f32 v[36:37], v[132:133], v[140:141], v[36:37]
  v_pk_fma_f32 v[38:39], v[134:135], v[142:143], v[38:39]
  v_pk_fma_f32 v[40:41], v[136:137], v[144:145], v[40:41]
  v_pk_fma_f32 v[42:43], v[138:139], v[146:147], v[42:43]
  s_add_u32 s58, s59, 4194304
  v_pk_mul_f32 v[108:109], v[12:13], v[172:173]
  v_pk_mul_f32 v[110:111], v[14:15], v[174:175]
  v_pk_mul_f32 v[112:113], v[16:17], v[176:177]
  v_pk_mul_f32 v[114:115], v[18:19], v[178:179]
  v_cvt_pk_bf16_f32 v108, v108, v109
  v_cvt_pk_bf16_f32 v109, v110, v111
  v_cvt_pk_bf16_f32 v110, v112, v113
  v_cvt_pk_bf16_f32 v111, v114, v115
  v_min_u32 v108, -2, v108
  v_min_u32 v109, -2, v109
  v_min_u32 v110, -2, v110
  v_min_u32 v111, -2, v111
  buffer_store_dwordx4 v[108:111], v3, s[20:23], s58 offen offset:0 sc0 sc1
  v_pk_mul_f32 v[116:117], v[20:21], v[172:173]
  v_pk_mul_f32 v[118:119], v[22:23], v[174:175]
  v_pk_mul_f32 v[120:121], v[24:25], v[176:177]
  v_pk_mul_f32 v[122:123], v[26:27], v[178:179]
  v_cvt_pk_bf16_f32 v116, v116, v117
  v_cvt_pk_bf16_f32 v117, v118, v119
  v_cvt_pk_bf16_f32 v118, v120, v121
  v_cvt_pk_bf16_f32 v119, v122, v123
  v_min_u32 v116, -2, v116
  v_min_u32 v117, -2, v117
  v_min_u32 v118, -2, v118
  v_min_u32 v119, -2, v119
  buffer_store_dwordx4 v[116:119], v3, s[20:23], s58 offen offset:1024 sc0 sc1
  v_pk_mul_f32 v[124:125], v[28:29], v[172:173]
  v_pk_mul_f32 v[126:127], v[30:31], v[174:175]
  v_pk_mul_f32 v[128:129], v[32:33], v[176:177]
  v_pk_mul_f32 v[130:131], v[34:35], v[178:179]
  v_cvt_pk_bf16_f32 v124, v124, v125
  v_cvt_pk_bf16_f32 v125, v126, v127
  v_cvt_pk_bf16_f32 v126, v128, v129
  v_cvt_pk_bf16_f32 v127, v130, v131
  v_min_u32 v124, -2, v124
  v_min_u32 v125, -2, v125
  v_min_u32 v126, -2, v126
  v_min_u32 v127, -2, v127
  buffer_store_dwordx4 v[124:127], v3, s[20:23], s58 offen offset:2048 sc0 sc1
  v_pk_mul_f32 v[132:133], v[36:37], v[172:173]
  v_pk_mul_f32 v[134:135], v[38:39], v[174:175]
  v_pk_mul_f32 v[136:137], v[40:41], v[176:177]
  v_pk_mul_f32 v[138:139], v[42:43], v[178:179]
  v_cvt_pk_bf16_f32 v132, v132, v133
  v_cvt_pk_bf16_f32 v133, v134, v135
  v_cvt_pk_bf16_f32 v134, v136, v137
  v_cvt_pk_bf16_f32 v135, v138, v139
  v_min_u32 v132, -2, v132
  v_min_u32 v133, -2, v133
  v_min_u32 v134, -2, v134
  v_min_u32 v135, -2, v135
  buffer_store_dwordx4 v[132:135], v3, s[20:23], s58 offen offset:3072 sc0 sc1
  s_barrier
  v_pk_add_f32 v[44:45], v[12:13], v[14:15]
  v_pk_mul_f32 v[52:53], v[12:13], v[12:13]
  v_pk_add_f32 v[46:47], v[20:21], v[22:23]
  v_pk_mul_f32 v[54:55], v[20:21], v[20:21]
  v_pk_add_f32 v[48:49], v[28:29], v[30:31]
  v_pk_mul_f32 v[56:57], v[28:29], v[28:29]
  v_pk_add_f32 v[50:51], v[36:37], v[38:39]
  v_pk_mul_f32 v[58:59], v[36:37], v[36:37]
  v_pk_add_f32 v[44:45], v[44:45], v[16:17]
  v_pk_fma_f32 v[52:53], v[14:15], v[14:15], v[52:53]
  v_pk_add_f32 v[46:47], v[46:47], v[24:25]
  v_pk_fma_f32 v[54:55], v[22:23], v[22:23], v[54:55]
  v_pk_add_f32 v[48:49], v[48:49], v[32:33]
  v_pk_fma_f32 v[56:57], v[30:31], v[30:31], v[56:57]
  v_pk_add_f32 v[50:51], v[50:51], v[40:41]
  v_pk_fma_f32 v[58:59], v[38:39], v[38:39], v[58:59]
  v_pk_add_f32 v[44:45], v[44:45], v[18:19]
  v_pk_fma_f32 v[52:53], v[16:17], v[16:17], v[52:53]
  v_pk_add_f32 v[46:47], v[46:47], v[26:27]
  v_pk_fma_f32 v[54:55], v[24:25], v[24:25], v[54:55]
  v_pk_add_f32 v[48:49], v[48:49], v[34:35]
  v_pk_fma_f32 v[56:57], v[32:33], v[32:33], v[56:57]
  v_pk_add_f32 v[50:51], v[50:51], v[42:43]
  v_pk_fma_f32 v[58:59], v[40:41], v[40:41], v[58:59]
  v_pk_fma_f32 v[52:53], v[18:19], v[18:19], v[52:53]
  v_pk_fma_f32 v[54:55], v[26:27], v[26:27], v[54:55]
  v_pk_fma_f32 v[56:57], v[34:35], v[34:35], v[56:57]
  v_pk_fma_f32 v[58:59], v[42:43], v[42:43], v[58:59]
  v_add_f32 v44, v44, v45
  v_add_f32 v45, v52, v53
  v_add_f32 v46, v46, v47
  v_add_f32 v47, v54, v55
  v_add_f32 v48, v48, v49
  v_add_f32 v49, v56, v57
  v_add_f32 v50, v50, v51
  v_add_f32 v51, v58, v59
  s_add_u32 s24, s10, 524288
  s_addc_u32 s25, s11, 0
  s_and_b32 s25, s25, 0xffff
  s_mov_b32 s26, 524288
  s_mov_b32 s27, 0x20000
  v_permlane16_swap_b32 v44, v46
  v_permlane16_swap_b32 v48, v50
  v_permlane16_swap_b32 v45, v47
  v_permlane16_swap_b32 v49, v51
  v_pk_add_f32 v[44:45], v[44:45], v[46:47]
  v_pk_add_f32 v[48:49], v[48:49], v[50:51]
  s_lshl_b32 s57, s40, 15
  s_lshl_b32 s58, s41, 11
  s_add_u32 s57, s57, s58
  s_lshl_b32 s58, s42, 9
  s_add_u32 s57, s57, s58
  v_lshlrev_b32 v7, 3, v2
  v_permlane32_swap_b32 v44, v48
  v_permlane32_swap_b32 v45, v49
  v_pk_add_f32 v[44:45], v[44:45], v[48:49]
  buffer_store_dwordx2 v[44:45], v7, s[24:27], s57 offen sc0 sc1
  v_cvt_pk_bf16_f32 v148, v12, v13
  v_cvt_pk_bf16_f32 v149, v14, v15
  v_cvt_pk_bf16_f32 v150, v16, v17
  v_cvt_pk_bf16_f32 v151, v18, v19
  buffer_store_dwordx4 v[148:151], v3, s[20:23], s59 offen offset:0 sc0 sc1
  v_cvt_pk_bf16_f32 v152, v20, v21
  v_cvt_pk_bf16_f32 v153, v22, v23
  v_cvt_pk_bf16_f32 v154, v24, v25
  v_cvt_pk_bf16_f32 v155, v26, v27
  buffer_store_dwordx4 v[152:155], v3, s[20:23], s59 offen offset:1024 sc0 sc1
  v_cvt_pk_bf16_f32 v156, v28, v29
  v_cvt_pk_bf16_f32 v157, v30, v31
  v_cvt_pk_bf16_f32 v158, v32, v33
  v_cvt_pk_bf16_f32 v159, v34, v35
  buffer_store_dwordx4 v[156:159], v3, s[20:23], s59 offen offset:2048 sc0 sc1
  v_cvt_pk_bf16_f32 v160, v36, v37
  v_cvt_pk_bf16_f32 v161, v38, v39
  v_cvt_pk_bf16_f32 v162, v40, v41
  v_cvt_pk_bf16_f32 v163, v42, v43
  buffer_store_dwordx4 v[160:163], v3, s[20:23], s59 offen offset:3072 sc0 sc1
  s_lshr_b32 s57, s57, 2
  v_mov_b32 v231, 1
  s_and_b32 s40, s2, 7
  s_lshr_b32 s3, s2, 3
  s_and_b32 s41, s40, 3
  s_lshl_b32 s41, s41, 2
  s_lshr_b32 s40, s40, 2
  s_lshl_b32 s40, s40, 3
  s_and_b32 s39, s3, 7
  s_or_b32 s40, s40, s39
  s_lshr_b32 s39, s3, 3
  s_or_b32 s41, s41, s39
  s_add_u32 s20, s10, 18874368
  s_addc_u32 s21, s11, 0
  s_and_b32 s21, s21, 0xffff
  s_mov_b32 s22, 14680064
  s_mov_b32 s23, 0x20000
  s_lshl_b32 s65, s40, 13
  s_lshr_b32 s50, s41, 3
  s_and_b32 s51, s41, 7
  s_lshl_b32 s67, s40, 1
  s_add_u32 s67, s67, s50
  s_mul_i32 s48, s67, 458752
  s_lshl_b32 s47, s43, 12
  s_add_u32 s48, s48, s47
  s_lshl_b32 s47, s51, 13
  s_add_u32 s50, s48, s47
  s_add_u32 s48, s50, s47
  s_add_u32 s50, s50, 131072
  s_lshl_b32 s47, s44, 9
  s_add_u32 s50, s50, s47
  v_and_b32 v7, 1, v5
  v_lshlrev_b32 v7, 10, v7
  v_lshrrev_b32 v6, 1, v5
  v_lshl_add_u32 v7, v6, 8, v7
  v_lshl_add_u32 v7, v4, 4, v7
  s_lshl_b32 s47, s44, 13
  s_add_u32 s48, s48, s47
  s_lshl_b32 s67, s67, 12
  s_lshl_b32 s47, s51, 9
  s_add_u32 s67, s67, s47
  s_lshl_b32 s47, s42, 7
  s_add_u32 s67, s67, s47
  s_add_u32 s67, s67, 131072
  s_mov_b32 s52, 0xbfb8aa3b
  s_add_u32 s24, s10, 52428800
  s_addc_u32 s25, s11, 0
  s_and_b32 s25, s25, 0xffff
  s_mov_b32 s26, 4194304
  s_mov_b32 s27, 0x20000
  s_lshl_b32 s63, s2, 14
  s_lshl_b32 s58, s42, 12
  s_add_u32 s63, s63, s58
  s_xor_b32 s64, s63, 0x4000
  s_bfe_u32 s58, s2, 0x20001
  s_lshl_b32 s58, s58, 2
  s_bfe_u32 s59, s2, 0x20003
  s_add_u32 s58, s58, s59
  s_lshl_b32 s58, s58, 1
  s_and_b32 s59, s2, 1
  s_add_u32 s58, s58, s59
  s_lshl_b32 s58, s58, 12
  s_add_u32 s58, s58, 131072
  v_lshl_add_u32 v227, v2, 7, s58
  s_xor_b32 s58, s67, 2048
  v_mov_b32 v226, s58
  v_cmp_gt_u32 vcc, 32, v2
  v_mov_b64 v[212:213], -1
  v_mov_b64 v[214:215], -1
  v_cndmask_b32 v227, v226, v227, vcc
  s_lshl_b32 s45, s43, 12
  v_add_u32 v8, s45, v3
  s_mul_i32 s46, s44, 7168
  s_add_u32 s46, s46, 8192
  v_add_u32 v9, s46, v3
  s_mov_b32 s53, 0
  v_mov_b32 v100, 0
  v_mov_b32 v101, 0
  v_mov_b32 v102, 0
  v_mov_b32 v103, 0
  v_mov_b32 v104, 0
  v_mov_b32 v105, 0
  v_mov_b32 v106, 0
  v_mov_b32 v107, 0
  v_mov_b32 v108, 0
  v_mov_b32 v109, 0
  v_mov_b32 v110, 0
  v_mov_b32 v111, 0
  v_mov_b32 v112, 0
  v_mov_b32 v113, 0
  v_mov_b32 v114, 0
  v_mov_b32 v115, 0
  v_mov_b32 v116, 0
  v_mov_b32 v117, 0
  v_mov_b32 v118, 0
  v_mov_b32 v119, 0
  v_mov_b32 v120, 0
  v_mov_b32 v121, 0
  v_mov_b32 v122, 0
  v_mov_b32 v123, 0
  v_mov_b32 v124, 0
  v_mov_b32 v125, 0
  v_mov_b32 v126, 0
  v_mov_b32 v127, 0
  v_mov_b32 v128, 0
  v_mov_b32 v129, 0
  v_mov_b32 v130, 0
  v_mov_b32 v131, 0
  v_mov_b32 v132, 0
  v_mov_b32 v133, 0
  v_mov_b32 v134, 0
  v_mov_b32 v135, 0
  v_mov_b32 v136, 0
  v_mov_b32 v137, 0
  v_mov_b32 v138, 0
  v_mov_b32 v139, 0
  v_mov_b32 v140, 0
  v_mov_b32 v141, 0
  v_mov_b32 v142, 0
  v_mov_b32 v143, 0
  v_mov_b32 v144, 0
  v_mov_b32 v145, 0
  v_mov_b32 v146, 0
  v_mov_b32 v147, 0
  v_mov_b32 v148, 0
  v_mov_b32 v149, 0
  v_mov_b32 v150, 0
  v_mov_b32 v151, 0
  v_mov_b32 v152, 0
  v_mov_b32 v153, 0
  v_mov_b32 v154, 0
  v_mov_b32 v155, 0
  v_mov_b32 v156, 0
  v_mov_b32 v157, 0
  v_mov_b32 v158, 0
  v_mov_b32 v159, 0
  v_mov_b32 v160, 0
  v_mov_b32 v161, 0
  v_mov_b32 v162, 0
  v_mov_b32 v163, 0
  v_mov_b32 v164, 0
  v_mov_b32 v165, 0
  v_mov_b32 v166, 0
  v_mov_b32 v167, 0
  v_mov_b32 v168, 0
  v_mov_b32 v169, 0
  v_mov_b32 v170, 0
  v_mov_b32 v171, 0
  v_mov_b32 v172, 0
  v_mov_b32 v173, 0
  v_mov_b32 v174, 0
  v_mov_b32 v175, 0
  v_mov_b32 v176, 0
  v_mov_b32 v177, 0
  v_mov_b32 v178, 0
  v_mov_b32 v179, 0
  v_mov_b32 v180, 0
  v_mov_b32 v181, 0
  v_mov_b32 v182, 0
  v_mov_b32 v183, 0
  v_mov_b32 v184, 0
  v_mov_b32 v185, 0
  v_mov_b32 v186, 0
  v_mov_b32 v187, 0
  v_mov_b32 v188, 0
  v_mov_b32 v189, 0
  v_mov_b32 v190, 0
  v_mov_b32 v191, 0
  v_mov_b32 v192, 0
  v_mov_b32 v193, 0
  v_mov_b32 v194, 0
  v_mov_b32 v195, 0
  v_mov_b32 v196, 0
  v_mov_b32 v197, 0
  v_mov_b32 v198, 0
  v_mov_b32 v199, 0
  v_mov_b32 v200, 0
  v_mov_b32 v201, 0
  v_mov_b32 v202, 0
  v_mov_b32 v203, 0
  v_mov_b32 v204, 0
  v_mov_b32 v205, 0
  v_mov_b32 v206, 0
  v_mov_b32 v207, 0
  v_mov_b32 v208, 0
  v_mov_b32 v209, 0
  v_mov_b32 v210, 0
  v_mov_b32 v211, 0
  v_add_u32 v10, s53, v8
  v_add_u32 v11, s53, v9
  s_add_u32 s53, s53, 22528
  s_cmp_eq_u32 s53, 157696
  s_cselect_b32 s53, 0, s53
  s_barrier
  ds_read_b128 v[28:31], v11 offset:0
  ds_read_b128 v[12:15], v10 offset:0
  ds_read_b128 v[16:19], v10 offset:1024
  ds_read_b128 v[20:23], v10 offset:2048
  ds_read_b128 v[24:27], v10 offset:3072
  ds_read_b128 v[32:35], v11 offset:1024
  ds_read_b128 v[36:39], v11 offset:2048
  ds_read_b128 v[40:43], v11 offset:3072
  ds_read_b128 v[44:47], v11 offset:4096
  ds_read_b128 v[48:51], v11 offset:5120
  ds_read_b128 v[52:55], v11 offset:6144
  v_add_u32 v10, s53, v8
  v_add_u32 v11, s53, v9
  s_add_u32 s53, s53, 22528
  s_cmp_eq_u32 s53, 157696
  s_cselect_b32 s53, 0, s53
  s_mov_b32 s56, 16
  s_waitcnt lgkmcnt(0)
.p2align 6
L_b1_cloop:
  s_barrier
  v_mfma_f32_16x16x32_bf16 v[100:103], v[28:31], v[12:15], v[100:103]
  ds_read_b128 v[72:75], v11 offset:0
  v_mfma_f32_16x16x32_bf16 v[128:131], v[28:31], v[16:19], v[128:131]
  ds_read_b128 v[56:59], v10 offset:0
  v_mfma_f32_16x16x32_bf16 v[156:159], v[28:31], v[20:23], v[156:159]
  ds_read_b128 v[60:63], v10 offset:1024
  v_mfma_f32_16x16x32_bf16 v[184:187], v[28:31], v[24:27], v[184:187]
  ds_read_b128 v[64:67], v10 offset:2048
  v_mfma_f32_16x16x32_bf16 v[188:191], v[32:35], v[24:27], v[188:191]
  ds_read_b128 v[68:71], v10 offset:3072
  v_mfma_f32_16x16x32_bf16 v[160:163], v[32:35], v[20:23], v[160:163]
  ds_read_b128 v[76:79], v11 offset:1024
  v_mfma_f32_16x16x32_bf16 v[132:135], v[32:35], v[16:19], v[132:135]
  ds_read_b128 v[80:83], v11 offset:2048
  v_mfma_f32_16x16x32_bf16 v[104:107], v[32:35], v[12:15], v[104:107]
  ds_read_b128 v[84:87], v11 offset:3072
  v_mfma_f32_16x16x32_bf16 v[108:111], v[36:39], v[12:15], v[108:111]
  ds_read_b128 v[88:91], v11 offset:4096
  v_mfma_f32_16x16x32_bf16 v[136:139], v[36:39], v[16:19], v[136:139]
  ds_read_b128 v[92:95], v11 offset:5120
  v_mfma_f32_16x16x32_bf16 v[164:167], v[36:39], v[20:23], v[164:167]
  ds_read_b128 v[96:99], v11 offset:6144
  v_mfma_f32_16x16x32_bf16 v[192:195], v[36:39], v[24:27], v[192:195]
  v_add_u32 v10, s53, v8
  v_mfma_f32_16x16x32_bf16 v[196:199], v[40:43], v[24:27], v[196:199]
  v_add_u32 v11, s53, v9
  v_mfma_f32_16x16x32_bf16 v[168:171], v[40:43], v[20:23], v[168:171]
  s_add_u32 s53, s53, 22528
  v_mfma_f32_16x16x32_bf16 v[140:143], v[40:43], v[16:19], v[140:143]
  s_cmp_eq_u32 s53, 157696
  v_mfma_f32_16x16x32_bf16 v[112:115], v[40:43], v[12:15], v[112:115]
  s_cselect_b32 s53, 0, s53
  v_mfma_f32_16x16x32_bf16 v[116:119], v[44:47], v[12:15], v[116:119]
  v_mfma_f32_16x16x32_bf16 v[144:147], v[44:47], v[16:19], v[144:147]
  v_mfma_f32_16x16x32_bf16 v[172:175], v[44:47], v[20:23], v[172:175]
  v_mfma_f32_16x16x32_bf16 v[200:203], v[44:47], v[24:27], v[200:203]
  v_mfma_f32_16x16x32_bf16 v[204:207], v[48:51], v[24:27], v[204:207]
  v_mfma_f32_16x16x32_bf16 v[176:179], v[48:51], v[20:23], v[176:179]
  v_mfma_f32_16x16x32_bf16 v[148:151], v[48:51], v[16:19], v[148:151]
  v_mfma_f32_16x16x32_bf16 v[120:123], v[48:51], v[12:15], v[120:123]
  v_mfma_f32_16x16x32_bf16 v[124:127], v[52:55], v[12:15], v[124:127]
  v_mfma_f32_16x16x32_bf16 v[152:155], v[52:55], v[16:19], v[152:155]
  v_mfma_f32_16x16x32_bf16 v[180:183], v[52:55], v[20:23], v[180:183]
  v_mfma_f32_16x16x32_bf16 v[208:211], v[52:55], v[24:27], v[208:211]
  s_waitcnt lgkmcnt(0)
  s_barrier
  v_mfma_f32_16x16x32_bf16 v[100:103], v[72:75], v[56:59], v[100:103]
  ds_read_b128 v[28:31], v11 offset:0
  v_mfma_f32_16x16x32_bf16 v[128:131], v[72:75], v[60:63], v[128:131]
  ds_read_b128 v[12:15], v10 offset:0
  v_mfma_f32_16x16x32_bf16 v[156:159], v[72:75], v[64:67], v[156:159]
  ds_read_b128 v[16:19], v10 offset:1024
  v_mfma_f32_16x16x32_bf16 v[184:187], v[72:75], v[68:71], v[184:187]
  ds_read_b128 v[20:23], v10 offset:2048
  v_mfma_f32_16x16x32_bf16 v[188:191], v[76:79], v[68:71], v[188:191]
  ds_read_b128 v[24:27], v10 offset:3072
  v_mfma_f32_16x16x32_bf16 v[160:163], v[76:79], v[64:67], v[160:163]
  ds_read_b128 v[32:35], v11 offset:1024
  v_mfma_f32_16x16x32_bf16 v[132:135], v[76:79], v[60:63], v[132:135]
  ds_read_b128 v[36:39], v11 offset:2048
  v_mfma_f32_16x16x32_bf16 v[104:107], v[76:79], v[56:59], v[104:107]
  ds_read_b128 v[40:43], v11 offset:3072
  v_mfma_f32_16x16x32_bf16 v[108:111], v[80:83], v[56:59], v[108:111]
  ds_read_b128 v[44:47], v11 offset:4096
  v_mfma_f32_16x16x32_bf16 v[136:139], v[80:83], v[60:63], v[136:139]
  ds_read_b128 v[48:51], v11 offset:5120
  v_mfma_f32_16x16x32_bf16 v[164:167], v[80:83], v[64:67], v[164:167]
  ds_read_b128 v[52:55], v11 offset:6144
  v_mfma_f32_16x16x32_bf16 v[192:195], v[80:83], v[68:71], v[192:195]
  v_add_u32 v10, s53, v8
  v_mfma_f32_16x16x32_bf16 v[196:199], v[84:87], v[68:71], v[196:199]
  v_add_u32 v11, s53, v9
  v_mfma_f32_16x16x32_bf16 v[168:171], v[84:87], v[64:67], v[168:171]
  s_add_u32 s53, s53, 22528
  v_mfma_f32_16x16x32_bf16 v[140:143], v[84:87], v[60:63], v[140:143]
  s_cmp_eq_u32 s53, 157696
  v_mfma_f32_16x16x32_bf16 v[112:115], v[84:87], v[56:59], v[112:115]
  s_cselect_b32 s53, 0, s53
  v_mfma_f32_16x16x32_bf16 v[116:119], v[88:91], v[56:59], v[116:119]
  v_mfma_f32_16x16x32_bf16 v[144:147], v[88:91], v[60:63], v[144:147]
  v_mfma_f32_16x16x32_bf16 v[172:175], v[88:91], v[64:67], v[172:175]
  v_mfma_f32_16x16x32_bf16 v[200:203], v[88:91], v[68:71], v[200:203]
  v_mfma_f32_16x16x32_bf16 v[204:207], v[92:95], v[68:71], v[204:207]
  v_mfma_f32_16x16x32_bf16 v[176:179], v[92:95], v[64:67], v[176:179]
  v_mfma_f32_16x16x32_bf16 v[148:151], v[92:95], v[60:63], v[148:151]
  v_mfma_f32_16x16x32_bf16 v[120:123], v[92:95], v[56:59], v[120:123]
  v_mfma_f32_16x16x32_bf16 v[124:127], v[96:99], v[56:59], v[124:127]
  v_mfma_f32_16x16x32_bf16 v[152:155], v[96:99], v[60:63], v[152:155]
  v_mfma_f32_16x16x32_bf16 v[180:183], v[96:99], v[64:67], v[180:183]
  v_mfma_f32_16x16x32_bf16 v[208:211], v[96:99], v[68:71], v[208:211]
  s_waitcnt lgkmcnt(0)
  s_bitcmp1_b32 0x1d228, s56
  s_cbranch_scc1 L_b1_hook
L_b1_hookret:
  s_sub_u32 s56, s56, 1
  s_cmp_lg_u32 s56, 0
  s_cbranch_scc1 L_b1_cloop
  s_branch L_b1_cdone
L_b1_hook:
  s_cmp_lg_u32 s56, 3
  s_cbranch_scc1 L_b1_hk3
  s_waitcnt vmcnt(0)
  v_cmp_gt_u32 vcc, 1, v229
  s_nop 0
  s_cmp_eq_u64 vcc, 0
  s_cbranch_scc1 L_pu0d
  s_mov_b32 s66, 4194304
L_pu0:
  buffer_load_dword v229, v227, s[32:35], 0 offen sc1
  s_waitcnt vmcnt(0)
  v_cmp_gt_u32 vcc, 1, v229
  s_sub_u32 s66, s66, 1
  s_cbranch_scc1 L_pu0d
  s_cmp_lg_u64 vcc, 0
  s_cbranch_scc1 L_pu0
L_pu0d:
  s_branch L_b1_hookret
L_b1_hk3:
  s_cmp_lg_u32 s56, 5
  s_cbranch_scc1 L_b1_hk5
  buffer_load_dword v229, v227, s[32:35], 0 offen sc1
  s_branch L_b1_hookret
L_b1_hk5:
  s_cmp_lg_u32 s56, 9
  s_cbranch_scc1 L_b1_hk9
  v_mov_b32 v231, 1
  s_waitcnt vmcnt(0)
  buffer_store_dword v231, v230, s[32:35], s67 offen sc0 sc1
  s_branch L_b1_hookret
L_b1_hk9:
  s_cmp_lg_u32 s56, 12
  s_cbranch_scc1 L_b1_hk12
  buffer_store_dwordx4 v[212:215], v3, s[20:23], s48 offen offset:0 sc0 sc1
  buffer_store_dwordx4 v[212:215], v3, s[24:27], s64 offen offset:0 sc0 sc1
  buffer_store_dwordx4 v[212:215], v3, s[20:23], s48 offen offset:1024 sc0 sc1
  buffer_store_dwordx4 v[212:215], v3, s[24:27], s64 offen offset:1024 sc0 sc1
  buffer_store_dwordx4 v[212:215], v3, s[20:23], s48 offen offset:2048 sc0 sc1
  buffer_store_dwordx4 v[212:215], v3, s[24:27], s64 offen offset:2048 sc0 sc1
  buffer_store_dwordx4 v[212:215], v3, s[20:23], s48 offen offset:3072 sc0 sc1
  buffer_store_dwordx4 v[212:215], v3, s[24:27], s64 offen offset:3072 sc0 sc1
  s_branch L_b1_hookret
L_b1_hk12:
  s_cmp_lg_u32 s56, 14
  s_cbranch_scc1 L_b1_hk14
  s_waitcnt vmcnt(0)
  v_cmp_eq_u32 vcc, 0, v229
  s_nop 0
  s_cmp_eq_u64 vcc, 0
  s_cbranch_scc1 L_cg1d
  s_mov_b32 s66, 4194304
L_cg1:
  buffer_load_dword v229, v228, s[32:35], s65 offen sc1
  s_waitcnt vmcnt(0)
  v_cmp_eq_u32 vcc, 0, v229
  s_sub_u32 s66, s66, 1
  s_cbranch_scc1 L_cg1d
  s_cmp_lg_u64 vcc, 0
  s_cbranch_scc1 L_cg1
L_cg1d:
  s_branch L_b1_hookret
L_b1_hk14:
  s_cmp_lg_u32 s56, 15
  s_cbranch_scc1 L_b1_hk15
  buffer_load_dword v229, v228, s[32:35], s65 offen sc1
  s_branch L_b1_hookret
L_b1_hk15:
  s_waitcnt vmcnt(0)
  buffer_store_dword v231, v230, s[32:35], s57 offen sc0 sc1
  s_branch L_b1_hookret
L_b1_cdone:
  s_mul_i32 s47, s44, 384
  s_add_u32 s47, s47, 157696
  v_lshl_add_u32 v8, v5, 4, s47
  s_lshl_b32 s47, s44, 6
  s_add_u32 s47, s47, 158464
  v_lshl_add_u32 v9, v5, 4, s47
  s_lshl_b32 s47, s43, 9
  s_add_u32 s47, s47, 160768
  v_lshl_add_u32 v10, v4, 3, s47
  ds_read_b64 v[92:93], v10 offset:0
  ds_read_b64 v[94:95], v10 offset:128
  ds_read_b64 v[96:97], v10 offset:256
  ds_read_b64 v[98:99], v10 offset:384
  ds_read_b128 v[60:63], v8 offset:0
  ds_read_b128 v[68:71], v8 offset:896
  ds_read_b128 v[64:67], v8 offset:64
  ds_read_b128 v[72:75], v8 offset:960
  ds_read_b128 v[76:79], v9
  ds_read_b128 v[84:87], v9 offset:896
  s_waitcnt lgkmcnt(0)
  v_pk_fma_f32 v[12:13], v[60:61], v[92:93], v[68:69] op_sel_hi:[1,0,1]
  v_pk_fma_f32 v[14:15], v[62:63], v[92:93], v[70:71] op_sel_hi:[1,0,1]
  v_pk_fma_f32 v[16:17], v[64:65], v[92:93], v[72:73] op_sel_hi:[1,0,1]
  v_pk_fma_f32 v[18:19], v[66:67], v[92:93], v[74:75] op_sel_hi:[1,0,1]
  v_pk_fma_f32 v[100:101], v[100:101], v[92:93], v[12:13] op_sel:[0,1,0]
  v_pk_fma_f32 v[102:103], v[102:103], v[92:93], v[14:15] op_sel:[0,1,0]
  v_pk_fma_f32 v[104:105], v[104:105], v[92:93], v[16:17] op_sel:[0,1,0]
  v_pk_fma_f32 v[106:107], v[106:107], v[92:93], v[18:19] op_sel:[0,1,0]
  v_pk_mul_f32 v[12:13], v[100:101], s[52:53] op_sel_hi:[1,0]
  v_pk_mul_f32 v[14:15], v[102:103], s[52:53] op_sel_hi:[1,0]
  v_pk_mul_f32 v[16:17], v[104:105], s[52:53] op_sel_hi:[1,0]
  v_pk_mul_f32 v[18:19], v[106:107], s[52:53] op_sel_hi:[1,0]
  v_exp_f32 v12, v12
  v_exp_f32 v13, v13
  v_exp_f32 v14, v14
  v_exp_f32 v15, v15
  v_exp_f32 v16, v16
  v_exp_f32 v17, v17
  v_exp_f32 v18, v18
  v_exp_f32 v19, v19
  v_pk_add_f32 v[12:13], v[12:13], 1.0 op_sel_hi:[1,0]
  v_pk_add_f32 v[14:15], v[14:15], 1.0 op_sel_hi:[1,0]
  v_pk_add_f32 v[16:17], v[16:17], 1.0 op_sel_hi:[1,0]
  v_pk_add_f32 v[18:19], v[18:19], 1.0 op_sel_hi:[1,0]
  v_rcp_f32 v12, v12
  v_rcp_f32 v13, v13
  v_rcp_f32 v14, v14
  v_rcp_f32 v15, v15
  v_rcp_f32 v16, v16
  v_rcp_f32 v17, v17
  v_rcp_f32 v18, v18
  v_rcp_f32 v19, v19
  v_pk_mul_f32 v[12:13], v[12:13], v[100:101]
  v_pk_mul_f32 v[14:15], v[14:15], v[102:103]
  v_pk_mul_f32 v[16:17], v[16:17], v[104:105]
  v_pk_mul_f32 v[18:19], v[18:19], v[106:107]
  v_cvt_pk_bf16_f32 v20, v12, v13
  v_cvt_pk_bf16_f32 v21, v14, v15
  v_cvt_pk_bf16_f32 v22, v16, v17
  v_cvt_pk_bf16_f32 v23, v18, v19
  v_min_u32 v20, -2, v20
  v_min_u32 v21, -2, v21
  v_min_u32 v22, -2, v22
  v_min_u32 v23, -2, v23
  buffer_store_dwordx4 v[20:23], v3, s[20:23], s48 offen offset:0 sc0 sc1
  v_pk_fma_f32 v[12:13], v[60:61], v[94:95], v[68:69] op_sel_hi:[1,0,1]
  v_pk_fma_f32 v[14:15], v[62:63], v[94:95], v[70:71] op_sel_hi:[1,0,1]
  v_pk_fma_f32 v[16:17], v[64:65], v[94:95], v[72:73] op_sel_hi:[1,0,1]
  v_pk_fma_f32 v[18:19], v[66:67], v[94:95], v[74:75] op_sel_hi:[1,0,1]
  v_pk_fma_f32 v[128:129], v[128:129], v[94:95], v[12:13] op_sel:[0,1,0]
  v_pk_fma_f32 v[130:131], v[130:131], v[94:95], v[14:15] op_sel:[0,1,0]
  v_pk_fma_f32 v[132:133], v[132:133], v[94:95], v[16:17] op_sel:[0,1,0]
  v_pk_fma_f32 v[134:135], v[134:135], v[94:95], v[18:19] op_sel:[0,1,0]
  v_pk_mul_f32 v[12:13], v[128:129], s[52:53] op_sel_hi:[1,0]
  v_pk_mul_f32 v[14:15], v[130:131], s[52:53] op_sel_hi:[1,0]
  v_pk_mul_f32 v[16:17], v[132:133], s[52:53] op_sel_hi:[1,0]
  v_pk_mul_f32 v[18:19], v[134:135], s[52:53] op_sel_hi:[1,0]
  v_exp_f32 v12, v12
  v_exp_f32 v13, v13
  v_exp_f32 v14, v14
  v_exp_f32 v15, v15
  v_exp_f32 v16, v16
  v_exp_f32 v17, v17
  v_exp_f32 v18, v18
  v_exp_f32 v19, v19
  v_pk_add_f32 v[12:13], v[12:13], 1.0 op_sel_hi:[1,0]
  v_pk_add_f32 v[14:15], v[14:15], 1.0 op_sel_hi:[1,0]
  v_pk_add_f32 v[16:17], v[16:17], 1.0 op_sel_hi:[1,0]
  v_pk_add_f32 v[18:19], v[18:19], 1.0 op_sel_hi:[1,0]
  v_rcp_f32 v12, v12
  v_rcp_f32 v13, v13
  v_rcp_f32 v14, v14
  v_rcp_f32 v15, v15
  v_rcp_f32 v16, v16
  v_rcp_f32 v17, v17
  v_rcp_f32 v18, v18
  v_rcp_f32 v19, v19
  v_pk_mul_f32 v[12:13], v[12:13], v[128:129]
  v_pk_mul_f32 v[14:15], v[14:15], v[130:131]
  v_pk_mul_f32 v[16:17], v[16:17], v[132:133]
  v_pk_mul_f32 v[18:19], v[18:19], v[134:135]
  v_cvt_pk_bf16_f32 v24, v12, v13
  v_cvt_pk_bf16_f32 v25, v14, v15
  v_cvt_pk_bf16_f32 v26, v16, v17
  v_cvt_pk_bf16_f32 v27, v18, v19
  v_min_u32 v24, -2, v24
  v_min_u32 v25, -2, v25
  v_min_u32 v26, -2, v26
  v_min_u32 v27, -2, v27
  buffer_store_dwordx4 v[24:27], v3, s[20:23], s48 offen offset:1024 sc0 sc1
  v_pk_fma_f32 v[12:13], v[60:61], v[96:97], v[68:69] op_sel_hi:[1,0,1]
  v_pk_fma_f32 v[14:15], v[62:63], v[96:97], v[70:71] op_sel_hi:[1,0,1]
  v_pk_fma_f32 v[16:17], v[64:65], v[96:97], v[72:73] op_sel_hi:[1,0,1]
  v_pk_fma_f32 v[18:19], v[66:67], v[96:97], v[74:75] op_sel_hi:[1,0,1]
  v_pk_fma_f32 v[156:157], v[156:157], v[96:97], v[12:13] op_sel:[0,1,0]
  v_pk_fma_f32 v[158:159], v[158:159], v[96:97], v[14:15] op_sel:[0,1,0]
  v_pk_fma_f32 v[160:161], v[160:161], v[96:97], v[16:17] op_sel:[0,1,0]
  v_pk_fma_f32 v[162:163], v[162:163], v[96:97], v[18:19] op_sel:[0,1,0]
  v_pk_mul_f32 v[12:13], v[156:157], s[52:53] op_sel_hi:[1,0]
  v_pk_mul_f32 v[14:15], v[158:159], s[52:53] op_sel_hi:[1,0]
  v_pk_mul_f32 v[16:17], v[160:161], s[52:53] op_sel_hi:[1,0]
  v_pk_mul_f32 v[18:19], v[162:163], s[52:53] op_sel_hi:[1,0]
  v_exp_f32 v12, v12
  v_exp_f32 v13, v13
  v_exp_f32 v14, v14
  v_exp_f32 v15, v15
  v_exp_f32 v16, v16
  v_exp_f32 v17, v17
  v_exp_f32 v18, v18
  v_exp_f32 v19, v19
  v_pk_add_f32 v[12:13], v[12:13], 1.0 op_sel_hi:[1,0]
  v_pk_add_f32 v[14:15], v[14:15], 1.0 op_sel_hi:[1,0]
  v_pk_add_f32 v[16:17], v[16:17], 1.0 op_sel_hi:[1,0]
  v_pk_add_f32 v[18:19], v[18:19], 1.0 op_sel_hi:[1,0]
  v_rcp_f32 v12, v12
  v_rcp_f32 v13, v13
  v_rcp_f32 v14, v14
  v_rcp_f32 v15, v15
  v_rcp_f32 v16, v16
  v_rcp_f32 v17, v17
  v_rcp_f32 v18, v18
  v_rcp_f32 v19, v19
  v_pk_mul_f32 v[12:13], v[12:13], v[156:157]
  v_pk_mul_f32 v[14:15], v[14:15], v[158:159]
  v_pk_mul_f32 v[16:17], v[16:17], v[160:161]
  v_pk_mul_f32 v[18:19], v[18:19], v[162:163]
  v_cvt_pk_bf16_f32 v28, v12, v13
  v_cvt_pk_bf16_f32 v29, v14, v15
  v_cvt_pk_bf16_f32 v30, v16, v17
  v_cvt_pk_bf16_f32 v31, v18, v19
  v_min_u32 v28, -2, v28
  v_min_u32 v29, -2, v29
  v_min_u32 v30, -2, v30
  v_min_u32 v31, -2, v31
  buffer_store_dwordx4 v[28:31], v3, s[20:23], s48 offen offset:2048 sc0 sc1
  v_pk_fma_f32 v[12:13], v[60:61], v[98:99], v[68:69] op_sel_hi:[1,0,1]
  v_pk_fma_f32 v[14:15], v[62:63], v[98:99], v[70:71] op_sel_hi:[1,0,1]
  v_pk_fma_f32 v[16:17], v[64:65], v[98:99], v[72:73] op_sel_hi:[1,0,1]
  v_pk_fma_f32 v[18:19], v[66:67], v[98:99], v[74:75] op_sel_hi:[1,0,1]
  v_pk_fma_f32 v[184:185], v[184:185], v[98:99], v[12:13] op_sel:[0,1,0]
  v_pk_fma_f32 v[186:187], v[186:187], v[98:99], v[14:15] op_sel:[0,1,0]
  v_pk_fma_f32 v[188:189], v[188:189], v[98:99], v[16:17] op_sel:[0,1,0]
  v_pk_fma_f32 v[190:191], v[190:191], v[98:99], v[18:19] op_sel:[0,1,0]
  v_pk_mul_f32 v[12:13], v[184:185], s[52:53] op_sel_hi:[1,0]
  v_pk_mul_f32 v[14:15], v[186:187], s[52:53] op_sel_hi:[1,0]
  v_pk_mul_f32 v[16:17], v[188:189], s[52:53] op_sel_hi:[1,0]
  v_pk_mul_f32 v[18:19], v[190:191], s[52:53] op_sel_hi:[1,0]
  v_exp_f32 v12, v12
  v_exp_f32 v13, v13
  v_exp_f32 v14, v14
  v_exp_f32 v15, v15
  v_exp_f32 v16, v16
  v_exp_f32 v17, v17
  v_exp_f32 v18, v18
  v_exp_f32 v19, v19
  v_pk_add_f32 v[12:13], v[12:13], 1.0 op_sel_hi:[1,0]
  v_pk_add_f32 v[14:15], v[14:15], 1.0 op_sel_hi:[1,0]
  v_pk_add_f32 v[16:17], v[16:17], 1.0 op_sel_hi:[1,0]
  v_pk_add_f32 v[18:19], v[18:19], 1.0 op_sel_hi:[1,0]
  v_rcp_f32 v12, v12
  v_rcp_f32 v13, v13
  v_rcp_f32 v14, v14
  v_rcp_f32 v15, v15
  v_rcp_f32 v16, v16
  v_rcp_f32 v17, v17
  v_rcp_f32 v18, v18
  v_rcp_f32 v19, v19
  v_pk_mul_f32 v[12:13], v[12:13], v[184:185]
  v_pk_mul_f32 v[14:15], v[14:15], v[186:187]
  v_pk_mul_f32 v[16:17], v[16:17], v[188:189]
  v_pk_mul_f32 v[18:19], v[18:19], v[190:191]
  v_cvt_pk_bf16_f32 v32, v12, v13
  v_cvt_pk_bf16_f32 v33, v14, v15
  v_cvt_pk_bf16_f32 v34, v16, v17
  v_cvt_pk_bf16_f32 v35, v18, v19
  v_min_u32 v32, -2, v32
  v_min_u32 v33, -2, v33
  v_min_u32 v34, -2, v34
  v_min_u32 v35, -2, v35
  buffer_store_dwordx4 v[32:35], v3, s[20:23], s48 offen offset:3072 sc0 sc1
  ds_read_b128 v[60:63], v8 offset:128
  ds_read_b128 v[68:71], v8 offset:1024
  ds_read_b128 v[64:67], v8 offset:192
  ds_read_b128 v[72:75], v8 offset:1088
  v_pk_fma_f32 v[12:13], v[76:77], v[92:93], v[84:85] op_sel_hi:[1,0,1]
  v_pk_fma_f32 v[14:15], v[78:79], v[92:93], v[86:87] op_sel_hi:[1,0,1]
  v_pk_fma_f32 v[124:125], v[124:125], v[92:93], v[12:13] op_sel:[0,1,0]
  v_pk_fma_f32 v[126:127], v[126:127], v[92:93], v[14:15] op_sel:[0,1,0]
  v_pk_mul_f32 v[12:13], v[124:125], s[52:53] op_sel_hi:[1,0]
  v_pk_mul_f32 v[14:15], v[126:127], s[52:53] op_sel_hi:[1,0]
  v_exp_f32 v12, v12
  v_exp_f32 v13, v13
  v_exp_f32 v14, v14
  v_exp_f32 v15, v15
  v_pk_add_f32 v[12:13], v[12:13], 1.0 op_sel_hi:[1,0]
  v_pk_add_f32 v[14:15], v[14:15], 1.0 op_sel_hi:[1,0]
  v_rcp_f32 v12, v12
  v_rcp_f32 v13, v13
  v_rcp_f32 v14, v14
  v_rcp_f32 v15, v15
  v_pk_mul_f32 v[12:13], v[12:13], v[124:125]
  v_pk_mul_f32 v[14:15], v[14:15], v[126:127]
  v_cvt_pk_bf16_f32 v36, v12, v13
  v_cvt_pk_bf16_f32 v37, v14, v15
  v_pk_fma_f32 v[12:13], v[76:77], v[94:95], v[84:85] op_sel_hi:[1,0,1]
  v_pk_fma_f32 v[14:15], v[78:79], v[94:95], v[86:87] op_sel_hi:[1,0,1]
  v_pk_fma_f32 v[152:153], v[152:153], v[94:95], v[12:13] op_sel:[0,1,0]
  v_pk_fma_f32 v[154:155], v[154:155], v[94:95], v[14:15] op_sel:[0,1,0]
  v_pk_mul_f32 v[12:13], v[152:153], s[52:53] op_sel_hi:[1,0]
  v_pk_mul_f32 v[14:15], v[154:155], s[52:53] op_sel_hi:[1,0]
  v_exp_f32 v12, v12
  v_exp_f32 v13, v13
  v_exp_f32 v14, v14
  v_exp_f32 v15, v15
  v_pk_add_f32 v[12:13], v[12:13], 1.0 op_sel_hi:[1,0]
  v_pk_add_f32 v[14:15], v[14:15], 1.0 op_sel_hi:[1,0]
  v_rcp_f32 v12, v12
  v_rcp_f32 v13, v13
  v_rcp_f32 v14, v14
  v_rcp_f32 v15, v15
  v_pk_mul_f32 v[12:13], v[12:13], v[152:153]
  v_pk_mul_f32 v[14:15], v[14:15], v[154:155]
  v_cvt_pk_bf16_f32 v38, v12, v13
  v_cvt_pk_bf16_f32 v39, v14, v15
  s_nop 1
  v_permlane16_swap_b32 v36, v38
  v_permlane16_swap_b32 v37, v39
  buffer_store_dwordx4 v[36:39], v7, s[20:23], s50 offen offset:0 sc0 sc1
  v_pk_fma_f32 v[12:13], v[76:77], v[96:97], v[84:85] op_sel_hi:[1,0,1]
  v_pk_fma_f32 v[14:15], v[78:79], v[96:97], v[86:87] op_sel_hi:[1,0,1]
  v_pk_fma_f32 v[180:181], v[180:181], v[96:97], v[12:13] op_sel:[0,1,0]
  v_pk_fma_f32 v[182:183], v[182:183], v[96:97], v[14:15] op_sel:[0,1,0]
  v_pk_mul_f32 v[12:13], v[180:181], s[52:53] op_sel_hi:[1,0]
  v_pk_mul_f32 v[14:15], v[182:183], s[52:53] op_sel_hi:[1,0]
  v_exp_f32 v12, v12
  v_exp_f32 v13, v13
  v_exp_f32 v14, v14
  v_exp_f32 v15, v15
  v_pk_add_f32 v[12:13], v[12:13], 1.0 op_sel_hi:[1,0]
  v_pk_add_f32 v[14:15], v[14:15], 1.0 op_sel_hi:[1,0]
  v_rcp_f32 v12, v12
  v_rcp_f32 v13, v13
  v_rcp_f32 v14, v14
  v_rcp_f32 v15, v15
  v_pk_mul_f32 v[12:13], v[12:13], v[180:181]
  v_pk_mul_f32 v[14:15], v[14:15], v[182:183]
  v_cvt_pk_bf16_f32 v40, v12, v13
  v_cvt_pk_bf16_f32 v41, v14, v15
  v_pk_fma_f32 v[12:13], v[76:77], v[98:99], v[84:85] op_sel_hi:[1,0,1]
  v_pk_fma_f32 v[14:15], v[78:79], v[98:99], v[86:87] op_sel_hi:[1,0,1]
  v_pk_fma_f32 v[208:209], v[208:209], v[98:99], v[12:13] op_sel:[0,1,0]
  v_pk_fma_f32 v[210:211], v[210:211], v[98:99], v[14:15] op_sel:[0,1,0]
  v_pk_mul_f32 v[12:13], v[208:209], s[52:53] op_sel_hi:[1,0]
  v_pk_mul_f32 v[14:15], v[210:211], s[52:53] op_sel_hi:[1,0]
  v_exp_f32 v12, v12
  v_exp_f32 v13, v13
  v_exp_f32 v14, v14
  v_exp_f32 v15, v15
  v_pk_add_f32 v[12:13], v[12:13], 1.0 op_sel_hi:[1,0]
  v_pk_add_f32 v[14:15], v[14:15], 1.0 op_sel_hi:[1,0]
  v_rcp_f32 v12, v12
  v_rcp_f32 v13, v13
  v_rcp_f32 v14, v14
  v_rcp_f32 v15, v15
  v_pk_mul_f32 v[12:13], v[12:13], v[208:209]
  v_pk_mul_f32 v[14:15], v[14:15], v[210:211]
  v_cvt_pk_bf16_f32 v42, v12, v13
  v_cvt_pk_bf16_f32 v43, v14, v15
  s_nop 1
  v_permlane16_swap_b32 v40, v42
  v_permlane16_swap_b32 v41, v43
  buffer_store_dwordx4 v[40:43], v7, s[20:23], s50 offen offset:2048 sc0 sc1
  s_barrier
  ds_read_b128 v[76:79], v8 offset:256
  ds_read_b128 v[84:87], v8 offset:1152
  ds_read_b128 v[80:83], v8 offset:320
  ds_read_b128 v[88:91], v8 offset:1216
  s_waitcnt lgkmcnt(4)
  v_pk_fma_f32 v[12:13], v[60:61], v[92:93], v[68:69] op_sel_hi:[1,0,1]
  v_pk_fma_f32 v[14:15], v[62:63], v[92:93], v[70:71] op_sel_hi:[1,0,1]
  v_pk_fma_f32 v[16:17], v[64:65], v[92:93], v[72:73] op_sel_hi:[1,0,1]
  v_pk_fma_f32 v[18:19], v[66:67], v[92:93], v[74:75] op_sel_hi:[1,0,1]
  v_pk_fma_f32 v[108:109], v[108:109], v[92:93], v[12:13] op_sel:[0,1,0]
  v_pk_fma_f32 v[110:111], v[110:111], v[92:93], v[14:15] op_sel:[0,1,0]
  v_pk_fma_f32 v[112:113], v[112:113], v[92:93], v[16:17] op_sel:[0,1,0]
  v_pk_fma_f32 v[114:115], v[114:115], v[92:93], v[18:19] op_sel:[0,1,0]
  v_pk_mul_f32 v[12:13], v[108:109], s[52:53] op_sel_hi:[1,0]
  v_pk_mul_f32 v[14:15], v[110:111], s[52:53] op_sel_hi:[1,0]
  v_pk_mul_f32 v[16:17], v[112:113], s[52:53] op_sel_hi:[1,0]
  v_pk_mul_f32 v[18:19], v[114:115], s[52:53] op_sel_hi:[1,0]
  v_exp_f32 v12, v12
  v_exp_f32 v13, v13
  v_exp_f32 v14, v14
  v_exp_f32 v15, v15
  v_exp_f32 v16, v16
  v_exp_f32 v17, v17
  v_exp_f32 v18, v18
  v_exp_f32 v19, v19
  v_pk_add_f32 v[12:13], v[12:13], 1.0 op_sel_hi:[1,0]
  v_pk_add_f32 v[14:15], v[14:15], 1.0 op_sel_hi:[1,0]
  v_pk_add_f32 v[16:17], v[16:17], 1.0 op_sel_hi:[1,0]
  v_pk_add_f32 v[18:19], v[18:19], 1.0 op_sel_hi:[1,0]
  v_rcp_f32 v12, v12
  v_rcp_f32 v13, v13
  v_rcp_f32 v14, v14
  v_rcp_f32 v15, v15
  v_rcp_f32 v16, v16
  v_rcp_f32 v17, v17
  v_rcp_f32 v18, v18
  v_rcp_f32 v19, v19
  v_pk_mul_f32 v[12:13], v[12:13], v[108:109]
  v_pk_mul_f32 v[14:15], v[14:15], v[110:111]
  v_pk_mul_f32 v[16:17], v[16:17], v[112:113]
  v_pk_mul_f32 v[18:19], v[18:19], v[114:115]
  v_cvt_pk_bf16_f32 v44, v12, v13
  v_cvt_pk_bf16_f32 v45, v14, v15
  v_cvt_pk_bf16_f32 v46, v16, v17
  v_cvt_pk_bf16_f32 v47, v18, v19
  v_pk_fma_f32 v[12:13], v[60:61], v[94:95], v[68:69] op_sel_hi:[1,0,1]
  v_pk_fma_f32 v[14:15], v[62:63], v[94:95], v[70:71] op_sel_hi:[1,0,1]
  v_pk_fma_f32 v[16:17], v[64:65], v[94:95], v[72:73] op_sel_hi:[1,0,1]
  v_pk_fma_f32 v[18:19], v[66:67], v[94:95], v[74:75] op_sel_hi:[1,0,1]
  v_pk_fma_f32 v[136:137], v[136:137], v[94:95], v[12:13] op_sel:[0,1,0]
  v_pk_fma_f32 v[138:139], v[138:139], v[94:95], v[14:15] op_sel:[0,1,0]
  v_pk_fma_f32 v[140:141], v[140:141], v[94:95], v[16:17] op_sel:[0,1,0]
  v_pk_fma_f32 v[142:143], v[142:143], v[94:95], v[18:19] op_sel:[0,1,0]
  v_pk_mul_f32 v[12:13], v[136:137], s[52:53] op_sel_hi:[1,0]
  v_pk_mul_f32 v[14:15], v[138:139], s[52:53] op_sel_hi:[1,0]
  v_pk_mul_f32 v[16:17], v[140:141], s[52:53] op_sel_hi:[1,0]
  v_pk_mul_f32 v[18:19], v[142:143], s[52:53] op_sel_hi:[1,0]
  v_exp_f32 v12, v12
  v_exp_f32 v13, v13
  v_exp_f32 v14, v14
  v_exp_f32 v15, v15
  v_exp_f32 v16, v16
  v_exp_f32 v17, v17
  v_exp_f32 v18, v18
  v_exp_f32 v19, v19
  v_pk_add_f32 v[12:13], v[12:13], 1.0 op_sel_hi:[1,0]
  v_pk_add_f32 v[14:15], v[14:15], 1.0 op_sel_hi:[1,0]
  v_pk_add_f32 v[16:17], v[16:17], 1.0 op_sel_hi:[1,0]
  v_pk_add_f32 v[18:19], v[18:19], 1.0 op_sel_hi:[1,0]
  v_rcp_f32 v12, v12
  v_rcp_f32 v13, v13
  v_rcp_f32 v14, v14
  v_rcp_f32 v15, v15
  v_rcp_f32 v16, v16
  v_rcp_f32 v17, v17
  v_rcp_f32 v18, v18
  v_rcp_f32 v19, v19
  v_pk_mul_f32 v[12:13], v[12:13], v[136:137]
  v_pk_mul_f32 v[14:15], v[14:15], v[138:139]
  v_pk_mul_f32 v[16:17], v[16:17], v[140:141]
  v_pk_mul_f32 v[18:19], v[18:19], v[142:143]
  v_cvt_pk_bf16_f32 v48, v12, v13
  v_cvt_pk_bf16_f32 v49, v14, v15
  v_cvt_pk_bf16_f32 v50, v16, v17
  v_cvt_pk_bf16_f32 v51, v18, v19
  v_pk_fma_f32 v[12:13], v[60:61], v[96:97], v[68:69] op_sel_hi:[1,0,1]
  v_pk_fma_f32 v[14:15], v[62:63], v[96:97], v[70:71] op_sel_hi:[1,0,1]
  v_pk_fma_f32 v[16:17], v[64:65], v[96:97], v[72:73] op_sel_hi:[1,0,1]
  v_pk_fma_f32 v[18:19], v[66:67], v[96:97], v[74:75] op_sel_hi:[1,0,1]
  v_pk_fma_f32 v[164:165], v[164:165], v[96:97], v[12:13] op_sel:[0,1,0]
  v_pk_fma_f32 v[166:167], v[166:167], v[96:97], v[14:15] op_sel:[0,1,0]
  v_pk_fma_f32 v[168:169], v[168:169], v[96:97], v[16:17] op_sel:[0,1,0]
  v_pk_fma_f32 v[170:171], v[170:171], v[96:97], v[18:19] op_sel:[0,1,0]
  v_pk_mul_f32 v[12:13], v[164:165], s[52:53] op_sel_hi:[1,0]
  v_pk_mul_f32 v[14:15], v[166:167], s[52:53] op_sel_hi:[1,0]
  v_pk_mul_f32 v[16:17], v[168:169], s[52:53] op_sel_hi:[1,0]
  v_pk_mul_f32 v[18:19], v[170:171], s[52:53] op_sel_hi:[1,0]
  v_exp_f32 v12, v12
  v_exp_f32 v13, v13
  v_exp_f32 v14, v14
  v_exp_f32 v15, v15
  v_exp_f32 v16, v16
  v_exp_f32 v17, v17
  v_exp_f32 v18, v18
  v_exp_f32 v19, v19
  v_pk_add_f32 v[12:13], v[12:13], 1.0 op_sel_hi:[1,0]
  v_pk_add_f32 v[14:15], v[14:15], 1.0 op_sel_hi:[1,0]
  v_pk_add_f32 v[16:17], v[16:17], 1.0 op_sel_hi:[1,0]
  v_pk_add_f32 v[18:19], v[18:19], 1.0 op_sel_hi:[1,0]
  v_rcp_f32 v12, v12
  v_rcp_f32 v13, v13
  v_rcp_f32 v14, v14
  v_rcp_f32 v15, v15
  v_rcp_f32 v16, v16
  v_rcp_f32 v17, v17
  v_rcp_f32 v18, v18
  v_rcp_f32 v19, v19
  v_pk_mul_f32 v[12:13], v[12:13], v[164:165]
  v_pk_mul_f32 v[14:15], v[14:15], v[166:167]
  v_pk_mul_f32 v[16:17], v[16:17], v[168:169]
  v_pk_mul_f32 v[18:19], v[18:19], v[170:171]
  v_cvt_pk_bf16_f32 v52, v12, v13
  v_cvt_pk_bf16_f32 v53, v14, v15
  v_cvt_pk_bf16_f32 v54, v16, v17
  v_cvt_pk_bf16_f32 v55, v18, v19
  v_pk_fma_f32 v[12:13], v[60:61], v[98:99], v[68:69] op_sel_hi:[1,0,1]
  v_pk_fma_f32 v[14:15], v[62:63], v[98:99], v[70:71] op_sel_hi:[1,0,1]
  v_pk_fma_f32 v[16:17], v[64:65], v[98:99], v[72:73] op_sel_hi:[1,0,1]
  v_pk_fma_f32 v[18:19], v[66:67], v[98:99], v[74:75] op_sel_hi:[1,0,1]
  v_pk_fma_f32 v[192:193], v[192:193], v[98:99], v[12:13] op_sel:[0,1,0]
  v_pk_fma_f32 v[194:195], v[194:195], v[98:99], v[14:15] op_sel:[0,1,0]
  v_pk_fma_f32 v[196:197], v[196:197], v[98:99], v[16:17] op_sel:[0,1,0]
  v_pk_fma_f32 v[198:199], v[198:199], v[98:99], v[18:19] op_sel:[0,1,0]
  v_pk_mul_f32 v[12:13], v[192:193], s[52:53] op_sel_hi:[1,0]
  v_pk_mul_f32 v[14:15], v[194:195], s[52:53] op_sel_hi:[1,0]
  v_pk_mul_f32 v[16:17], v[196:197], s[52:53] op_sel_hi:[1,0]
  v_pk_mul_f32 v[18:19], v[198:199], s[52:53] op_sel_hi:[1,0]
  v_exp_f32 v12, v12
  v_exp_f32 v13, v13
  v_exp_f32 v14, v14
  v_exp_f32 v15, v15
  v_exp_f32 v16, v16
  v_exp_f32 v17, v17
  v_exp_f32 v18, v18
  v_exp_f32 v19, v19
  v_pk_add_f32 v[12:13], v[12:13], 1.0 op_sel_hi:[1,0]
  v_pk_add_f32 v[14:15], v[14:15], 1.0 op_sel_hi:[1,0]
  v_pk_add_f32 v[16:17], v[16:17], 1.0 op_sel_hi:[1,0]
  v_pk_add_f32 v[18:19], v[18:19], 1.0 op_sel_hi:[1,0]
  v_rcp_f32 v12, v12
  v_rcp_f32 v13, v13
  v_rcp_f32 v14, v14
  v_rcp_f32 v15, v15
  v_rcp_f32 v16, v16
  v_rcp_f32 v17, v17
  v_rcp_f32 v18, v18
  v_rcp_f32 v19, v19
  v_pk_mul_f32 v[12:13], v[12:13], v[192:193]
  v_pk_mul_f32 v[14:15], v[14:15], v[194:195]
  v_pk_mul_f32 v[16:17], v[16:17], v[196:197]
  v_pk_mul_f32 v[18:19], v[18:19], v[198:199]
  v_cvt_pk_bf16_f32 v56, v12, v13
  v_cvt_pk_bf16_f32 v57, v14, v15
  v_cvt_pk_bf16_f32 v58, v16, v17
  v_cvt_pk_bf16_f32 v59, v18, v19
  s_waitcnt lgkmcnt(0)
  v_pk_fma_f32 v[12:13], v[76:77], v[92:93], v[84:85] op_sel_hi:[1,0,1]
  v_pk_fma_f32 v[14:15], v[78:79], v[92:93], v[86:87] op_sel_hi:[1,0,1]
  v_pk_fma_f32 v[16:17], v[80:81], v[92:93], v[88:89] op_sel_hi:[1,0,1]
  v_pk_fma_f32 v[18:19], v[82:83], v[92:93], v[90:91] op_sel_hi:[1,0,1]
  v_pk_fma_f32 v[116:117], v[116:117], v[92:93], v[12:13] op_sel:[0,1,0]
  v_pk_fma_f32 v[118:119], v[118:119], v[92:93], v[14:15] op_sel:[0,1,0]
  v_pk_fma_f32 v[120:121], v[120:121], v[92:93], v[16:17] op_sel:[0,1,0]
  v_pk_fma_f32 v[122:123], v[122:123], v[92:93], v[18:19] op_sel:[0,1,0]
  v_pk_mul_f32 v[12:13], v[116:117], s[52:53] op_sel_hi:[1,0]
  v_pk_mul_f32 v[14:15], v[118:119], s[52:53] op_sel_hi:[1,0]
  v_pk_mul_f32 v[16:17], v[120:121], s[52:53] op_sel_hi:[1,0]
  v_pk_mul_f32 v[18:19], v[122:123], s[52:53] op_sel_hi:[1,0]
  v_exp_f32 v12, v12
  v_exp_f32 v13, v13
  v_exp_f32 v14, v14
  v_exp_f32 v15, v15
  v_exp_f32 v16, v16
  v_exp_f32 v17, v17
  v_exp_f32 v18, v18
  v_exp_f32 v19, v19
  v_pk_add_f32 v[12:13], v[12:13], 1.0 op_sel_hi:[1,0]
  v_pk_add_f32 v[14:15], v[14:15], 1.0 op_sel_hi:[1,0]
  v_pk_add_f32 v[16:17], v[16:17], 1.0 op_sel_hi:[1,0]
  v_pk_add_f32 v[18:19], v[18:19], 1.0 op_sel_hi:[1,0]
  v_rcp_f32 v12, v12
  v_rcp_f32 v13, v13
  v_rcp_f32 v14, v14
  v_rcp_f32 v15, v15
  v_rcp_f32 v16, v16
  v_rcp_f32 v17, v17
  v_rcp_f32 v18, v18
  v_rcp_f32 v19, v19
  v_pk_mul_f32 v[12:13], v[12:13], v[116:117]
  v_pk_mul_f32 v[14:15], v[14:15], v[118:119]
  v_pk_mul_f32 v[16:17], v[16:17], v[120:121]
  v_pk_mul_f32 v[18:19], v[18:19], v[122:123]
  v_cvt_pk_bf16_f32 v232, v12, v13
  v_cvt_pk_bf16_f32 v233, v14, v15
  v_cvt_pk_bf16_f32 v234, v16, v17
  v_cvt_pk_bf16_f32 v235, v18, v19
  v_pk_fma_f32 v[12:13], v[76:77], v[94:95], v[84:85] op_sel_hi:[1,0,1]
  v_pk_fma_f32 v[14:15], v[78:79], v[94:95], v[86:87] op_sel_hi:[1,0,1]
  v_pk_fma_f32 v[16:17], v[80:81], v[94:95], v[88:89] op_sel_hi:[1,0,1]
  v_pk_fma_f32 v[18:19], v[82:83], v[94:95], v[90:91] op_sel_hi:[1,0,1]
  v_pk_fma_f32 v[144:145], v[144:145], v[94:95], v[12:13] op_sel:[0,1,0]
  v_pk_fma_f32 v[146:147], v[146:147], v[94:95], v[14:15] op_sel:[0,1,0]
  v_pk_fma_f32 v[148:149], v[148:149], v[94:95], v[16:17] op_sel:[0,1,0]
  v_pk_fma_f32 v[150:151], v[150:151], v[94:95], v[18:19] op_sel:[0,1,0]
  v_pk_mul_f32 v[12:13], v[144:145], s[52:53] op_sel_hi:[1,0]
  v_pk_mul_f32 v[14:15], v[146:147], s[52:53] op_sel_hi:[1,0]
  v_pk_mul_f32 v[16:17], v[148:149], s[52:53] op_sel_hi:[1,0]
  v_pk_mul_f32 v[18:19], v[150:151], s[52:53] op_sel_hi:[1,0]
  v_exp_f32 v12, v12
  v_exp_f32 v13, v13
  v_exp_f32 v14, v14
  v_exp_f32 v15, v15
  v_exp_f32 v16, v16
  v_exp_f32 v17, v17
  v_exp_f32 v18, v18
  v_exp_f32 v19, v19
  v_pk_add_f32 v[12:13], v[12:13], 1.0 op_sel_hi:[1,0]
  v_pk_add_f32 v[14:15], v[14:15], 1.0 op_sel_hi:[1,0]
  v_pk_add_f32 v[16:17], v[16:17], 1.0 op_sel_hi:[1,0]
  v_pk_add_f32 v[18:19], v[18:19], 1.0 op_sel_hi:[1,0]
  v_rcp_f32 v12, v12
  v_rcp_f32 v13, v13
  v_rcp_f32 v14, v14
  v_rcp_f32 v15, v15
  v_rcp_f32 v16, v16
  v_rcp_f32 v17, v17
  v_rcp_f32 v18, v18
  v_rcp_f32 v19, v19
  v_pk_mul_f32 v[12:13], v[12:13], v[144:145]
  v_pk_mul_f32 v[14:15], v[14:15], v[146:147]
  v_pk_mul_f32 v[16:17], v[16:17], v[148:149]
  v_pk_mul_f32 v[18:19], v[18:19], v[150:151]
  v_cvt_pk_bf16_f32 v236, v12, v13
  v_cvt_pk_bf16_f32 v237, v14, v15
  v_cvt_pk_bf16_f32 v238, v16, v17
  v_cvt_pk_bf16_f32 v239, v18, v19
  v_pk_fma_f32 v[12:13], v[76:77], v[96:97], v[84:85] op_sel_hi:[1,0,1]
  v_pk_fma_f32 v[14:15], v[78:79], v[96:97], v[86:87] op_sel_hi:[1,0,1]
  v_pk_fma_f32 v[16:17], v[80:81], v[96:97], v[88:89] op_sel_hi:[1,0,1]
  v_pk_fma_f32 v[18:19], v[82:83], v[96:97], v[90:91] op_sel_hi:[1,0,1]
  v_pk_fma_f32 v[172:173], v[172:173], v[96:97], v[12:13] op_sel:[0,1,0]
  v_pk_fma_f32 v[174:175], v[174:175], v[96:97], v[14:15] op_sel:[0,1,0]
  v_pk_fma_f32 v[176:177], v[176:177], v[96:97], v[16:17] op_sel:[0,1,0]
  v_pk_fma_f32 v[178:179], v[178:179], v[96:97], v[18:19] op_sel:[0,1,0]
  v_pk_mul_f32 v[12:13], v[172:173], s[52:53] op_sel_hi:[1,0]
  v_pk_mul_f32 v[14:15], v[174:175], s[52:53] op_sel_hi:[1,0]
  v_pk_mul_f32 v[16:17], v[176:177], s[52:53] op_sel_hi:[1,0]
  v_pk_mul_f32 v[18:19], v[178:179], s[52:53] op_sel_hi:[1,0]
  v_exp_f32 v12, v12
  v_exp_f32 v13, v13
  v_exp_f32 v14, v14
  v_exp_f32 v15, v15
  v_exp_f32 v16, v16
  v_exp_f32 v17, v17
  v_exp_f32 v18, v18
  v_exp_f32 v19, v19
  v_pk_add_f32 v[12:13], v[12:13], 1.0 op_sel_hi:[1,0]
  v_pk_add_f32 v[14:15], v[14:15], 1.0 op_sel_hi:[1,0]
  v_pk_add_f32 v[16:17], v[16:17], 1.0 op_sel_hi:[1,0]
  v_pk_add_f32 v[18:19], v[18:19], 1.0 op_sel_hi:[1,0]
  v_rcp_f32 v12, v12
  v_rcp_f32 v13, v13
  v_rcp_f32 v14, v14
  v_rcp_f32 v15, v15
  v_rcp_f32 v16, v16
  v_rcp_f32 v17, v17
  v_rcp_f32 v18, v18
  v_rcp_f32 v19, v19
  v_pk_mul_f32 v[12:13], v[12:13], v[172:173]
  v_pk_mul_f32 v[14:15], v[14:15], v[174:175]
  v_pk_mul_f32 v[16:17], v[16:17], v[176:177]
  v_pk_mul_f32 v[18:19], v[18:19], v[178:179]
  v_cvt_pk_bf16_f32 v240, v12, v13
  v_cvt_pk_bf16_f32 v241, v14, v15
  v_cvt_pk_bf16_f32 v242, v16, v17
  v_cvt_pk_bf16_f32 v243, v18, v19
  v_pk_fma_f32 v[12:13], v[76:77], v[98:99], v[84:85] op_sel_hi:[1,0,1]
  v_pk_fma_f32 v[14:15], v[78:79], v[98:99], v[86:87] op_sel_hi:[1,0,1]
  v_pk_fma_f32 v[16:17], v[80:81], v[98:99], v[88:89] op_sel_hi:[1,0,1]
  v_pk_fma_f32 v[18:19], v[82:83], v[98:99], v[90:91] op_sel_hi:[1,0,1]
  v_pk_fma_f32 v[200:201], v[200:201], v[98:99], v[12:13] op_sel:[0,1,0]
  v_pk_fma_f32 v[202:203], v[202:203], v[98:99], v[14:15] op_sel:[0,1,0]
  v_pk_fma_f32 v[204:205], v[204:205], v[98:99], v[16:17] op_sel:[0,1,0]
  v_pk_fma_f32 v[206:207], v[206:207], v[98:99], v[18:19] op_sel:[0,1,0]
  v_pk_mul_f32 v[12:13], v[200:201], s[52:53] op_sel_hi:[1,0]
  v_pk_mul_f32 v[14:15], v[202:203], s[52:53] op_sel_hi:[1,0]
  v_pk_mul_f32 v[16:17], v[204:205], s[52:53] op_sel_hi:[1,0]
  v_pk_mul_f32 v[18:19], v[206:207], s[52:53] op_sel_hi:[1,0]
  v_exp_f32 v12, v12
  v_exp_f32 v13, v13
  v_exp_f32 v14, v14
  v_exp_f32 v15, v15
  v_exp_f32 v16, v16
  v_exp_f32 v17, v17
  v_exp_f32 v18, v18
  v_exp_f32 v19, v19
  v_pk_add_f32 v[12:13], v[12:13], 1.0 op_sel_hi:[1,0]
  v_pk_add_f32 v[14:15], v[14:15], 1.0 op_sel_hi:[1,0]
  v_pk_add_f32 v[16:17], v[16:17], 1.0 op_sel_hi:[1,0]
  v_pk_add_f32 v[18:19], v[18:19], 1.0 op_sel_hi:[1,0]
  v_rcp_f32 v12, v12
  v_rcp_f32 v13, v13
  v_rcp_f32 v14, v14
  v_rcp_f32 v15, v15
  v_rcp_f32 v16, v16
  v_rcp_f32 v17, v17
  v_rcp_f32 v18, v18
  v_rcp_f32 v19, v19
  v_pk_mul_f32 v[12:13], v[12:13], v[200:201]
  v_pk_mul_f32 v[14:15], v[14:15], v[202:203]
  v_pk_mul_f32 v[16:17], v[16:17], v[204:205]
  v_pk_mul_f32 v[18:19], v[18:19], v[206:207]
  v_cvt_pk_bf16_f32 v244, v12, v13
  v_cvt_pk_bf16_f32 v245, v14, v15
  v_cvt_pk_bf16_f32 v246, v16, v17
  v_cvt_pk_bf16_f32 v247, v18, v19
  v_mov_b32 v231, 2
  s_waitcnt vmcnt(0)
  buffer_store_dword v231, v230, s[32:35], s67 offen sc0 sc1
  s_add_u32 s68, s48, 196608
  s_add_u32 s69, s48, 327680
  s_add_u32 s36, s10, 18874368
  s_addc_u32 s37, s11, 0
  s_and_b32 s37, s37, 0xffff
  s_mov_b32 s38, 14680064
  s_mov_b32 s39, 0x20000
  s_and_b32 s61, s2, 1
  s_bfe_u32 s40, s2, 0x20001
  s_lshl_b32 s40, s40, 2
  s_bfe_u32 s3, s2, 0x20003
  s_add_u32 s40, s40, s3
  s_lshr_b32 s41, s2, 5
  s_add_u32 s20, s10, 10485760
  s_addc_u32 s21, s11, 0
  s_and_b32 s21, s21, 0xffff
  s_mov_b32 s22, 4194304
  s_mov_b32 s23, 0x20000
  s_mov_b32 s28, s8
  s_and_b32 s29, s9, 0xffff
  s_mov_b32 s30, 4194304
  s_mov_b32 s31, 0x20000
  s_lshl_b32 s62, s41, 2
  s_lshl_b32 s58, s44, 1
  s_add_u32 s62, s62, s58
  s_add_u32 s62, s62, s61
  s_lshl_b32 s59, s40, 18
  s_lshl_b32 s58, s62, 13
  s_add_u32 s59, s59, s58
  s_lshl_b32 s58, s43, 12
  s_add_u32 s59, s59, s58
  s_lshl_b32 s60, s40, 18
  s_lshl_b32 s58, s43, 17
  s_add_u32 s60, s60, s58
  s_lshl_b32 s58, s62, 6
  s_add_u32 s60, s60, s58
  s_and_b32 s58, s62, 3
  s_lshl_b32 s58, s58, 7
  s_add_u32 s58, s58, 161792
  v_lshl_add_u32 v6, v5, 4, s58
  s_lshl_b32 s45, s43, 12
  v_add_u32 v8, s45, v3
  s_mul_i32 s46, s44, 4096
  s_add_u32 s46, s46, 16384
  v_add_u32 v9, s46, v3
  s_mov_b32 s53, 0
  v_mov_b32 v140, 0
  v_mov_b32 v141, 0
  v_mov_b32 v142, 0
  v_mov_b32 v143, 0
  v_mov_b32 v144, 0
  v_mov_b32 v145, 0
  v_mov_b32 v146, 0
  v_mov_b32 v147, 0
  v_mov_b32 v148, 0
  v_mov_b32 v149, 0
  v_mov_b32 v150, 0
  v_mov_b32 v151, 0
  v_mov_b32 v152, 0
  v_mov_b32 v153, 0
  v_mov_b32 v154, 0
  v_mov_b32 v155, 0
  v_mov_b32 v156, 0
  v_mov_b32 v157, 0
  v_mov_b32 v158, 0
  v_mov_b32 v159, 0
  v_mov_b32 v160, 0
  v_mov_b32 v161, 0
  v_mov_b32 v162, 0
  v_mov_b32 v163, 0
  v_mov_b32 v164, 0
  v_mov_b32 v165, 0
  v_mov_b32 v166, 0
  v_mov_b32 v167, 0
  v_mov_b32 v168, 0
  v_mov_b32 v169, 0
  v_mov_b32 v170, 0
  v_mov_b32 v171, 0
  v_mov_b32 v172, 0
  v_mov_b32 v173, 0
  v_mov_b32 v174, 0
  v_mov_b32 v175, 0
  v_mov_b32 v176, 0
  v_mov_b32 v177, 0
  v_mov_b32 v178, 0
  v_mov_b32 v179, 0
  v_mov_b32 v180, 0
  v_mov_b32 v181, 0
  v_mov_b32 v182, 0
  v_mov_b32 v183, 0
  v_mov_b32 v184, 0
  v_mov_b32 v185, 0
  v_mov_b32 v186, 0
  v_mov_b32 v187, 0
  v_mov_b32 v188, 0
  v_mov_b32 v189, 0
  v_mov_b32 v190, 0
  v_mov_b32 v191, 0
  v_mov_b32 v192, 0
  v_mov_b32 v193, 0
  v_mov_b32 v194, 0
  v_mov_b32 v195, 0
  v_mov_b32 v196, 0
  v_mov_b32 v197, 0
  v_mov_b32 v198, 0
  v_mov_b32 v199, 0
  v_mov_b32 v200, 0
  v_mov_b32 v201, 0
  v_mov_b32 v202, 0
  v_mov_b32 v203, 0
  v_add_u32 v10, s53, v8
  v_add_u32 v11, s53, v9
  s_add_u32 s53, s53, 32768
  s_cmp_eq_u32 s53, 131072
  s_cselect_b32 s53, 0, s53
  s_barrier
  buffer_store_dwordx4 v[44:47], v3, s[36:39], s68 offen offset:0 sc0 sc1
  buffer_store_dwordx4 v[48:51], v3, s[36:39], s68 offen offset:1024 sc0 sc1
  buffer_store_dwordx4 v[52:55], v3, s[36:39], s68 offen offset:2048 sc0 sc1
  buffer_store_dwordx4 v[56:59], v3, s[36:39], s68 offen offset:3072 sc0 sc1
  ds_read_b128 v[28:31], v11 offset:0
  ds_read_b128 v[12:15], v10 offset:0
  ds_read_b128 v[16:19], v10 offset:1024
  ds_read_b128 v[20:23], v10 offset:2048
  ds_read_b128 v[24:27], v10 offset:3072
  ds_read_b128 v[32:35], v11 offset:1024
  ds_read_b128 v[36:39], v11 offset:2048
  ds_read_b128 v[40:43], v11 offset:3072
  ds_read_b128 v[60:63], v11 offset:8192
  ds_read_b128 v[44:47], v10 offset:8192
  ds_read_b128 v[48:51], v10 offset:9216
  ds_read_b128 v[52:55], v10 offset:10240
  ds_read_b128 v[56:59], v10 offset:11264
  ds_read_b128 v[64:67], v11 offset:9216
  ds_read_b128 v[68:71], v11 offset:10240
  ds_read_b128 v[72:75], v11 offset:11264
  v_add_u32 v10, s53, v8
  v_add_u32 v11, s53, v9
  s_add_u32 s53, s53, 32768
  s_cmp_eq_u32 s53, 131072
  s_cselect_b32 s53, 0, s53
  s_mov_b32 s56, 14
  s_waitcnt lgkmcnt(0)
.p2align 6
L_b2_cloop:
  s_barrier
  v_mfma_f32_16x16x32_bf16 v[140:143], v[28:31], v[12:15], v[140:143]
  ds_read_b128 v[92:95], v11 offset:0
  v_mfma_f32_16x16x32_bf16 v[140:143], v[60:63], v[44:47], v[140:143]
  ds_read_b128 v[76:79], v10 offset:0
  v_mfma_f32_16x16x32_bf16 v[156:159], v[28:31], v[16:19], v[156:159]
  ds_read_b128 v[80:83], v10 offset:1024
  v_mfma_f32_16x16x32_bf16 v[156:159], v[60:63], v[48:51], v[156:159]
  ds_read_b128 v[84:87], v10 offset:2048
  v_mfma_f32_16x16x32_bf16 v[172:175], v[28:31], v[20:23], v[172:175]
  ds_read_b128 v[88:91], v10 offset:3072
  v_mfma_f32_16x16x32_bf16 v[172:175], v[60:63], v[52:55], v[172:175]
  ds_read_b128 v[96:99], v11 offset:1024
  v_mfma_f32_16x16x32_bf16 v[188:191], v[28:31], v[24:27], v[188:191]
  ds_read_b128 v[100:103], v11 offset:2048
  v_mfma_f32_16x16x32_bf16 v[188:191], v[60:63], v[56:59], v[188:191]
  ds_read_b128 v[104:107], v11 offset:3072
  v_mfma_f32_16x16x32_bf16 v[192:195], v[32:35], v[24:27], v[192:195]
  ds_read_b128 v[124:127], v11 offset:8192
  v_mfma_f32_16x16x32_bf16 v[192:195], v[64:67], v[56:59], v[192:195]
  ds_read_b128 v[108:111], v10 offset:8192
  v_mfma_f32_16x16x32_bf16 v[176:179], v[32:35], v[20:23], v[176:179]
  ds_read_b128 v[112:115], v10 offset:9216
  v_mfma_f32_16x16x32_bf16 v[176:179], v[64:67], v[52:55], v[176:179]
  ds_read_b128 v[116:119], v10 offset:10240
  v_mfma_f32_16x16x32_bf16 v[160:163], v[32:35], v[16:19], v[160:163]
  ds_read_b128 v[120:123], v10 offset:11264
  v_mfma_f32_16x16x32_bf16 v[160:163], v[64:67], v[48:51], v[160:163]
  ds_read_b128 v[128:131], v11 offset:9216
  v_mfma_f32_16x16x32_bf16 v[144:147], v[32:35], v[12:15], v[144:147]
  ds_read_b128 v[132:135], v11 offset:10240
  v_mfma_f32_16x16x32_bf16 v[144:147], v[64:67], v[44:47], v[144:147]
  ds_read_b128 v[136:139], v11 offset:11264
  v_mfma_f32_16x16x32_bf16 v[148:151], v[36:39], v[12:15], v[148:151]
  v_add_u32 v10, s53, v8
  v_mfma_f32_16x16x32_bf16 v[148:151], v[68:71], v[44:47], v[148:151]
  v_add_u32 v11, s53, v9
  v_mfma_f32_16x16x32_bf16 v[164:167], v[36:39], v[16:19], v[164:167]
  s_add_u32 s53, s53, 32768
  v_mfma_f32_16x16x32_bf16 v[164:167], v[68:71], v[48:51], v[164:167]
  s_cmp_eq_u32 s53, 131072
  v_mfma_f32_16x16x32_bf16 v[180:183], v[36:39], v[20:23], v[180:183]
  s_cselect_b32 s53, 0, s53
  v_mfma_f32_16x16x32_bf16 v[180:183], v[68:71], v[52:55], v[180:183]
  v_mfma_f32_16x16x32_bf16 v[196:199], v[36:39], v[24:27], v[196:199]
  v_mfma_f32_16x16x32_bf16 v[196:199], v[68:71], v[56:59], v[196:199]
  v_mfma_f32_16x16x32_bf16 v[200:203], v[40:43], v[24:27], v[200:203]
  v_mfma_f32_16x16x32_bf16 v[200:203], v[72:75], v[56:59], v[200:203]
  v_mfma_f32_16x16x32_bf16 v[184:187], v[40:43], v[20:23], v[184:187]
  v_mfma_f32_16x16x32_bf16 v[184:187], v[72:75], v[52:55], v[184:187]
  v_mfma_f32_16x16x32_bf16 v[168:171], v[40:43], v[16:19], v[168:171]
  v_mfma_f32_16x16x32_bf16 v[168:171], v[72:75], v[48:51], v[168:171]
  v_mfma_f32_16x16x32_bf16 v[152:155], v[40:43], v[12:15], v[152:155]
  v_mfma_f32_16x16x32_bf16 v[152:155], v[72:75], v[44:47], v[152:155]
  s_waitcnt lgkmcnt(0)
  s_barrier
  v_mfma_f32_16x16x32_bf16 v[140:143], v[92:95], v[76:79], v[140:143]
  ds_read_b128 v[28:31], v11 offset:0
  v_mfma_f32_16x16x32_bf16 v[140:143], v[124:127], v[108:111], v[140:143]
  ds_read_b128 v[12:15], v10 offset:0
  v_mfma_f32_16x16x32_bf16 v[156:159], v[92:95], v[80:83], v[156:159]
  ds_read_b128 v[16:19], v10 offset:1024
  v_mfma_f32_16x16x32_bf16 v[156:159], v[124:127], v[112:115], v[156:159]
  ds_read_b128 v[20:23], v10 offset:2048
  v_mfma_f32_16x16x32_bf16 v[172:175], v[92:95], v[84:87], v[172:175]
  ds_read_b128 v[24:27], v10 offset:3072
  v_mfma_f32_16x16x32_bf16 v[172:175], v[124:127], v[116:119], v[172:175]
  ds_read_b128 v[32:35], v11 offset:1024
  v_mfma_f32_16x16x32_bf16 v[188:191], v[92:95], v[88:91], v[188:191]
  ds_read_b128 v[36:39], v11 offset:2048
  v_mfma_f32_16x16x32_bf16 v[188:191], v[124:127], v[120:123], v[188:191]
  ds_read_b128 v[40:43], v11 offset:3072
  v_mfma_f32_16x16x32_bf16 v[192:195], v[96:99], v[88:91], v[192:195]
  ds_read_b128 v[60:63], v11 offset:8192
  v_mfma_f32_16x16x32_bf16 v[192:195], v[128:131], v[120:123], v[192:195]
  ds_read_b128 v[44:47], v10 offset:8192
  v_mfma_f32_16x16x32_bf16 v[176:179], v[96:99], v[84:87], v[176:179]
  ds_read_b128 v[48:51], v10 offset:9216
  v_mfma_f32_16x16x32_bf16 v[176:179], v[128:131], v[116:119], v[176:179]
  ds_read_b128 v[52:55], v10 offset:10240
  v_mfma_f32_16x16x32_bf16 v[160:163], v[96:99], v[80:83], v[160:163]
  ds_read_b128 v[56:59], v10 offset:11264
  v_mfma_f32_16x16x32_bf16 v[160:163], v[128:131], v[112:115], v[160:163]
  ds_read_b128 v[64:67], v11 offset:9216
  v_mfma_f32_16x16x32_bf16 v[144:147], v[96:99], v[76:79], v[144:147]
  ds_read_b128 v[68:71], v11 offset:10240
  v_mfma_f32_16x16x32_bf16 v[144:147], v[128:131], v[108:111], v[144:147]
  ds_read_b128 v[72:75], v11 offset:11264
  v_mfma_f32_16x16x32_bf16 v[148:151], v[100:103], v[76:79], v[148:151]
  v_add_u32 v10, s53, v8
  v_mfma_f32_16x16x32_bf16 v[148:151], v[132:135], v[108:111], v[148:151]
  v_add_u32 v11, s53, v9
  v_mfma_f32_16x16x32_bf16 v[164:167], v[100:103], v[80:83], v[164:167]
  s_add_u32 s53, s53, 32768
  v_mfma_f32_16x16x32_bf16 v[164:167], v[132:135], v[112:115], v[164:167]
  s_cmp_eq_u32 s53, 131072
  v_mfma_f32_16x16x32_bf16 v[180:183], v[100:103], v[84:87], v[180:183]
  s_cselect_b32 s53, 0, s53
  v_mfma_f32_16x16x32_bf16 v[180:183], v[132:135], v[116:119], v[180:183]
  v_mfma_f32_16x16x32_bf16 v[196:199], v[100:103], v[88:91], v[196:199]
  v_mfma_f32_16x16x32_bf16 v[196:199], v[132:135], v[120:123], v[196:199]
  v_mfma_f32_16x16x32_bf16 v[200:203], v[104:107], v[88:91], v[200:203]
  v_mfma_f32_16x16x32_bf16 v[200:203], v[136:139], v[120:123], v[200:203]
  v_mfma_f32_16x16x32_bf16 v[184:187], v[104:107], v[84:87], v[184:187]
  v_mfma_f32_16x16x32_bf16 v[184:187], v[136:139], v[116:119], v[184:187]
  v_mfma_f32_16x16x32_bf16 v[168:171], v[104:107], v[80:83], v[168:171]
  v_mfma_f32_16x16x32_bf16 v[168:171], v[136:139], v[112:115], v[168:171]
  v_mfma_f32_16x16x32_bf16 v[152:155], v[104:107], v[76:79], v[152:155]
  v_mfma_f32_16x16x32_bf16 v[152:155], v[136:139], v[108:111], v[152:155]
  s_waitcnt lgkmcnt(0)
  s_bitcmp1_b32 0x7988, s56
  s_cbranch_scc1 L_b2_hook
L_b2_hookret:
  s_sub_u32 s56, s56, 1
  s_cmp_lg_u32 s56, 0
  s_cbranch_scc1 L_b2_cloop
  s_branch L_b2_cdone
L_b2_hook:
  s_cmp_lg_u32 s56, 3
  s_cbranch_scc1 L_b2_hk3
  buffer_load_dwordx4 v[212:215], v3, s[20:23], s59 offen offset:0 sc1
  buffer_load_dwordx4 v[216:219], v3, s[20:23], s59 offen offset:1024 sc1
  buffer_load_dwordx4 v[220:223], v3, s[20:23], s59 offen offset:2048 sc1
  buffer_load_dwordx4 v[224:227], v3, s[20:23], s59 offen offset:3072 sc1
  s_branch L_b2_hookret
L_b2_hk3:
  s_cmp_lg_u32 s56, 7
  s_cbranch_scc1 L_b2_hk7
  s_waitcnt vmcnt(0)
  v_cmp_gt_u32 vcc, 4, v229
  s_nop 0
  s_cmp_eq_u64 vcc, 0
  s_cbranch_scc1 L_pu3d
  s_mov_b32 s66, 4194304
L_pu3:
  buffer_load_dword v229, v227, s[32:35], 0 offen sc1
  s_waitcnt vmcnt(0)
  v_cmp_gt_u32 vcc, 4, v229
  s_sub_u32 s66, s66, 1
  s_cbranch_scc1 L_pu3d
  s_cmp_lg_u64 vcc, 0
  s_cbranch_scc1 L_pu3
L_pu3d:
  s_branch L_b2_hookret
L_b2_hk7:
  s_cmp_lg_u32 s56, 8
  s_cbranch_scc1 L_b2_hk8
  buffer_load_dword v229, v227, s[32:35], 0 offen sc1
  s_branch L_b2_hookret
L_b2_hk8:
  s_cmp_lg_u32 s56, 11
  s_cbranch_scc1 L_b2_hk11
  v_mov_b32 v231, 4
  s_waitcnt vmcnt(0)
  buffer_store_dword v231, v230, s[32:35], s67 offen sc0 sc1
  v_cmp_gt_u32 vcc, 3, v229
  s_nop 0
  s_cmp_eq_u64 vcc, 0
  s_cbranch_scc1 L_pu2d
  s_mov_b32 s66, 4194304
L_pu2:
  buffer_load_dword v229, v227, s[32:35], 0 offen sc1
  s_waitcnt vmcnt(0)
  v_cmp_gt_u32 vcc, 3, v229
  s_sub_u32 s66, s66, 1
  s_cbranch_scc1 L_pu2d
  s_cmp_lg_u64 vcc, 0
  s_cbranch_scc1 L_pu2
L_pu2d:
  s_branch L_b2_hookret
L_b2_hk11:
  s_cmp_lg_u32 s56, 12
  s_cbranch_scc1 L_b2_hk12
  buffer_load_dword v229, v227, s[32:35], 0 offen sc1
  s_branch L_b2_hookret
L_b2_hk12:
  s_cmp_lg_u32 s56, 13
  s_cbranch_scc1 L_b2_hk13
  v_mov_b32 v231, 3
  s_waitcnt vmcnt(0)
  buffer_store_dword v231, v230, s[32:35], s67 offen sc0 sc1
  v_cmp_gt_u32 vcc, 2, v229
  s_nop 0
  s_cmp_eq_u64 vcc, 0
  s_cbranch_scc1 L_pu1cd
  s_mov_b32 s66, 4194304
L_pu1c:
  buffer_load_dword v229, v227, s[32:35], 0 offen sc1
  s_waitcnt vmcnt(0)
  v_cmp_gt_u32 vcc, 2, v229
  s_sub_u32 s66, s66, 1
  s_cbranch_scc1 L_pu1cd
  s_cmp_lg_u64 vcc, 0
  s_cbranch_scc1 L_pu1c
L_pu1cd:
  buffer_store_dwordx4 v[232:235], v3, s[36:39], s69 offen offset:0 sc0 sc1
  buffer_store_dwordx4 v[236:239], v3, s[36:39], s69 offen offset:1024 sc0 sc1
  buffer_store_dwordx4 v[240:243], v3, s[36:39], s69 offen offset:2048 sc0 sc1
  buffer_store_dwordx4 v[244:247], v3, s[36:39], s69 offen offset:3072 sc0 sc1
  s_branch L_b2_hookret
L_b2_hk13:
  buffer_load_dword v229, v227, s[32:35], 0 offen sc1
  s_branch L_b2_hookret
L_b2_cdone:
  ds_read_b128 v[204:207], v6
  ds_read_b128 v[208:211], v6 offset:64
  s_waitcnt vmcnt(0)
  s_nop 2
  v_cvt_pk_bf16_f32 v76, v148, v149
  v_cvt_pk_bf16_f32 v77, v150, v151
  v_cvt_pk_bf16_f32 v78, v152, v153
  v_cvt_pk_bf16_f32 v79, v154, v155
  v_min_u32 v76, -2, v76
  v_min_u32 v77, -2, v77
  v_min_u32 v78, -2, v78
  v_min_u32 v79, -2, v79
  buffer_store_dwordx4 v[76:79], v3, s[24:27], s64 offen offset:0 sc0 sc1
  v_cvt_pk_bf16_f32 v80, v164, v165
  v_cvt_pk_bf16_f32 v81, v166, v167
  v_cvt_pk_bf16_f32 v82, v168, v169
  v_cvt_pk_bf16_f32 v83, v170, v171
  v_min_u32 v80, -2, v80
  v_min_u32 v81, -2, v81
  v_min_u32 v82, -2, v82
  v_min_u32 v83, -2, v83
  buffer_store_dwordx4 v[80:83], v3, s[24:27], s64 offen offset:1024 sc0 sc1
  v_cvt_pk_bf16_f32 v84, v180, v181
  v_cvt_pk_bf16_f32 v85, v182, v183
  v_cvt_pk_bf16_f32 v86, v184, v185
  v_cvt_pk_bf16_f32 v87, v186, v187
  v_min_u32 v84, -2, v84
  v_min_u32 v85, -2, v85
  v_min_u32 v86, -2, v86
  v_min_u32 v87, -2, v87
  buffer_store_dwordx4 v[84:87], v3, s[24:27], s64 offen offset:2048 sc0 sc1
  v_cvt_pk_bf16_f32 v88, v196, v197
  v_cvt_pk_bf16_f32 v89, v198, v199
  v_cvt_pk_bf16_f32 v90, v200, v201
  v_cvt_pk_bf16_f32 v91, v202, v203
  v_min_u32 v88, -2, v88
  v_min_u32 v89, -2, v89
  v_min_u32 v90, -2, v90
  v_min_u32 v91, -2, v91
  buffer_store_dwordx4 v[88:91], v3, s[24:27], s64 offen offset:3072 sc0 sc1
  v_lshlrev_b32 v12, 16, v212
  v_and_b32 v13, 0xffff0000, v212
  v_lshlrev_b32 v14, 16, v213
  v_and_b32 v15, 0xffff0000, v213
  v_lshlrev_b32 v16, 16, v214
  v_and_b32 v17, 0xffff0000, v214
  v_lshlrev_b32 v18, 16, v215
  v_and_b32 v19, 0xffff0000, v215
  v_lshlrev_b32 v20, 16, v216
  v_and_b32 v21, 0xffff0000, v216
  v_lshlrev_b32 v22, 16, v217
  v_and_b32 v23, 0xffff0000, v217
  v_lshlrev_b32 v24, 16, v218
  v_and_b32 v25, 0xffff0000, v218
  v_lshlrev_b32 v26, 16, v219
  v_and_b32 v27, 0xffff0000, v219
  v_lshlrev_b32 v28, 16, v220
  v_and_b32 v29, 0xffff0000, v220
  v_lshlrev_b32 v30, 16, v221
  v_and_b32 v31, 0xffff0000, v221
  v_lshlrev_b32 v32, 16, v222
  v_and_b32 v33, 0xffff0000, v222
  v_lshlrev_b32 v34, 16, v223
  v_and_b32 v35, 0xffff0000, v223
  v_lshlrev_b32 v36, 16, v224
  v_and_b32 v37, 0xffff0000, v224
  v_lshlrev_b32 v38, 16, v225
  v_and_b32 v39, 0xffff0000, v225
  v_lshlrev_b32 v40, 16, v226
  v_and_b32 v41, 0xffff0000, v226
  v_lshlrev_b32 v42, 16, v227
  v_and_b32 v43, 0xffff0000, v227
  s_mov_b32 s66, 4194304
L_px:
  buffer_load_dwordx4 v[92:95], v3, s[24:27], s63 offen offset:0 sc1
  buffer_load_dwordx4 v[96:99], v3, s[24:27], s63 offen offset:1024 sc1
  buffer_load_dwordx4 v[100:103], v3, s[24:27], s63 offen offset:2048 sc1
  buffer_load_dwordx4 v[104:107], v3, s[24:27], s63 offen offset:3072 sc1
  s_waitcnt vmcnt(0)
  v_max3_u32 v7, v92, v93, v94
  v_max3_u32 v7, v7, v95, v96
  v_max3_u32 v7, v7, v97, v98
  v_max3_u32 v7, v7, v99, v100
  v_max3_u32 v7, v7, v101, v102
  v_max3_u32 v7, v7, v103, v104
  v_max3_u32 v7, v7, v105, v106
  v_max_u32 v7, v7, v107
  v_cmp_eq_u32 vcc, -1, v7
  s_sub_u32 s66, s66, 1
  s_cbranch_scc1 L_pxd
  s_cmp_lg_u64 vcc, 0
  s_cbranch_scc1 L_px
L_pxd:
  v_and_b32 v7, 1, v5
  v_lshlrev_b32 v7, 5, v7
  v_lshrrev_b32 v8, 1, v5
  v_lshl_add_u32 v7, v8, 4, v7
  v_lshl_add_u32 v7, v4, 11, v7
  s_waitcnt lgkmcnt(0)
  v_lshlrev_b32 v44, 16, v92
  v_and_b32 v45, 0xffff0000, v92
  v_lshlrev_b32 v46, 16, v93
  v_and_b32 v47, 0xffff0000, v93
  v_lshlrev_b32 v48, 16, v94
  v_and_b32 v49, 0xffff0000, v94
  v_lshlrev_b32 v50, 16, v95
  v_and_b32 v51, 0xffff0000, v95
  v_pk_add_f32 v[44:45], v[44:45], v[140:141]
  v_pk_add_f32 v[46:47], v[46:47], v[142:143]
  v_pk_add_f32 v[48:49], v[48:49], v[144:145]
  v_pk_add_f32 v[50:51], v[50:51], v[146:147]
  v_pk_fma_f32 v[12:13], v[44:45], v[204:205], v[12:13]
  v_pk_fma_f32 v[14:15], v[46:47], v[206:207], v[14:15]
  v_pk_fma_f32 v[16:17], v[48:49], v[208:209], v[16:17]
  v_pk_fma_f32 v[18:19], v[50:51], v[210:211], v[18:19]
  v_cvt_pk_bf16_f32 v212, v12, v13
  v_cvt_pk_bf16_f32 v213, v14, v15
  v_cvt_pk_bf16_f32 v214, v16, v17
  v_cvt_pk_bf16_f32 v215, v18, v19
  s_add_u32 s58, s60, 0
  s_nop 0
  v_permlane16_swap_b32 v212, v214
  v_permlane16_swap_b32 v213, v215
  buffer_store_dwordx4 v[212:215], v7, s[28:31], s58 offen sc0 sc1
  v_lshlrev_b32 v52, 16, v96
  v_and_b32 v53, 0xffff0000, v96
  v_lshlrev_b32 v54, 16, v97
  v_and_b32 v55, 0xffff0000, v97
  v_lshlrev_b32 v56, 16, v98
  v_and_b32 v57, 0xffff0000, v98
  v_lshlrev_b32 v58, 16, v99
  v_and_b32 v59, 0xffff0000, v99
  v_pk_add_f32 v[52:53], v[52:53], v[156:157]
  v_pk_add_f32 v[54:55], v[54:55], v[158:159]
  v_pk_add_f32 v[56:57], v[56:57], v[160:161]
  v_pk_add_f32 v[58:59], v[58:59], v[162:163]
  v_pk_fma_f32 v[20:21], v[52:53], v[204:205], v[20:21]
  v_pk_fma_f32 v[22:23], v[54:55], v[206:207], v[22:23]
  v_pk_fma_f32 v[24:25], v[56:57], v[208:209], v[24:25]
  v_pk_fma_f32 v[26:27], v[58:59], v[210:211], v[26:27]
  v_cvt_pk_bf16_f32 v216, v20, v21
  v_cvt_pk_bf16_f32 v217, v22, v23
  v_cvt_pk_bf16_f32 v218, v24, v25
  v_cvt_pk_bf16_f32 v219, v26, v27
  s_add_u32 s58, s60, 32768
  s_nop 0
  v_permlane16_swap_b32 v216, v218
  v_permlane16_swap_b32 v217, v219
  buffer_store_dwordx4 v[216:219], v7, s[28:31], s58 offen sc0 sc1
  v_lshlrev_b32 v60, 16, v100
  v_and_b32 v61, 0xffff0000, v100
  v_lshlrev_b32 v62, 16, v101
  v_and_b32 v63, 0xffff0000, v101
  v_lshlrev_b32 v64, 16, v102
  v_and_b32 v65, 0xffff0000, v102
  v_lshlrev_b32 v66, 16, v103
  v_and_b32 v67, 0xffff0000, v103
  v_pk_add_f32 v[60:61], v[60:61], v[172:173]
  v_pk_add_f32 v[62:63], v[62:63], v[174:175]
  v_pk_add_f32 v[64:65], v[64:65], v[176:177]
  v_pk_add_f32 v[66:67], v[66:67], v[178:179]
  v_pk_fma_f32 v[28:29], v[60:61], v[204:205], v[28:29]
  v_pk_fma_f32 v[30:31], v[62:63], v[206:207], v[30:31]
  v_pk_fma_f32 v[32:33], v[64:65], v[208:209], v[32:33]
  v_pk_fma_f32 v[34:35], v[66:67], v[210:211], v[34:35]
  v_cvt_pk_bf16_f32 v220, v28, v29
  v_cvt_pk_bf16_f32 v221, v30, v31
  v_cvt_pk_bf16_f32 v222, v32, v33
  v_cvt_pk_bf16_f32 v223, v34, v35
  s_add_u32 s58, s60, 65536
  s_nop 0
  v_permlane16_swap_b32 v220, v222
  v_permlane16_swap_b32 v221, v223
  buffer_store_dwordx4 v[220:223], v7, s[28:31], s58 offen sc0 sc1
  v_lshlrev_b32 v68, 16, v104
  v_and_b32 v69, 0xffff0000, v104
  v_lshlrev_b32 v70, 16, v105
  v_and_b32 v71, 0xffff0000, v105
  v_lshlrev_b32 v72, 16, v106
  v_and_b32 v73, 0xffff0000, v106
  v_lshlrev_b32 v74, 16, v107
  v_and_b32 v75, 0xffff0000, v107
  v_pk_add_f32 v[68:69], v[68:69], v[188:189]
  v_pk_add_f32 v[70:71], v[70:71], v[190:191]
  v_pk_add_f32 v[72:73], v[72:73], v[192:193]
  v_pk_add_f32 v[74:75], v[74:75], v[194:195]
  v_pk_fma_f32 v[36:37], v[68:69], v[204:205], v[36:37]
  v_pk_fma_f32 v[38:39], v[70:71], v[206:207], v[38:39]
  v_pk_fma_f32 v[40:41], v[72:73], v[208:209], v[40:41]
  v_pk_fma_f32 v[42:43], v[74:75], v[210:211], v[42:43]
  v_cvt_pk_bf16_f32 v224, v36, v37
  v_cvt_pk_bf16_f32 v225, v38, v39
  v_cvt_pk_bf16_f32 v226, v40, v41
  v_cvt_pk_bf16_f32 v227, v42, v43
  s_add_u32 s58, s60, 98304
  s_nop 0
  v_permlane16_swap_b32 v224, v226
  v_permlane16_swap_b32 v225, v227
  buffer_store_dwordx4 v[224:227], v7, s[28:31], s58 offen sc0 sc1
  s_endpgm
L_attn_bar:
  s_waitcnt lgkmcnt(0)
  s_barrier
  s_branch L_attn_barret
L_attn_fallback:
  v_mov_b32 v12, 0xff800000
  v_mov_b32 v14, 0xff800000
  s_mov_b32 s50, 0
  s_waitcnt lgkmcnt(0)
L_attn_floop:
  buffer_load_dwordx4 v[112:115], v3, s[20:23], s50 offen sc1
  buffer_load_dwordx4 v[116:119], v3, s[20:23], s50 offen offset:1024 sc1
  s_waitcnt vmcnt(0)
  v_mfma_f32_32x32x16_bf16 v[16:31], v[112:115], v[144:147], 0
  v_mfma_f32_32x32x16_bf16 v[32:47], v[112:115], v[152:155], 0
  v_mfma_f32_32x32x16_bf16 v[16:31], v[116:119], v[148:151], v[16:31]
  v_mfma_f32_32x32x16_bf16 v[32:47], v[116:119], v[156:159], v[32:47]
  s_nop 11
  v_max3_f32 v12, v12, v16, v17
  v_max3_f32 v12, v12, v18, v19
  v_max3_f32 v12, v12, v20, v21
  v_max3_f32 v12, v12, v22, v23
  v_max3_f32 v12, v12, v24, v25
  v_max3_f32 v12, v12, v26, v27
  v_max3_f32 v12, v12, v28, v29
  v_max3_f32 v12, v12, v30, v31
  v_max3_f32 v14, v14, v32, v33
  v_max3_f32 v14, v14, v34, v35
  v_max3_f32 v14, v14, v36, v37
  v_max3_f32 v14, v14, v38, v39
  v_max3_f32 v14, v14, v40, v41
  v_max3_f32 v14, v14, v42, v43
  v_max3_f32 v14, v14, v44, v45
  v_max3_f32 v14, v14, v46, v47
  s_add_u32 s50, s50, 4096
  s_cmp_lt_u32 s50, 262144
  s_cbranch_scc1 L_attn_floop
  v_mov_b32 v13, v12
  v_mov_b32 v15, v14
  s_nop 1
  v_permlane32_swap_b32 v12, v13
  v_permlane32_swap_b32 v14, v15
  v_max_f32 v12, v12, v13
  v_max_f32 v14, v14, v15
  v_sub_f32 v12, 0, v12
  v_sub_f32 v14, 0, v14
  v_mov_b32 v13, v12
  v_mov_b32 v15, v14
  v_mov_b64 v[80:81], v[12:13]
  v_mov_b64 v[82:83], v[12:13]
  v_mov_b64 v[84:85], v[12:13]
  v_mov_b64 v[86:87], v[12:13]
  v_mov_b64 v[88:89], v[12:13]
  v_mov_b64 v[90:91], v[12:13]
  v_mov_b64 v[92:93], v[12:13]
  v_mov_b64 v[94:95], v[12:13]
  v_mov_b64 v[96:97], v[14:15]
  v_mov_b64 v[98:99], v[14:15]
  v_mov_b64 v[100:101], v[14:15]
  v_mov_b64 v[102:103], v[14:15]
  v_mov_b64 v[104:105], v[14:15]
  v_mov_b64 v[106:107], v[14:15]
  v_mov_b64 v[108:109], v[14:15]
  v_mov_b64 v[110:111], v[14:15]
  v_mov_b64 v[48:49], 0
  v_mov_b64 v[64:65], 0
  v_mov_b64 v[50:51], 0
  v_mov_b64 v[66:67], 0
  v_mov_b64 v[52:53], 0
  v_mov_b64 v[68:69], 0
  v_mov_b64 v[54:55], 0
  v_mov_b64 v[70:71], 0
  v_mov_b64 v[56:57], 0
  v_mov_b64 v[72:73], 0
  v_mov_b64 v[58:59], 0
  v_mov_b64 v[74:75], 0
  v_mov_b64 v[60:61], 0
  v_mov_b64 v[76:77], 0
  v_mov_b64 v[62:63], 0
  v_mov_b64 v[78:79], 0
  v_mov_b64 v[128:129], 0
  v_mov_b64 v[132:133], 0
  v_mov_b64 v[130:131], 0
  v_mov_b64 v[134:135], 0
  s_mov_b32 s50, 0
L_attn_floop2:
  buffer_load_dwordx4 v[112:115], v3, s[20:23], s50 offen sc1
  buffer_load_dwordx4 v[116:119], v3, s[20:23], s50 offen offset:1024 sc1
  buffer_load_dwordx4 v[120:123], v3, s[20:23], s50 offen offset:2048 sc1
  buffer_load_dwordx4 v[124:127], v3, s[20:23], s50 offen offset:3072 sc1
  s_waitcnt vmcnt(0)
  v_mfma_f32_32x32x16_bf16 v[16:31], v[112:115], v[144:147], v[80:95]
  v_mfma_f32_32x32x16_bf16 v[32:47], v[112:115], v[152:155], v[96:111]
  v_mfma_f32_32x32x16_bf16 v[16:31], v[116:119], v[148:151], v[16:31]
  v_mfma_f32_32x32x16_bf16 v[32:47], v[116:119], v[156:159], v[32:47]
  s_nop 11
  v_exp_f32 v16, v16
  v_exp_f32 v17, v17
  v_exp_f32 v18, v18
  v_exp_f32 v19, v19
  v_exp_f32 v20, v20
  v_exp_f32 v21, v21
  v_exp_f32 v22, v22
  v_exp_f32 v23, v23
  v_exp_f32 v24, v24
  v_exp_f32 v25, v25
  v_exp_f32 v26, v26
  v_exp_f32 v27, v27
  v_exp_f32 v28, v28
  v_exp_f32 v29, v29
  v_exp_f32 v30, v30
  v_exp_f32 v31, v31
  v_exp_f32 v32, v32
  v_exp_f32 v33, v33
  v_exp_f32 v34, v34
  v_exp_f32 v35, v35
  v_exp_f32 v36, v36
  v_exp_f32 v37, v37
  v_exp_f32 v38, v38
  v_exp_f32 v39, v39
  v_exp_f32 v40, v40
  v_exp_f32 v41, v41
  v_exp_f32 v42, v42
  v_exp_f32 v43, v43
  v_exp_f32 v44, v44
  v_exp_f32 v45, v45
  v_exp_f32 v46, v46
  v_exp_f32 v47, v47
  s_nop 1
  v_smfmac_f32_32x32x32_bf16 v[48:63], v[120:123], v[16:23], v140
  v_smfmac_f32_32x32x32_bf16 v[48:63], v[124:127], v[24:31], v140
  v_smfmac_f32_16x16x64_bf16 v[128:131], v[136:139], v[16:23], v140
  v_smfmac_f32_16x16x64_bf16 v[128:131], v[136:139], v[24:31], v140
  v_smfmac_f32_32x32x32_bf16 v[64:79], v[120:123], v[32:39], v140
  v_smfmac_f32_32x32x32_bf16 v[64:79], v[124:127], v[40:47], v140
  v_smfmac_f32_16x16x64_bf16 v[132:135], v[136:139], v[32:39], v140
  v_smfmac_f32_16x16x64_bf16 v[132:135], v[136:139], v[40:47], v140
  s_add_u32 s50, s50, 4096
  s_cmp_lt_u32 s50, 262144
  s_cbranch_scc1 L_attn_floop2
  s_nop 11
  s_branch L_attn_norm
L_f_exit:
  s_endpgm
L_code_end:
.section .rodata,"a"
.p2align 6
.amdhsa_kernel adaLN_cond__grouped_kv_mqa__dense_activation_silu__prompt_kernel
  .amdhsa_next_free_vgpr 248
  .amdhsa_next_free_sgpr 96
  .amdhsa_accum_offset 248
  .amdhsa_group_segment_fixed_size 0
  .amdhsa_kernarg_size 104
  .amdhsa_user_sgpr_count 2
  .amdhsa_user_sgpr_kernarg_segment_ptr 1
  .amdhsa_system_sgpr_workgroup_id_x 1
  .amdhsa_float_denorm_mode_32 3
  .amdhsa_float_denorm_mode_16_64 3
.end_amdhsa_kernel
```
